```python
import torch

def _softmax(x, axis=-1):
    return torch.softmax(x, dim=axis)

def _gelu(x):
    return torch.nn.functional.gelu(x, approximate='tanh')

def _silu(x):
    return torch.nn.functional.silu(x)

def _sigmoid(x):
    return torch.sigmoid(x)

def _layernorm(x, axis=-1, eps=1e-05):
    m = x.mean(dim=axis, keepdim=True)
    v = x.var(dim=axis, keepdim=True, unbiased=False)
    return (x - m) / torch.sqrt(v + eps)

def _scatter_add(tgt, idx, src, axis=0):
    return tgt.clone().index_add_(axis, idx, src)

def _segment_sum(src, seg, n):
    out = torch.zeros((n,) + src.shape[1:], dtype=src.dtype)
    return out.index_add_(0, seg, src)

def _pad(x, pw):
    flat = tuple((v for pair in reversed(pw) for v in pair))
    return torch.nn.functional.pad(x, flat)
kernel_name = 'recurrent_scan__memory_aug_recurrent_mem_tr__swiglu_ffn__prompt'

def setup_inputs():

    _w = lambda a: (lambda t: t.to(torch.bfloat16) if t.is_floating_point() else t)(torch.as_tensor(a))

    def _A_setup():
        B, S, Dm = (1, 2048, 640)
        H, Dh = (32, 192)
        M, seg = (8, 32)
        seg = min(seg, S)
        S = S // seg * seg
        return {'x': _w((lambda *s: torch.randn(*s, dtype=torch.bfloat16) * 0.05)(B, S, Dm)), 'mem0': _w((lambda *s: torch.randn(*s, dtype=torch.bfloat16) * 0.2)(B, M, Dm)), 'Wq': _w((lambda *s: torch.randn(*s, dtype=torch.bfloat16) * 0.8)(Dm, H, Dh) * Dm ** (-0.5)), 'Wk': _w((lambda *s: torch.randn(*s, dtype=torch.bfloat16) * 0.8)(Dm, H, Dh) * Dm ** (-0.5)), 'Wv': _w((lambda *s: torch.randn(*s, dtype=torch.bfloat16) * 0.2)(Dm, H, Dh) * Dm ** (-0.5)), 'Wo': _w((lambda *s: torch.randn(*s, dtype=torch.bfloat16) * 0.2)(H, Dh, Dm) * (H * Dh) ** (-0.5)), 'seg_len': seg}
    _A_in = _A_setup()

    def _B_setup():
        B, S, D, F = (1, 2048, 640, 1536)
        return {'x': _w((lambda *s: torch.randn(*s, dtype=torch.bfloat16) * 0.05)(B, S, D)), 'w_gate': _w((lambda *s: torch.randn(*s, dtype=torch.bfloat16) * 0.1)(D, F)), 'w_up': _w((lambda *s: torch.randn(*s, dtype=torch.bfloat16) * 0.1)(D, F)), 'w_down': _w((lambda *s: torch.randn(*s, dtype=torch.bfloat16) * 0.1)(F, D))}
    _B_in = _B_setup()
    return {'A_x': _A_in['x'], 'A_mem0': _A_in['mem0'], 'A_Wq': _A_in['Wq'], 'A_Wk': _A_in['Wk'], 'A_Wv': _A_in['Wv'], 'A_Wo': _A_in['Wo'], 'A_seg_len': _A_in['seg_len'], 'B_x': _B_in['x'], 'B_w_gate': _B_in['w_gate'], 'B_w_up': _B_in['w_up'], 'B_w_down': _B_in['w_down']}

def reference(A_x, A_mem0, A_Wq, A_Wk, A_Wv, A_Wo, A_seg_len, B_x, B_w_gate, B_w_up, B_w_down):

    def _A_ref(x, mem0, Wq, Wk, Wv, Wo, seg_len):
        B, S, Dm = x.shape
        H, Dh = (Wq.shape[1], Wq.shape[2])
        M = mem0.shape[1]
        scale = Dh ** (-0.5)
        n_seg = S // seg_len
        L = M + seg_len
        idx = torch.arange(L)
        mask = (idx[:, None] < M) | (idx[:, None] >= idx[None, :])
        mem = mem0
        outs = []
        for s in range(n_seg):
            xs = x[:, s * seg_len:(s + 1) * seg_len, :].clone()
            h = torch.concatenate([mem, xs], axis=1)
            q = torch.einsum('btd,dhe->bhte', h, Wq)
            k = torch.einsum('btd,dhe->bhte', h, Wk)
            v = torch.einsum('btd,dhe->bhte', h, Wv)
            scores = torch.einsum('bhqe,bhke->bhqk', q, k) * scale
            scores = torch.where(mask[None, None], scores, -1000000000.0)
            p = _softmax(scores, axis=-1)
            o = torch.einsum('bhqk,bhke->bhqe', p, v)
            o = torch.einsum('bhte,hed->btd', o, Wo)
            mem = o[:, :M, :].clone()
            outs.append(o[:, M:, :])
        return torch.concatenate(outs, axis=1)

    def _B_ref(x, w_gate, w_up, w_down):
        g = _silu(x @ w_gate)
        u = x @ w_up
        return g * u @ w_down
    x = A_x
    xn = _layernorm(x, axis=-1)
    s = _A_ref(xn, A_mem0, A_Wq, A_Wk, A_Wv, A_Wo, A_seg_len)
    g = _silu(_B_ref(xn, B_w_gate, B_w_up, B_w_down))
    return x + s * g
```

```asm
; @launch grid=(256,1,1) block=(512,1,1) lds=163840
.amdgcn_target "amdgcn-amd-amdhsa--gfx950"
.text
.globl recurrent_scan__memory_aug_recurrent_mem_tr__swiglu_ffn__prompt_kernel
.p2align 8
.type recurrent_scan__memory_aug_recurrent_mem_tr__swiglu_ffn__prompt_kernel,@function
recurrent_scan__memory_aug_recurrent_mem_tr__swiglu_ffn__prompt_kernel:
    s_cmp_ge_u32 s2, 256
    s_cbranch_scc1 END
    s_load_dwordx8 s[64:71], s[0:1], 0
    s_load_dwordx4 s[72:75], s[0:1], 32
    s_load_dwordx8 s[76:83], s[0:1], 64
    s_load_dwordx4 s[84:87], s[0:1], 96
    v_lshrrev_b32 v1, 6, v0
    v_and_b32 v0, 63, v0
    v_readfirstlane_b32 s26, v1
    s_getreg_b32 s27, hwreg(HW_REG_XCC_ID, 0, 4)
    s_add_u32 s27, s27, 0
    s_xor_b32 s27, s27, 0
    s_and_b32 s27, s27, 7
    s_mov_b32 s30, 200000
    s_mov_b32 s31, 0
    v_lshlrev_b32 v2, 4, v0
    v_lshlrev_b32 v3, 3, v0
    s_waitcnt lgkmcnt(0)
    s_mov_b32 s8, s86
    s_mov_b32 s9, s87
    s_mov_b32 s10, 268435456
    s_mov_b32 s11, 0x00020000
    s_mov_b32 s20, s64
    s_mov_b32 s21, s65
    s_mov_b32 s22, 2621440
    s_mov_b32 s23, 0x00020000
    s_lshr_b32 s28, s2, 3
    s_cmp_lg_u32 s26, 7
    s_cbranch_scc1 ROLE
    s_setprio 3
    s_lshl_b32 s3, s27, 5
    v_mov_b32 v4, s3
    s_lshl_b32 s3, 1, s28
    v_mov_b32 v6, 1
    v_mov_b32 v7, s3
    s_mov_b64 exec, 1
    global_atomic_add_x2 v[10:11], v4, v[6:7], s[84:85] sc0 sc1
    s_mov_b64 exec, -1
ROLE:
    s_mul_i32 s32, s27, 1048576
    s_cmp_ge_u32 s28, 28
    s_cbranch_scc1 PRO_F
    s_cmp_lt_u32 s26, 4
    s_cbranch_scc1 PRO_G
    s_setprio 3
    s_sub_u32 s14, s26, 4
    v_and_b32 v4, 7, v0
    v_mul_u32_u24 v4, 1280, v4
    v_lshrrev_b32 v5, 3, v0
    v_lshlrev_b32 v5, 5, v5
    v_add_u32 v4, v4, v5
    s_cmp_ge_u32 s28, 18
    s_cbranch_scc1 PRO_D
    s_mul_i32 s3, s14, 10240
    v_add_u32 v4, s3, v4
    buffer_load_dwordx4 v[160:163], v4, s[20:23], 0 offen offset:0
    buffer_load_dwordx4 v[164:167], v4, s[20:23], 0 offen offset:16
    buffer_load_dwordx4 v[168:171], v4, s[20:23], 0 offen offset:256
    buffer_load_dwordx4 v[172:175], v4, s[20:23], 0 offen offset:272
    buffer_load_dwordx4 v[176:179], v4, s[20:23], 0 offen offset:512
    buffer_load_dwordx4 v[180:183], v4, s[20:23], 0 offen offset:528
    buffer_load_dwordx4 v[184:187], v4, s[20:23], 0 offen offset:768
    buffer_load_dwordx4 v[188:191], v4, s[20:23], 0 offen offset:784
    buffer_load_dwordx4 v[192:195], v4, s[20:23], 0 offen offset:1024
    buffer_load_dwordx4 v[196:199], v4, s[20:23], 0 offen offset:1040
    v_add_u32 v4, 40960, v4
    buffer_load_dwordx4 v[212:215], v4, s[20:23], 0 offen offset:0
    buffer_load_dwordx4 v[216:219], v4, s[20:23], 0 offen offset:16
    buffer_load_dwordx4 v[220:223], v4, s[20:23], 0 offen offset:256
    buffer_load_dwordx4 v[224:227], v4, s[20:23], 0 offen offset:272
    buffer_load_dwordx4 v[228:231], v4, s[20:23], 0 offen offset:512
    buffer_load_dwordx4 v[232:235], v4, s[20:23], 0 offen offset:528
    buffer_load_dwordx4 v[236:239], v4, s[20:23], 0 offen offset:768
    buffer_load_dwordx4 v[240:243], v4, s[20:23], 0 offen offset:784
    buffer_load_dwordx4 v[244:247], v4, s[20:23], 0 offen offset:1024
    buffer_load_dwordx4 v[248:251], v4, s[20:23], 0 offen offset:1040
    s_mov_b32 s16, s66
    s_mov_b32 s17, s67
    s_mov_b32 s18, 10240
    s_mov_b32 s19, 0x00020000
    v_and_b32 v5, 7, v0
    v_mul_u32_u24 v5, 1280, v5
    v_lshrrev_b32 v6, 3, v0
    v_lshl_add_u32 v5, v6, 4, v5
    s_lshl_b32 s3, s14, 7
    v_add_u32 v5, s3, v5
    buffer_load_dwordx4 v[200:203], v5, s[16:19], 0 offen offset:0
    buffer_load_dwordx4 v[204:207], v5, s[16:19], 0 offen offset:512
    buffer_load_dwordx4 v[208:211], v5, s[16:19], 0 offen offset:1024
    s_cmp_lg_u32 s26, 7
    s_cbranch_scc1 PRO_A1
    s_cmp_lg_u32 s31, 0
    s_cbranch_scc1 PRO_A1
    s_waitcnt vmcnt(23)
    v_readfirstlane_b32 s88, v10
    v_readfirstlane_b32 s3, v11
    s_lshr_b32 s3, s3, s28
    s_and_b32 s3, s3, 1
    s_lshl_b32 s3, s3, 12
    s_cmp_lt_u32 s88, 32
    s_cselect_b32 s89, 1, 4194305
    s_add_u32 s89, s89, s3
    v_mov_b32 v12, 16
    v_mov_b32 v13, s89
    s_mov_b64 exec, 1
    global_atomic_add v14, v12, v13, s[84:85] sc0 sc1
    s_mov_b64 exec, -1
    s_waitcnt vmcnt(14)
    s_branch PRO_A2
PRO_A1:
    s_waitcnt vmcnt(13)
PRO_A2:
    v_lshlrev_b32 v64, 16, v160
    v_and_b32 v65, 0xffff0000, v160
    v_lshlrev_b32 v66, 16, v161
    v_and_b32 v67, 0xffff0000, v161
    v_lshlrev_b32 v68, 16, v162
    v_and_b32 v69, 0xffff0000, v162
    v_lshlrev_b32 v70, 16, v163
    v_and_b32 v71, 0xffff0000, v163
    v_lshlrev_b32 v72, 16, v164
    v_and_b32 v73, 0xffff0000, v164
    v_lshlrev_b32 v74, 16, v165
    v_and_b32 v75, 0xffff0000, v165
    v_lshlrev_b32 v76, 16, v166
    v_and_b32 v77, 0xffff0000, v166
    v_lshlrev_b32 v78, 16, v167
    v_and_b32 v79, 0xffff0000, v167
    v_lshlrev_b32 v80, 16, v168
    v_and_b32 v81, 0xffff0000, v168
    v_lshlrev_b32 v82, 16, v169
    v_and_b32 v83, 0xffff0000, v169
    v_lshlrev_b32 v84, 16, v170
    v_and_b32 v85, 0xffff0000, v170
    v_lshlrev_b32 v86, 16, v171
    v_and_b32 v87, 0xffff0000, v171
    v_lshlrev_b32 v88, 16, v172
    v_and_b32 v89, 0xffff0000, v172
    v_lshlrev_b32 v90, 16, v173
    v_and_b32 v91, 0xffff0000, v173
    v_lshlrev_b32 v92, 16, v174
    v_and_b32 v93, 0xffff0000, v174
    v_lshlrev_b32 v94, 16, v175
    v_and_b32 v95, 0xffff0000, v175
    v_lshlrev_b32 v96, 16, v176
    v_and_b32 v97, 0xffff0000, v176
    v_lshlrev_b32 v98, 16, v177
    v_and_b32 v99, 0xffff0000, v177
    v_lshlrev_b32 v100, 16, v178
    v_and_b32 v101, 0xffff0000, v178
    v_lshlrev_b32 v102, 16, v179
    v_and_b32 v103, 0xffff0000, v179
    v_lshlrev_b32 v104, 16, v180
    v_and_b32 v105, 0xffff0000, v180
    v_lshlrev_b32 v106, 16, v181
    v_and_b32 v107, 0xffff0000, v181
    v_lshlrev_b32 v108, 16, v182
    v_and_b32 v109, 0xffff0000, v182
    v_lshlrev_b32 v110, 16, v183
    v_and_b32 v111, 0xffff0000, v183
    v_lshlrev_b32 v112, 16, v184
    v_and_b32 v113, 0xffff0000, v184
    v_lshlrev_b32 v114, 16, v185
    v_and_b32 v115, 0xffff0000, v185
    v_lshlrev_b32 v116, 16, v186
    v_and_b32 v117, 0xffff0000, v186
    v_lshlrev_b32 v118, 16, v187
    v_and_b32 v119, 0xffff0000, v187
    v_lshlrev_b32 v120, 16, v188
    v_and_b32 v121, 0xffff0000, v188
    v_lshlrev_b32 v122, 16, v189
    v_and_b32 v123, 0xffff0000, v189
    v_lshlrev_b32 v124, 16, v190
    v_and_b32 v125, 0xffff0000, v190
    v_lshlrev_b32 v126, 16, v191
    v_and_b32 v127, 0xffff0000, v191
    v_lshlrev_b32 v128, 16, v192
    v_and_b32 v129, 0xffff0000, v192
    v_lshlrev_b32 v130, 16, v193
    v_and_b32 v131, 0xffff0000, v193
    v_lshlrev_b32 v132, 16, v194
    v_and_b32 v133, 0xffff0000, v194
    v_lshlrev_b32 v134, 16, v195
    v_and_b32 v135, 0xffff0000, v195
    v_lshlrev_b32 v136, 16, v196
    v_and_b32 v137, 0xffff0000, v196
    v_lshlrev_b32 v138, 16, v197
    v_and_b32 v139, 0xffff0000, v197
    v_lshlrev_b32 v140, 16, v198
    v_and_b32 v141, 0xffff0000, v198
    v_lshlrev_b32 v142, 16, v199
    v_and_b32 v143, 0xffff0000, v199
    v_pk_add_f32 v[144:145], v[64:65], v[66:67]
    v_pk_add_f32 v[146:147], v[68:69], v[70:71]
    v_pk_add_f32 v[144:145], v[144:145], v[72:73]
    v_pk_add_f32 v[146:147], v[146:147], v[74:75]
    v_pk_add_f32 v[144:145], v[144:145], v[76:77]
    v_pk_add_f32 v[146:147], v[146:147], v[78:79]
    v_pk_add_f32 v[144:145], v[144:145], v[80:81]
    v_pk_add_f32 v[146:147], v[146:147], v[82:83]
    v_pk_add_f32 v[144:145], v[144:145], v[84:85]
    v_pk_add_f32 v[146:147], v[146:147], v[86:87]
    v_pk_add_f32 v[144:145], v[144:145], v[88:89]
    v_pk_add_f32 v[146:147], v[146:147], v[90:91]
    v_pk_add_f32 v[144:145], v[144:145], v[92:93]
    v_pk_add_f32 v[146:147], v[146:147], v[94:95]
    v_pk_add_f32 v[144:145], v[144:145], v[96:97]
    v_pk_add_f32 v[146:147], v[146:147], v[98:99]
    v_pk_add_f32 v[144:145], v[144:145], v[100:101]
    v_pk_add_f32 v[146:147], v[146:147], v[102:103]
    v_pk_add_f32 v[144:145], v[144:145], v[104:105]
    v_pk_add_f32 v[146:147], v[146:147], v[106:107]
    v_pk_add_f32 v[144:145], v[144:145], v[108:109]
    v_pk_add_f32 v[146:147], v[146:147], v[110:111]
    v_pk_add_f32 v[144:145], v[144:145], v[112:113]
    v_pk_add_f32 v[146:147], v[146:147], v[114:115]
    v_pk_add_f32 v[144:145], v[144:145], v[116:117]
    v_pk_add_f32 v[146:147], v[146:147], v[118:119]
    v_pk_add_f32 v[144:145], v[144:145], v[120:121]
    v_pk_add_f32 v[146:147], v[146:147], v[122:123]
    v_pk_add_f32 v[144:145], v[144:145], v[124:125]
    v_pk_add_f32 v[146:147], v[146:147], v[126:127]
    v_pk_add_f32 v[144:145], v[144:145], v[128:129]
    v_pk_add_f32 v[146:147], v[146:147], v[130:131]
    v_pk_add_f32 v[144:145], v[144:145], v[132:133]
    v_pk_add_f32 v[146:147], v[146:147], v[134:135]
    v_pk_add_f32 v[144:145], v[144:145], v[136:137]
    v_pk_add_f32 v[146:147], v[146:147], v[138:139]
    v_pk_add_f32 v[144:145], v[144:145], v[140:141]
    v_pk_add_f32 v[146:147], v[146:147], v[142:143]
    v_pk_add_f32 v[144:145], v[144:145], v[146:147]
    v_add_f32 v144, v144, v145
    s_nop 1
    v_add_f32_dpp v144, v144, v144 row_ror:8 row_mask:0xf bank_mask:0xf
    v_mov_b32 v145, v144
    s_nop 1
    v_permlane16_swap_b32 v144, v145
    v_add_f32 v144, v144, v145
    v_mov_b32 v145, v144
    s_nop 1
    v_permlane32_swap_b32 v144, v145
    v_add_f32 v144, v144, v145
    v_mul_f32 v144, 0x3acccccd, v144
    v_pk_add_f32 v[146:147], v[64:65], v[144:145] op_sel_hi:[1,0] neg_lo:[0,1] neg_hi:[0,1]
    s_nop 0
    v_pk_mul_f32 v[150:151], v[146:147], v[146:147]
    v_pk_add_f32 v[148:149], v[66:67], v[144:145] op_sel_hi:[1,0] neg_lo:[0,1] neg_hi:[0,1]
    s_nop 0
    v_pk_mul_f32 v[152:153], v[148:149], v[148:149]
    v_pk_add_f32 v[146:147], v[68:69], v[144:145] op_sel_hi:[1,0] neg_lo:[0,1] neg_hi:[0,1]
    s_nop 0
    v_pk_fma_f32 v[150:151], v[146:147], v[146:147], v[150:151]
    v_pk_add_f32 v[148:149], v[70:71], v[144:145] op_sel_hi:[1,0] neg_lo:[0,1] neg_hi:[0,1]
    s_nop 0
    v_pk_fma_f32 v[152:153], v[148:149], v[148:149], v[152:153]
    v_pk_add_f32 v[146:147], v[72:73], v[144:145] op_sel_hi:[1,0] neg_lo:[0,1] neg_hi:[0,1]
    s_nop 0
    v_pk_fma_f32 v[150:151], v[146:147], v[146:147], v[150:151]
    v_pk_add_f32 v[148:149], v[74:75], v[144:145] op_sel_hi:[1,0] neg_lo:[0,1] neg_hi:[0,1]
    s_nop 0
    v_pk_fma_f32 v[152:153], v[148:149], v[148:149], v[152:153]
    v_pk_add_f32 v[146:147], v[76:77], v[144:145] op_sel_hi:[1,0] neg_lo:[0,1] neg_hi:[0,1]
    s_nop 0
    v_pk_fma_f32 v[150:151], v[146:147], v[146:147], v[150:151]
    v_pk_add_f32 v[148:149], v[78:79], v[144:145] op_sel_hi:[1,0] neg_lo:[0,1] neg_hi:[0,1]
    s_nop 0
    v_pk_fma_f32 v[152:153], v[148:149], v[148:149], v[152:153]
    v_pk_add_f32 v[146:147], v[80:81], v[144:145] op_sel_hi:[1,0] neg_lo:[0,1] neg_hi:[0,1]
    s_nop 0
    v_pk_fma_f32 v[150:151], v[146:147], v[146:147], v[150:151]
    v_pk_add_f32 v[148:149], v[82:83], v[144:145] op_sel_hi:[1,0] neg_lo:[0,1] neg_hi:[0,1]
    s_nop 0
    v_pk_fma_f32 v[152:153], v[148:149], v[148:149], v[152:153]
    v_pk_add_f32 v[146:147], v[84:85], v[144:145] op_sel_hi:[1,0] neg_lo:[0,1] neg_hi:[0,1]
    s_nop 0
    v_pk_fma_f32 v[150:151], v[146:147], v[146:147], v[150:151]
    v_pk_add_f32 v[148:149], v[86:87], v[144:145] op_sel_hi:[1,0] neg_lo:[0,1] neg_hi:[0,1]
    s_nop 0
    v_pk_fma_f32 v[152:153], v[148:149], v[148:149], v[152:153]
    v_pk_add_f32 v[146:147], v[88:89], v[144:145] op_sel_hi:[1,0] neg_lo:[0,1] neg_hi:[0,1]
    s_nop 0
    v_pk_fma_f32 v[150:151], v[146:147], v[146:147], v[150:151]
    v_pk_add_f32 v[148:149], v[90:91], v[144:145] op_sel_hi:[1,0] neg_lo:[0,1] neg_hi:[0,1]
    s_nop 0
    v_pk_fma_f32 v[152:153], v[148:149], v[148:149], v[152:153]
    v_pk_add_f32 v[146:147], v[92:93], v[144:145] op_sel_hi:[1,0] neg_lo:[0,1] neg_hi:[0,1]
    s_nop 0
    v_pk_fma_f32 v[150:151], v[146:147], v[146:147], v[150:151]
    v_pk_add_f32 v[148:149], v[94:95], v[144:145] op_sel_hi:[1,0] neg_lo:[0,1] neg_hi:[0,1]
    s_nop 0
    v_pk_fma_f32 v[152:153], v[148:149], v[148:149], v[152:153]
    v_pk_add_f32 v[146:147], v[96:97], v[144:145] op_sel_hi:[1,0] neg_lo:[0,1] neg_hi:[0,1]
    s_nop 0
    v_pk_fma_f32 v[150:151], v[146:147], v[146:147], v[150:151]
    v_pk_add_f32 v[148:149], v[98:99], v[144:145] op_sel_hi:[1,0] neg_lo:[0,1] neg_hi:[0,1]
    s_nop 0
    v_pk_fma_f32 v[152:153], v[148:149], v[148:149], v[152:153]
    v_pk_add_f32 v[146:147], v[100:101], v[144:145] op_sel_hi:[1,0] neg_lo:[0,1] neg_hi:[0,1]
    s_nop 0
    v_pk_fma_f32 v[150:151], v[146:147], v[146:147], v[150:151]
    v_pk_add_f32 v[148:149], v[102:103], v[144:145] op_sel_hi:[1,0] neg_lo:[0,1] neg_hi:[0,1]
    s_nop 0
    v_pk_fma_f32 v[152:153], v[148:149], v[148:149], v[152:153]
    v_pk_add_f32 v[146:147], v[104:105], v[144:145] op_sel_hi:[1,0] neg_lo:[0,1] neg_hi:[0,1]
    s_nop 0
    v_pk_fma_f32 v[150:151], v[146:147], v[146:147], v[150:151]
    v_pk_add_f32 v[148:149], v[106:107], v[144:145] op_sel_hi:[1,0] neg_lo:[0,1] neg_hi:[0,1]
    s_nop 0
    v_pk_fma_f32 v[152:153], v[148:149], v[148:149], v[152:153]
    v_pk_add_f32 v[146:147], v[108:109], v[144:145] op_sel_hi:[1,0] neg_lo:[0,1] neg_hi:[0,1]
    s_nop 0
    v_pk_fma_f32 v[150:151], v[146:147], v[146:147], v[150:151]
    v_pk_add_f32 v[148:149], v[110:111], v[144:145] op_sel_hi:[1,0] neg_lo:[0,1] neg_hi:[0,1]
    s_nop 0
    v_pk_fma_f32 v[152:153], v[148:149], v[148:149], v[152:153]
    v_pk_add_f32 v[146:147], v[112:113], v[144:145] op_sel_hi:[1,0] neg_lo:[0,1] neg_hi:[0,1]
    s_nop 0
    v_pk_fma_f32 v[150:151], v[146:147], v[146:147], v[150:151]
    v_pk_add_f32 v[148:149], v[114:115], v[144:145] op_sel_hi:[1,0] neg_lo:[0,1] neg_hi:[0,1]
    s_nop 0
    v_pk_fma_f32 v[152:153], v[148:149], v[148:149], v[152:153]
    v_pk_add_f32 v[146:147], v[116:117], v[144:145] op_sel_hi:[1,0] neg_lo:[0,1] neg_hi:[0,1]
    s_nop 0
    v_pk_fma_f32 v[150:151], v[146:147], v[146:147], v[150:151]
    v_pk_add_f32 v[148:149], v[118:119], v[144:145] op_sel_hi:[1,0] neg_lo:[0,1] neg_hi:[0,1]
    s_nop 0
    v_pk_fma_f32 v[152:153], v[148:149], v[148:149], v[152:153]
    v_pk_add_f32 v[146:147], v[120:121], v[144:145] op_sel_hi:[1,0] neg_lo:[0,1] neg_hi:[0,1]
    s_nop 0
    v_pk_fma_f32 v[150:151], v[146:147], v[146:147], v[150:151]
    v_pk_add_f32 v[148:149], v[122:123], v[144:145] op_sel_hi:[1,0] neg_lo:[0,1] neg_hi:[0,1]
    s_nop 0
    v_pk_fma_f32 v[152:153], v[148:149], v[148:149], v[152:153]
    v_pk_add_f32 v[146:147], v[124:125], v[144:145] op_sel_hi:[1,0] neg_lo:[0,1] neg_hi:[0,1]
    s_nop 0
    v_pk_fma_f32 v[150:151], v[146:147], v[146:147], v[150:151]
    v_pk_add_f32 v[148:149], v[126:127], v[144:145] op_sel_hi:[1,0] neg_lo:[0,1] neg_hi:[0,1]
    s_nop 0
    v_pk_fma_f32 v[152:153], v[148:149], v[148:149], v[152:153]
    v_pk_add_f32 v[146:147], v[128:129], v[144:145] op_sel_hi:[1,0] neg_lo:[0,1] neg_hi:[0,1]
    s_nop 0
    v_pk_fma_f32 v[150:151], v[146:147], v[146:147], v[150:151]
    v_pk_add_f32 v[148:149], v[130:131], v[144:145] op_sel_hi:[1,0] neg_lo:[0,1] neg_hi:[0,1]
    s_nop 0
    v_pk_fma_f32 v[152:153], v[148:149], v[148:149], v[152:153]
    v_pk_add_f32 v[146:147], v[132:133], v[144:145] op_sel_hi:[1,0] neg_lo:[0,1] neg_hi:[0,1]
    s_nop 0
    v_pk_fma_f32 v[150:151], v[146:147], v[146:147], v[150:151]
    v_pk_add_f32 v[148:149], v[134:135], v[144:145] op_sel_hi:[1,0] neg_lo:[0,1] neg_hi:[0,1]
    s_nop 0
    v_pk_fma_f32 v[152:153], v[148:149], v[148:149], v[152:153]
    v_pk_add_f32 v[146:147], v[136:137], v[144:145] op_sel_hi:[1,0] neg_lo:[0,1] neg_hi:[0,1]
    s_nop 0
    v_pk_fma_f32 v[150:151], v[146:147], v[146:147], v[150:151]
    v_pk_add_f32 v[148:149], v[138:139], v[144:145] op_sel_hi:[1,0] neg_lo:[0,1] neg_hi:[0,1]
    s_nop 0
    v_pk_fma_f32 v[152:153], v[148:149], v[148:149], v[152:153]
    v_pk_add_f32 v[146:147], v[140:141], v[144:145] op_sel_hi:[1,0] neg_lo:[0,1] neg_hi:[0,1]
    s_nop 0
    v_pk_fma_f32 v[150:151], v[146:147], v[146:147], v[150:151]
    v_pk_add_f32 v[148:149], v[142:143], v[144:145] op_sel_hi:[1,0] neg_lo:[0,1] neg_hi:[0,1]
    s_nop 0
    v_pk_fma_f32 v[152:153], v[148:149], v[148:149], v[152:153]
    v_pk_add_f32 v[150:151], v[150:151], v[152:153]
    v_add_f32 v146, v150, v151
    s_nop 1
    v_add_f32_dpp v146, v146, v146 row_ror:8 row_mask:0xf bank_mask:0xf
    v_mov_b32 v147, v146
    s_nop 1
    v_permlane16_swap_b32 v146, v147
    v_add_f32 v146, v146, v147
    v_mov_b32 v147, v146
    s_nop 1
    v_permlane32_swap_b32 v146, v147
    v_add_f32 v146, v146, v147
    v_mul_f32 v146, 0x3acccccd, v146
    v_cvt_pk_bf16_f32 v146, v146, v146
    v_lshlrev_b32 v146, 16, v146
    v_add_f32 v146, 0x3727c5ac, v146
    v_cvt_pk_bf16_f32 v146, v146, v146
    v_lshlrev_b32 v146, 16, v146
    v_sqrt_f32 v146, v146
    s_nop 0
    v_cvt_pk_bf16_f32 v146, v146, v146
    v_lshlrev_b32 v146, 16, v146
    v_rcp_f32 v146, v146
    v_cvt_pk_bf16_f32 v144, v144, v144
    v_lshlrev_b32 v144, 16, v144
    v_pk_add_f32 v[148:149], v[64:65], v[144:145] op_sel_hi:[1,0] neg_lo:[0,1] neg_hi:[0,1]
    s_nop 0
    v_cvt_pk_bf16_f32 v148, v148, v149
    v_and_b32 v149, 0xffff0000, v148
    v_lshlrev_b32 v148, 16, v148
    v_pk_mul_f32 v[148:149], v[148:149], v[146:147] op_sel_hi:[1,0]
    s_nop 0
    v_cvt_pk_bf16_f32 v160, v148, v149
    v_pk_add_f32 v[150:151], v[66:67], v[144:145] op_sel_hi:[1,0] neg_lo:[0,1] neg_hi:[0,1]
    s_nop 0
    v_cvt_pk_bf16_f32 v150, v150, v151
    v_and_b32 v151, 0xffff0000, v150
    v_lshlrev_b32 v150, 16, v150
    v_pk_mul_f32 v[150:151], v[150:151], v[146:147] op_sel_hi:[1,0]
    s_nop 0
    v_cvt_pk_bf16_f32 v162, v150, v151
    v_pk_add_f32 v[148:149], v[68:69], v[144:145] op_sel_hi:[1,0] neg_lo:[0,1] neg_hi:[0,1]
    s_nop 0
    v_cvt_pk_bf16_f32 v148, v148, v149
    v_and_b32 v149, 0xffff0000, v148
    v_lshlrev_b32 v148, 16, v148
    v_pk_mul_f32 v[148:149], v[148:149], v[146:147] op_sel_hi:[1,0]
    s_nop 0
    v_cvt_pk_bf16_f32 v164, v148, v149
    v_pk_add_f32 v[150:151], v[70:71], v[144:145] op_sel_hi:[1,0] neg_lo:[0,1] neg_hi:[0,1]
    s_nop 0
    v_cvt_pk_bf16_f32 v150, v150, v151
    v_and_b32 v151, 0xffff0000, v150
    v_lshlrev_b32 v150, 16, v150
    v_pk_mul_f32 v[150:151], v[150:151], v[146:147] op_sel_hi:[1,0]
    s_nop 0
    v_cvt_pk_bf16_f32 v166, v150, v151
    v_pk_add_f32 v[148:149], v[72:73], v[144:145] op_sel_hi:[1,0] neg_lo:[0,1] neg_hi:[0,1]
    s_nop 0
    v_cvt_pk_bf16_f32 v148, v148, v149
    v_and_b32 v149, 0xffff0000, v148
    v_lshlrev_b32 v148, 16, v148
    v_pk_mul_f32 v[148:149], v[148:149], v[146:147] op_sel_hi:[1,0]
    s_nop 0
    v_cvt_pk_bf16_f32 v161, v148, v149
    v_pk_add_f32 v[150:151], v[74:75], v[144:145] op_sel_hi:[1,0] neg_lo:[0,1] neg_hi:[0,1]
    s_nop 0
    v_cvt_pk_bf16_f32 v150, v150, v151
    v_and_b32 v151, 0xffff0000, v150
    v_lshlrev_b32 v150, 16, v150
    v_pk_mul_f32 v[150:151], v[150:151], v[146:147] op_sel_hi:[1,0]
    s_nop 0
    v_cvt_pk_bf16_f32 v163, v150, v151
    v_pk_add_f32 v[148:149], v[76:77], v[144:145] op_sel_hi:[1,0] neg_lo:[0,1] neg_hi:[0,1]
    s_nop 0
    v_cvt_pk_bf16_f32 v148, v148, v149
    v_and_b32 v149, 0xffff0000, v148
    v_lshlrev_b32 v148, 16, v148
    v_pk_mul_f32 v[148:149], v[148:149], v[146:147] op_sel_hi:[1,0]
    s_nop 0
    v_cvt_pk_bf16_f32 v165, v148, v149
    v_pk_add_f32 v[150:151], v[78:79], v[144:145] op_sel_hi:[1,0] neg_lo:[0,1] neg_hi:[0,1]
    s_nop 0
    v_cvt_pk_bf16_f32 v150, v150, v151
    v_and_b32 v151, 0xffff0000, v150
    v_lshlrev_b32 v150, 16, v150
    v_pk_mul_f32 v[150:151], v[150:151], v[146:147] op_sel_hi:[1,0]
    s_nop 0
    v_cvt_pk_bf16_f32 v167, v150, v151
    v_pk_add_f32 v[148:149], v[80:81], v[144:145] op_sel_hi:[1,0] neg_lo:[0,1] neg_hi:[0,1]
    s_nop 0
    v_cvt_pk_bf16_f32 v148, v148, v149
    v_and_b32 v149, 0xffff0000, v148
    v_lshlrev_b32 v148, 16, v148
    v_pk_mul_f32 v[148:149], v[148:149], v[146:147] op_sel_hi:[1,0]
    s_nop 0
    v_cvt_pk_bf16_f32 v168, v148, v149
    v_pk_add_f32 v[150:151], v[82:83], v[144:145] op_sel_hi:[1,0] neg_lo:[0,1] neg_hi:[0,1]
    s_nop 0
    v_cvt_pk_bf16_f32 v150, v150, v151
    v_and_b32 v151, 0xffff0000, v150
    v_lshlrev_b32 v150, 16, v150
    v_pk_mul_f32 v[150:151], v[150:151], v[146:147] op_sel_hi:[1,0]
    s_nop 0
    v_cvt_pk_bf16_f32 v170, v150, v151
    v_pk_add_f32 v[148:149], v[84:85], v[144:145] op_sel_hi:[1,0] neg_lo:[0,1] neg_hi:[0,1]
    s_nop 0
    v_cvt_pk_bf16_f32 v148, v148, v149
    v_and_b32 v149, 0xffff0000, v148
    v_lshlrev_b32 v148, 16, v148
    v_pk_mul_f32 v[148:149], v[148:149], v[146:147] op_sel_hi:[1,0]
    s_nop 0
    v_cvt_pk_bf16_f32 v172, v148, v149
    v_pk_add_f32 v[150:151], v[86:87], v[144:145] op_sel_hi:[1,0] neg_lo:[0,1] neg_hi:[0,1]
    s_nop 0
    v_cvt_pk_bf16_f32 v150, v150, v151
    v_and_b32 v151, 0xffff0000, v150
    v_lshlrev_b32 v150, 16, v150
    v_pk_mul_f32 v[150:151], v[150:151], v[146:147] op_sel_hi:[1,0]
    s_nop 0
    v_cvt_pk_bf16_f32 v174, v150, v151
    v_pk_add_f32 v[148:149], v[88:89], v[144:145] op_sel_hi:[1,0] neg_lo:[0,1] neg_hi:[0,1]
    s_nop 0
    v_cvt_pk_bf16_f32 v148, v148, v149
    v_and_b32 v149, 0xffff0000, v148
    v_lshlrev_b32 v148, 16, v148
    v_pk_mul_f32 v[148:149], v[148:149], v[146:147] op_sel_hi:[1,0]
    s_nop 0
    v_cvt_pk_bf16_f32 v169, v148, v149
    v_pk_add_f32 v[150:151], v[90:91], v[144:145] op_sel_hi:[1,0] neg_lo:[0,1] neg_hi:[0,1]
    s_nop 0
    v_cvt_pk_bf16_f32 v150, v150, v151
    v_and_b32 v151, 0xffff0000, v150
    v_lshlrev_b32 v150, 16, v150
    v_pk_mul_f32 v[150:151], v[150:151], v[146:147] op_sel_hi:[1,0]
    s_nop 0
    v_cvt_pk_bf16_f32 v171, v150, v151
    v_pk_add_f32 v[148:149], v[92:93], v[144:145] op_sel_hi:[1,0] neg_lo:[0,1] neg_hi:[0,1]
    s_nop 0
    v_cvt_pk_bf16_f32 v148, v148, v149
    v_and_b32 v149, 0xffff0000, v148
    v_lshlrev_b32 v148, 16, v148
    v_pk_mul_f32 v[148:149], v[148:149], v[146:147] op_sel_hi:[1,0]
    s_nop 0
    v_cvt_pk_bf16_f32 v173, v148, v149
    v_pk_add_f32 v[150:151], v[94:95], v[144:145] op_sel_hi:[1,0] neg_lo:[0,1] neg_hi:[0,1]
    s_nop 0
    v_cvt_pk_bf16_f32 v150, v150, v151
    v_and_b32 v151, 0xffff0000, v150
    v_lshlrev_b32 v150, 16, v150
    v_pk_mul_f32 v[150:151], v[150:151], v[146:147] op_sel_hi:[1,0]
    s_nop 0
    v_cvt_pk_bf16_f32 v175, v150, v151
    v_pk_add_f32 v[148:149], v[96:97], v[144:145] op_sel_hi:[1,0] neg_lo:[0,1] neg_hi:[0,1]
    s_nop 0
    v_cvt_pk_bf16_f32 v148, v148, v149
    v_and_b32 v149, 0xffff0000, v148
    v_lshlrev_b32 v148, 16, v148
    v_pk_mul_f32 v[148:149], v[148:149], v[146:147] op_sel_hi:[1,0]
    s_nop 0
    v_cvt_pk_bf16_f32 v176, v148, v149
    v_pk_add_f32 v[150:151], v[98:99], v[144:145] op_sel_hi:[1,0] neg_lo:[0,1] neg_hi:[0,1]
    s_nop 0
    v_cvt_pk_bf16_f32 v150, v150, v151
    v_and_b32 v151, 0xffff0000, v150
    v_lshlrev_b32 v150, 16, v150
    v_pk_mul_f32 v[150:151], v[150:151], v[146:147] op_sel_hi:[1,0]
    s_nop 0
    v_cvt_pk_bf16_f32 v178, v150, v151
    v_pk_add_f32 v[148:149], v[100:101], v[144:145] op_sel_hi:[1,0] neg_lo:[0,1] neg_hi:[0,1]
    s_nop 0
    v_cvt_pk_bf16_f32 v148, v148, v149
    v_and_b32 v149, 0xffff0000, v148
    v_lshlrev_b32 v148, 16, v148
    v_pk_mul_f32 v[148:149], v[148:149], v[146:147] op_sel_hi:[1,0]
    s_nop 0
    v_cvt_pk_bf16_f32 v180, v148, v149
    v_pk_add_f32 v[150:151], v[102:103], v[144:145] op_sel_hi:[1,0] neg_lo:[0,1] neg_hi:[0,1]
    s_nop 0
    v_cvt_pk_bf16_f32 v150, v150, v151
    v_and_b32 v151, 0xffff0000, v150
    v_lshlrev_b32 v150, 16, v150
    v_pk_mul_f32 v[150:151], v[150:151], v[146:147] op_sel_hi:[1,0]
    s_nop 0
    v_cvt_pk_bf16_f32 v182, v150, v151
    v_pk_add_f32 v[148:149], v[104:105], v[144:145] op_sel_hi:[1,0] neg_lo:[0,1] neg_hi:[0,1]
    s_nop 0
    v_cvt_pk_bf16_f32 v148, v148, v149
    v_and_b32 v149, 0xffff0000, v148
    v_lshlrev_b32 v148, 16, v148
    v_pk_mul_f32 v[148:149], v[148:149], v[146:147] op_sel_hi:[1,0]
    s_nop 0
    v_cvt_pk_bf16_f32 v177, v148, v149
    v_pk_add_f32 v[150:151], v[106:107], v[144:145] op_sel_hi:[1,0] neg_lo:[0,1] neg_hi:[0,1]
    s_nop 0
    v_cvt_pk_bf16_f32 v150, v150, v151
    v_and_b32 v151, 0xffff0000, v150
    v_lshlrev_b32 v150, 16, v150
    v_pk_mul_f32 v[150:151], v[150:151], v[146:147] op_sel_hi:[1,0]
    s_nop 0
    v_cvt_pk_bf16_f32 v179, v150, v151
    v_pk_add_f32 v[148:149], v[108:109], v[144:145] op_sel_hi:[1,0] neg_lo:[0,1] neg_hi:[0,1]
    s_nop 0
    v_cvt_pk_bf16_f32 v148, v148, v149
    v_and_b32 v149, 0xffff0000, v148
    v_lshlrev_b32 v148, 16, v148
    v_pk_mul_f32 v[148:149], v[148:149], v[146:147] op_sel_hi:[1,0]
    s_nop 0
    v_cvt_pk_bf16_f32 v181, v148, v149
    v_pk_add_f32 v[150:151], v[110:111], v[144:145] op_sel_hi:[1,0] neg_lo:[0,1] neg_hi:[0,1]
    s_nop 0
    v_cvt_pk_bf16_f32 v150, v150, v151
    v_and_b32 v151, 0xffff0000, v150
    v_lshlrev_b32 v150, 16, v150
    v_pk_mul_f32 v[150:151], v[150:151], v[146:147] op_sel_hi:[1,0]
    s_nop 0
    v_cvt_pk_bf16_f32 v183, v150, v151
    v_pk_add_f32 v[148:149], v[112:113], v[144:145] op_sel_hi:[1,0] neg_lo:[0,1] neg_hi:[0,1]
    s_nop 0
    v_cvt_pk_bf16_f32 v148, v148, v149
    v_and_b32 v149, 0xffff0000, v148
    v_lshlrev_b32 v148, 16, v148
    v_pk_mul_f32 v[148:149], v[148:149], v[146:147] op_sel_hi:[1,0]
    s_nop 0
    v_cvt_pk_bf16_f32 v184, v148, v149
    v_pk_add_f32 v[150:151], v[114:115], v[144:145] op_sel_hi:[1,0] neg_lo:[0,1] neg_hi:[0,1]
    s_nop 0
    v_cvt_pk_bf16_f32 v150, v150, v151
    v_and_b32 v151, 0xffff0000, v150
    v_lshlrev_b32 v150, 16, v150
    v_pk_mul_f32 v[150:151], v[150:151], v[146:147] op_sel_hi:[1,0]
    s_nop 0
    v_cvt_pk_bf16_f32 v186, v150, v151
    v_pk_add_f32 v[148:149], v[116:117], v[144:145] op_sel_hi:[1,0] neg_lo:[0,1] neg_hi:[0,1]
    s_nop 0
    v_cvt_pk_bf16_f32 v148, v148, v149
    v_and_b32 v149, 0xffff0000, v148
    v_lshlrev_b32 v148, 16, v148
    v_pk_mul_f32 v[148:149], v[148:149], v[146:147] op_sel_hi:[1,0]
    s_nop 0
    v_cvt_pk_bf16_f32 v188, v148, v149
    v_pk_add_f32 v[150:151], v[118:119], v[144:145] op_sel_hi:[1,0] neg_lo:[0,1] neg_hi:[0,1]
    s_nop 0
    v_cvt_pk_bf16_f32 v150, v150, v151
    v_and_b32 v151, 0xffff0000, v150
    v_lshlrev_b32 v150, 16, v150
    v_pk_mul_f32 v[150:151], v[150:151], v[146:147] op_sel_hi:[1,0]
    s_nop 0
    v_cvt_pk_bf16_f32 v190, v150, v151
    v_pk_add_f32 v[148:149], v[120:121], v[144:145] op_sel_hi:[1,0] neg_lo:[0,1] neg_hi:[0,1]
    s_nop 0
    v_cvt_pk_bf16_f32 v148, v148, v149
    v_and_b32 v149, 0xffff0000, v148
    v_lshlrev_b32 v148, 16, v148
    v_pk_mul_f32 v[148:149], v[148:149], v[146:147] op_sel_hi:[1,0]
    s_nop 0
    v_cvt_pk_bf16_f32 v185, v148, v149
    v_pk_add_f32 v[150:151], v[122:123], v[144:145] op_sel_hi:[1,0] neg_lo:[0,1] neg_hi:[0,1]
    s_nop 0
    v_cvt_pk_bf16_f32 v150, v150, v151
    v_and_b32 v151, 0xffff0000, v150
    v_lshlrev_b32 v150, 16, v150
    v_pk_mul_f32 v[150:151], v[150:151], v[146:147] op_sel_hi:[1,0]
    s_nop 0
    v_cvt_pk_bf16_f32 v187, v150, v151
    v_pk_add_f32 v[148:149], v[124:125], v[144:145] op_sel_hi:[1,0] neg_lo:[0,1] neg_hi:[0,1]
    s_nop 0
    v_cvt_pk_bf16_f32 v148, v148, v149
    v_and_b32 v149, 0xffff0000, v148
    v_lshlrev_b32 v148, 16, v148
    v_pk_mul_f32 v[148:149], v[148:149], v[146:147] op_sel_hi:[1,0]
    s_nop 0
    v_cvt_pk_bf16_f32 v189, v148, v149
    v_pk_add_f32 v[150:151], v[126:127], v[144:145] op_sel_hi:[1,0] neg_lo:[0,1] neg_hi:[0,1]
    s_nop 0
    v_cvt_pk_bf16_f32 v150, v150, v151
    v_and_b32 v151, 0xffff0000, v150
    v_lshlrev_b32 v150, 16, v150
    v_pk_mul_f32 v[150:151], v[150:151], v[146:147] op_sel_hi:[1,0]
    s_nop 0
    v_cvt_pk_bf16_f32 v191, v150, v151
    v_pk_add_f32 v[148:149], v[128:129], v[144:145] op_sel_hi:[1,0] neg_lo:[0,1] neg_hi:[0,1]
    s_nop 0
    v_cvt_pk_bf16_f32 v148, v148, v149
    v_and_b32 v149, 0xffff0000, v148
    v_lshlrev_b32 v148, 16, v148
    v_pk_mul_f32 v[148:149], v[148:149], v[146:147] op_sel_hi:[1,0]
    s_nop 0
    v_cvt_pk_bf16_f32 v192, v148, v149
    v_pk_add_f32 v[150:151], v[130:131], v[144:145] op_sel_hi:[1,0] neg_lo:[0,1] neg_hi:[0,1]
    s_nop 0
    v_cvt_pk_bf16_f32 v150, v150, v151
    v_and_b32 v151, 0xffff0000, v150
    v_lshlrev_b32 v150, 16, v150
    v_pk_mul_f32 v[150:151], v[150:151], v[146:147] op_sel_hi:[1,0]
    s_nop 0
    v_cvt_pk_bf16_f32 v194, v150, v151
    v_pk_add_f32 v[148:149], v[132:133], v[144:145] op_sel_hi:[1,0] neg_lo:[0,1] neg_hi:[0,1]
    s_nop 0
    v_cvt_pk_bf16_f32 v148, v148, v149
    v_and_b32 v149, 0xffff0000, v148
    v_lshlrev_b32 v148, 16, v148
    v_pk_mul_f32 v[148:149], v[148:149], v[146:147] op_sel_hi:[1,0]
    s_nop 0
    v_cvt_pk_bf16_f32 v196, v148, v149
    v_pk_add_f32 v[150:151], v[134:135], v[144:145] op_sel_hi:[1,0] neg_lo:[0,1] neg_hi:[0,1]
    s_nop 0
    v_cvt_pk_bf16_f32 v150, v150, v151
    v_and_b32 v151, 0xffff0000, v150
    v_lshlrev_b32 v150, 16, v150
    v_pk_mul_f32 v[150:151], v[150:151], v[146:147] op_sel_hi:[1,0]
    s_nop 0
    v_cvt_pk_bf16_f32 v198, v150, v151
    v_pk_add_f32 v[148:149], v[136:137], v[144:145] op_sel_hi:[1,0] neg_lo:[0,1] neg_hi:[0,1]
    s_nop 0
    v_cvt_pk_bf16_f32 v148, v148, v149
    v_and_b32 v149, 0xffff0000, v148
    v_lshlrev_b32 v148, 16, v148
    v_pk_mul_f32 v[148:149], v[148:149], v[146:147] op_sel_hi:[1,0]
    s_nop 0
    v_cvt_pk_bf16_f32 v193, v148, v149
    v_pk_add_f32 v[150:151], v[138:139], v[144:145] op_sel_hi:[1,0] neg_lo:[0,1] neg_hi:[0,1]
    s_nop 0
    v_cvt_pk_bf16_f32 v150, v150, v151
    v_and_b32 v151, 0xffff0000, v150
    v_lshlrev_b32 v150, 16, v150
    v_pk_mul_f32 v[150:151], v[150:151], v[146:147] op_sel_hi:[1,0]
    s_nop 0
    v_cvt_pk_bf16_f32 v195, v150, v151
    v_pk_add_f32 v[148:149], v[140:141], v[144:145] op_sel_hi:[1,0] neg_lo:[0,1] neg_hi:[0,1]
    s_nop 0
    v_cvt_pk_bf16_f32 v148, v148, v149
    v_and_b32 v149, 0xffff0000, v148
    v_lshlrev_b32 v148, 16, v148
    v_pk_mul_f32 v[148:149], v[148:149], v[146:147] op_sel_hi:[1,0]
    s_nop 0
    v_cvt_pk_bf16_f32 v197, v148, v149
    v_pk_add_f32 v[150:151], v[142:143], v[144:145] op_sel_hi:[1,0] neg_lo:[0,1] neg_hi:[0,1]
    s_nop 0
    v_cvt_pk_bf16_f32 v150, v150, v151
    v_and_b32 v151, 0xffff0000, v150
    v_lshlrev_b32 v150, 16, v150
    v_pk_mul_f32 v[150:151], v[150:151], v[146:147] op_sel_hi:[1,0]
    s_nop 0
    v_cvt_pk_bf16_f32 v199, v150, v151
    s_waitcnt vmcnt(1)
    v_lshlrev_b32 v64, 16, v212
    v_and_b32 v65, 0xffff0000, v212
    v_lshlrev_b32 v66, 16, v213
    v_and_b32 v67, 0xffff0000, v213
    v_lshlrev_b32 v68, 16, v214
    v_and_b32 v69, 0xffff0000, v214
    v_lshlrev_b32 v70, 16, v215
    v_and_b32 v71, 0xffff0000, v215
    v_lshlrev_b32 v72, 16, v216
    v_and_b32 v73, 0xffff0000, v216
    v_lshlrev_b32 v74, 16, v217
    v_and_b32 v75, 0xffff0000, v217
    v_lshlrev_b32 v76, 16, v218
    v_and_b32 v77, 0xffff0000, v218
    v_lshlrev_b32 v78, 16, v219
    v_and_b32 v79, 0xffff0000, v219
    v_lshlrev_b32 v80, 16, v220
    v_and_b32 v81, 0xffff0000, v220
    v_lshlrev_b32 v82, 16, v221
    v_and_b32 v83, 0xffff0000, v221
    v_lshlrev_b32 v84, 16, v222
    v_and_b32 v85, 0xffff0000, v222
    v_lshlrev_b32 v86, 16, v223
    v_and_b32 v87, 0xffff0000, v223
    v_lshlrev_b32 v88, 16, v224
    v_and_b32 v89, 0xffff0000, v224
    v_lshlrev_b32 v90, 16, v225
    v_and_b32 v91, 0xffff0000, v225
    v_lshlrev_b32 v92, 16, v226
    v_and_b32 v93, 0xffff0000, v226
    v_lshlrev_b32 v94, 16, v227
    v_and_b32 v95, 0xffff0000, v227
    v_lshlrev_b32 v96, 16, v228
    v_and_b32 v97, 0xffff0000, v228
    v_lshlrev_b32 v98, 16, v229
    v_and_b32 v99, 0xffff0000, v229
    v_lshlrev_b32 v100, 16, v230
    v_and_b32 v101, 0xffff0000, v230
    v_lshlrev_b32 v102, 16, v231
    v_and_b32 v103, 0xffff0000, v231
    v_lshlrev_b32 v104, 16, v232
    v_and_b32 v105, 0xffff0000, v232
    v_lshlrev_b32 v106, 16, v233
    v_and_b32 v107, 0xffff0000, v233
    v_lshlrev_b32 v108, 16, v234
    v_and_b32 v109, 0xffff0000, v234
    v_lshlrev_b32 v110, 16, v235
    v_and_b32 v111, 0xffff0000, v235
    v_lshlrev_b32 v112, 16, v236
    v_and_b32 v113, 0xffff0000, v236
    v_lshlrev_b32 v114, 16, v237
    v_and_b32 v115, 0xffff0000, v237
    v_lshlrev_b32 v116, 16, v238
    v_and_b32 v117, 0xffff0000, v238
    v_lshlrev_b32 v118, 16, v239
    v_and_b32 v119, 0xffff0000, v239
    v_lshlrev_b32 v120, 16, v240
    v_and_b32 v121, 0xffff0000, v240
    v_lshlrev_b32 v122, 16, v241
    v_and_b32 v123, 0xffff0000, v241
    v_lshlrev_b32 v124, 16, v242
    v_and_b32 v125, 0xffff0000, v242
    v_lshlrev_b32 v126, 16, v243
    v_and_b32 v127, 0xffff0000, v243
    v_lshlrev_b32 v128, 16, v244
    v_and_b32 v129, 0xffff0000, v244
    v_lshlrev_b32 v130, 16, v245
    v_and_b32 v131, 0xffff0000, v245
    v_lshlrev_b32 v132, 16, v246
    v_and_b32 v133, 0xffff0000, v246
    v_lshlrev_b32 v134, 16, v247
    v_and_b32 v135, 0xffff0000, v247
    v_lshlrev_b32 v136, 16, v248
    v_and_b32 v137, 0xffff0000, v248
    v_lshlrev_b32 v138, 16, v249
    v_and_b32 v139, 0xffff0000, v249
    v_lshlrev_b32 v140, 16, v250
    v_and_b32 v141, 0xffff0000, v250
    v_lshlrev_b32 v142, 16, v251
    v_and_b32 v143, 0xffff0000, v251
    v_pk_add_f32 v[144:145], v[64:65], v[66:67]
    v_pk_add_f32 v[146:147], v[68:69], v[70:71]
    v_pk_add_f32 v[144:145], v[144:145], v[72:73]
    v_pk_add_f32 v[146:147], v[146:147], v[74:75]
    v_pk_add_f32 v[144:145], v[144:145], v[76:77]
    v_pk_add_f32 v[146:147], v[146:147], v[78:79]
    v_pk_add_f32 v[144:145], v[144:145], v[80:81]
    v_pk_add_f32 v[146:147], v[146:147], v[82:83]
    v_pk_add_f32 v[144:145], v[144:145], v[84:85]
    v_pk_add_f32 v[146:147], v[146:147], v[86:87]
    v_pk_add_f32 v[144:145], v[144:145], v[88:89]
    v_pk_add_f32 v[146:147], v[146:147], v[90:91]
    v_pk_add_f32 v[144:145], v[144:145], v[92:93]
    v_pk_add_f32 v[146:147], v[146:147], v[94:95]
    v_pk_add_f32 v[144:145], v[144:145], v[96:97]
    v_pk_add_f32 v[146:147], v[146:147], v[98:99]
    v_pk_add_f32 v[144:145], v[144:145], v[100:101]
    v_pk_add_f32 v[146:147], v[146:147], v[102:103]
    v_pk_add_f32 v[144:145], v[144:145], v[104:105]
    v_pk_add_f32 v[146:147], v[146:147], v[106:107]
    v_pk_add_f32 v[144:145], v[144:145], v[108:109]
    v_pk_add_f32 v[146:147], v[146:147], v[110:111]
    v_pk_add_f32 v[144:145], v[144:145], v[112:113]
    v_pk_add_f32 v[146:147], v[146:147], v[114:115]
    v_pk_add_f32 v[144:145], v[144:145], v[116:117]
    v_pk_add_f32 v[146:147], v[146:147], v[118:119]
    v_pk_add_f32 v[144:145], v[144:145], v[120:121]
    v_pk_add_f32 v[146:147], v[146:147], v[122:123]
    v_pk_add_f32 v[144:145], v[144:145], v[124:125]
    v_pk_add_f32 v[146:147], v[146:147], v[126:127]
    v_pk_add_f32 v[144:145], v[144:145], v[128:129]
    v_pk_add_f32 v[146:147], v[146:147], v[130:131]
    v_pk_add_f32 v[144:145], v[144:145], v[132:133]
    v_pk_add_f32 v[146:147], v[146:147], v[134:135]
    v_pk_add_f32 v[144:145], v[144:145], v[136:137]
    v_pk_add_f32 v[146:147], v[146:147], v[138:139]
    v_pk_add_f32 v[144:145], v[144:145], v[140:141]
    v_pk_add_f32 v[146:147], v[146:147], v[142:143]
    v_pk_add_f32 v[144:145], v[144:145], v[146:147]
    v_add_f32 v144, v144, v145
    s_nop 1
    v_add_f32_dpp v144, v144, v144 row_ror:8 row_mask:0xf bank_mask:0xf
    v_mov_b32 v145, v144
    s_nop 1
    v_permlane16_swap_b32 v144, v145
    v_add_f32 v144, v144, v145
    v_mov_b32 v145, v144
    s_nop 1
    v_permlane32_swap_b32 v144, v145
    v_add_f32 v144, v144, v145
    v_mul_f32 v144, 0x3acccccd, v144
    v_pk_add_f32 v[146:147], v[64:65], v[144:145] op_sel_hi:[1,0] neg_lo:[0,1] neg_hi:[0,1]
    s_nop 0
    v_pk_mul_f32 v[150:151], v[146:147], v[146:147]
    v_pk_add_f32 v[148:149], v[66:67], v[144:145] op_sel_hi:[1,0] neg_lo:[0,1] neg_hi:[0,1]
    s_nop 0
    v_pk_mul_f32 v[152:153], v[148:149], v[148:149]
    v_pk_add_f32 v[146:147], v[68:69], v[144:145] op_sel_hi:[1,0] neg_lo:[0,1] neg_hi:[0,1]
    s_nop 0
    v_pk_fma_f32 v[150:151], v[146:147], v[146:147], v[150:151]
    v_pk_add_f32 v[148:149], v[70:71], v[144:145] op_sel_hi:[1,0] neg_lo:[0,1] neg_hi:[0,1]
    s_nop 0
    v_pk_fma_f32 v[152:153], v[148:149], v[148:149], v[152:153]
    v_pk_add_f32 v[146:147], v[72:73], v[144:145] op_sel_hi:[1,0] neg_lo:[0,1] neg_hi:[0,1]
    s_nop 0
    v_pk_fma_f32 v[150:151], v[146:147], v[146:147], v[150:151]
    v_pk_add_f32 v[148:149], v[74:75], v[144:145] op_sel_hi:[1,0] neg_lo:[0,1] neg_hi:[0,1]
    s_nop 0
    v_pk_fma_f32 v[152:153], v[148:149], v[148:149], v[152:153]
    v_pk_add_f32 v[146:147], v[76:77], v[144:145] op_sel_hi:[1,0] neg_lo:[0,1] neg_hi:[0,1]
    s_nop 0
    v_pk_fma_f32 v[150:151], v[146:147], v[146:147], v[150:151]
    v_pk_add_f32 v[148:149], v[78:79], v[144:145] op_sel_hi:[1,0] neg_lo:[0,1] neg_hi:[0,1]
    s_nop 0
    v_pk_fma_f32 v[152:153], v[148:149], v[148:149], v[152:153]
    v_pk_add_f32 v[146:147], v[80:81], v[144:145] op_sel_hi:[1,0] neg_lo:[0,1] neg_hi:[0,1]
    s_nop 0
    v_pk_fma_f32 v[150:151], v[146:147], v[146:147], v[150:151]
    v_pk_add_f32 v[148:149], v[82:83], v[144:145] op_sel_hi:[1,0] neg_lo:[0,1] neg_hi:[0,1]
    s_nop 0
    v_pk_fma_f32 v[152:153], v[148:149], v[148:149], v[152:153]
    v_pk_add_f32 v[146:147], v[84:85], v[144:145] op_sel_hi:[1,0] neg_lo:[0,1] neg_hi:[0,1]
    s_nop 0
    v_pk_fma_f32 v[150:151], v[146:147], v[146:147], v[150:151]
    v_pk_add_f32 v[148:149], v[86:87], v[144:145] op_sel_hi:[1,0] neg_lo:[0,1] neg_hi:[0,1]
    s_nop 0
    v_pk_fma_f32 v[152:153], v[148:149], v[148:149], v[152:153]
    v_pk_add_f32 v[146:147], v[88:89], v[144:145] op_sel_hi:[1,0] neg_lo:[0,1] neg_hi:[0,1]
    s_nop 0
    v_pk_fma_f32 v[150:151], v[146:147], v[146:147], v[150:151]
    v_pk_add_f32 v[148:149], v[90:91], v[144:145] op_sel_hi:[1,0] neg_lo:[0,1] neg_hi:[0,1]
    s_nop 0
    v_pk_fma_f32 v[152:153], v[148:149], v[148:149], v[152:153]
    v_pk_add_f32 v[146:147], v[92:93], v[144:145] op_sel_hi:[1,0] neg_lo:[0,1] neg_hi:[0,1]
    s_nop 0
    v_pk_fma_f32 v[150:151], v[146:147], v[146:147], v[150:151]
    v_pk_add_f32 v[148:149], v[94:95], v[144:145] op_sel_hi:[1,0] neg_lo:[0,1] neg_hi:[0,1]
    s_nop 0
    v_pk_fma_f32 v[152:153], v[148:149], v[148:149], v[152:153]
    v_pk_add_f32 v[146:147], v[96:97], v[144:145] op_sel_hi:[1,0] neg_lo:[0,1] neg_hi:[0,1]
    s_nop 0
    v_pk_fma_f32 v[150:151], v[146:147], v[146:147], v[150:151]
    v_pk_add_f32 v[148:149], v[98:99], v[144:145] op_sel_hi:[1,0] neg_lo:[0,1] neg_hi:[0,1]
    s_nop 0
    v_pk_fma_f32 v[152:153], v[148:149], v[148:149], v[152:153]
    v_pk_add_f32 v[146:147], v[100:101], v[144:145] op_sel_hi:[1,0] neg_lo:[0,1] neg_hi:[0,1]
    s_nop 0
    v_pk_fma_f32 v[150:151], v[146:147], v[146:147], v[150:151]
    v_pk_add_f32 v[148:149], v[102:103], v[144:145] op_sel_hi:[1,0] neg_lo:[0,1] neg_hi:[0,1]
    s_nop 0
    v_pk_fma_f32 v[152:153], v[148:149], v[148:149], v[152:153]
    v_pk_add_f32 v[146:147], v[104:105], v[144:145] op_sel_hi:[1,0] neg_lo:[0,1] neg_hi:[0,1]
    s_nop 0
    v_pk_fma_f32 v[150:151], v[146:147], v[146:147], v[150:151]
    v_pk_add_f32 v[148:149], v[106:107], v[144:145] op_sel_hi:[1,0] neg_lo:[0,1] neg_hi:[0,1]
    s_nop 0
    v_pk_fma_f32 v[152:153], v[148:149], v[148:149], v[152:153]
    v_pk_add_f32 v[146:147], v[108:109], v[144:145] op_sel_hi:[1,0] neg_lo:[0,1] neg_hi:[0,1]
    s_nop 0
    v_pk_fma_f32 v[150:151], v[146:147], v[146:147], v[150:151]
    v_pk_add_f32 v[148:149], v[110:111], v[144:145] op_sel_hi:[1,0] neg_lo:[0,1] neg_hi:[0,1]
    s_nop 0
    v_pk_fma_f32 v[152:153], v[148:149], v[148:149], v[152:153]
    v_pk_add_f32 v[146:147], v[112:113], v[144:145] op_sel_hi:[1,0] neg_lo:[0,1] neg_hi:[0,1]
    s_nop 0
    v_pk_fma_f32 v[150:151], v[146:147], v[146:147], v[150:151]
    v_pk_add_f32 v[148:149], v[114:115], v[144:145] op_sel_hi:[1,0] neg_lo:[0,1] neg_hi:[0,1]
    s_nop 0
    v_pk_fma_f32 v[152:153], v[148:149], v[148:149], v[152:153]
    v_pk_add_f32 v[146:147], v[116:117], v[144:145] op_sel_hi:[1,0] neg_lo:[0,1] neg_hi:[0,1]
    s_nop 0
    v_pk_fma_f32 v[150:151], v[146:147], v[146:147], v[150:151]
    v_pk_add_f32 v[148:149], v[118:119], v[144:145] op_sel_hi:[1,0] neg_lo:[0,1] neg_hi:[0,1]
    s_nop 0
    v_pk_fma_f32 v[152:153], v[148:149], v[148:149], v[152:153]
    v_pk_add_f32 v[146:147], v[120:121], v[144:145] op_sel_hi:[1,0] neg_lo:[0,1] neg_hi:[0,1]
    s_nop 0
    v_pk_fma_f32 v[150:151], v[146:147], v[146:147], v[150:151]
    v_pk_add_f32 v[148:149], v[122:123], v[144:145] op_sel_hi:[1,0] neg_lo:[0,1] neg_hi:[0,1]
    s_nop 0
    v_pk_fma_f32 v[152:153], v[148:149], v[148:149], v[152:153]
    v_pk_add_f32 v[146:147], v[124:125], v[144:145] op_sel_hi:[1,0] neg_lo:[0,1] neg_hi:[0,1]
    s_nop 0
    v_pk_fma_f32 v[150:151], v[146:147], v[146:147], v[150:151]
    v_pk_add_f32 v[148:149], v[126:127], v[144:145] op_sel_hi:[1,0] neg_lo:[0,1] neg_hi:[0,1]
    s_nop 0
    v_pk_fma_f32 v[152:153], v[148:149], v[148:149], v[152:153]
    v_pk_add_f32 v[146:147], v[128:129], v[144:145] op_sel_hi:[1,0] neg_lo:[0,1] neg_hi:[0,1]
    s_nop 0
    v_pk_fma_f32 v[150:151], v[146:147], v[146:147], v[150:151]
    v_pk_add_f32 v[148:149], v[130:131], v[144:145] op_sel_hi:[1,0] neg_lo:[0,1] neg_hi:[0,1]
    s_nop 0
    v_pk_fma_f32 v[152:153], v[148:149], v[148:149], v[152:153]
    v_pk_add_f32 v[146:147], v[132:133], v[144:145] op_sel_hi:[1,0] neg_lo:[0,1] neg_hi:[0,1]
    s_nop 0
    v_pk_fma_f32 v[150:151], v[146:147], v[146:147], v[150:151]
    v_pk_add_f32 v[148:149], v[134:135], v[144:145] op_sel_hi:[1,0] neg_lo:[0,1] neg_hi:[0,1]
    s_nop 0
    v_pk_fma_f32 v[152:153], v[148:149], v[148:149], v[152:153]
    v_pk_add_f32 v[146:147], v[136:137], v[144:145] op_sel_hi:[1,0] neg_lo:[0,1] neg_hi:[0,1]
    s_nop 0
    v_pk_fma_f32 v[150:151], v[146:147], v[146:147], v[150:151]
    v_pk_add_f32 v[148:149], v[138:139], v[144:145] op_sel_hi:[1,0] neg_lo:[0,1] neg_hi:[0,1]
    s_nop 0
    v_pk_fma_f32 v[152:153], v[148:149], v[148:149], v[152:153]
    v_pk_add_f32 v[146:147], v[140:141], v[144:145] op_sel_hi:[1,0] neg_lo:[0,1] neg_hi:[0,1]
    s_nop 0
    v_pk_fma_f32 v[150:151], v[146:147], v[146:147], v[150:151]
    v_pk_add_f32 v[148:149], v[142:143], v[144:145] op_sel_hi:[1,0] neg_lo:[0,1] neg_hi:[0,1]
    s_nop 0
    v_pk_fma_f32 v[152:153], v[148:149], v[148:149], v[152:153]
    v_pk_add_f32 v[150:151], v[150:151], v[152:153]
    v_add_f32 v146, v150, v151
    s_nop 1
    v_add_f32_dpp v146, v146, v146 row_ror:8 row_mask:0xf bank_mask:0xf
    v_mov_b32 v147, v146
    s_nop 1
    v_permlane16_swap_b32 v146, v147
    v_add_f32 v146, v146, v147
    v_mov_b32 v147, v146
    s_nop 1
    v_permlane32_swap_b32 v146, v147
    v_add_f32 v146, v146, v147
    v_mul_f32 v146, 0x3acccccd, v146
    v_cvt_pk_bf16_f32 v146, v146, v146
    v_lshlrev_b32 v146, 16, v146
    v_add_f32 v146, 0x3727c5ac, v146
    v_cvt_pk_bf16_f32 v146, v146, v146
    v_lshlrev_b32 v146, 16, v146
    v_sqrt_f32 v146, v146
    s_nop 0
    v_cvt_pk_bf16_f32 v146, v146, v146
    v_lshlrev_b32 v146, 16, v146
    v_rcp_f32 v146, v146
    v_cvt_pk_bf16_f32 v144, v144, v144
    v_lshlrev_b32 v144, 16, v144
    v_pk_add_f32 v[148:149], v[64:65], v[144:145] op_sel_hi:[1,0] neg_lo:[0,1] neg_hi:[0,1]
    s_nop 0
    v_cvt_pk_bf16_f32 v148, v148, v149
    v_and_b32 v149, 0xffff0000, v148
    v_lshlrev_b32 v148, 16, v148
    v_pk_mul_f32 v[148:149], v[148:149], v[146:147] op_sel_hi:[1,0]
    s_nop 0
    v_cvt_pk_bf16_f32 v212, v148, v149
    v_pk_add_f32 v[150:151], v[66:67], v[144:145] op_sel_hi:[1,0] neg_lo:[0,1] neg_hi:[0,1]
    s_nop 0
    v_cvt_pk_bf16_f32 v150, v150, v151
    v_and_b32 v151, 0xffff0000, v150
    v_lshlrev_b32 v150, 16, v150
    v_pk_mul_f32 v[150:151], v[150:151], v[146:147] op_sel_hi:[1,0]
    s_nop 0
    v_cvt_pk_bf16_f32 v214, v150, v151
    v_pk_add_f32 v[148:149], v[68:69], v[144:145] op_sel_hi:[1,0] neg_lo:[0,1] neg_hi:[0,1]
    s_nop 0
    v_cvt_pk_bf16_f32 v148, v148, v149
    v_and_b32 v149, 0xffff0000, v148
    v_lshlrev_b32 v148, 16, v148
    v_pk_mul_f32 v[148:149], v[148:149], v[146:147] op_sel_hi:[1,0]
    s_nop 0
    v_cvt_pk_bf16_f32 v216, v148, v149
    v_pk_add_f32 v[150:151], v[70:71], v[144:145] op_sel_hi:[1,0] neg_lo:[0,1] neg_hi:[0,1]
    s_nop 0
    v_cvt_pk_bf16_f32 v150, v150, v151
    v_and_b32 v151, 0xffff0000, v150
    v_lshlrev_b32 v150, 16, v150
    v_pk_mul_f32 v[150:151], v[150:151], v[146:147] op_sel_hi:[1,0]
    s_nop 0
    v_cvt_pk_bf16_f32 v218, v150, v151
    v_pk_add_f32 v[148:149], v[72:73], v[144:145] op_sel_hi:[1,0] neg_lo:[0,1] neg_hi:[0,1]
    s_nop 0
    v_cvt_pk_bf16_f32 v148, v148, v149
    v_and_b32 v149, 0xffff0000, v148
    v_lshlrev_b32 v148, 16, v148
    v_pk_mul_f32 v[148:149], v[148:149], v[146:147] op_sel_hi:[1,0]
    s_nop 0
    v_cvt_pk_bf16_f32 v213, v148, v149
    v_pk_add_f32 v[150:151], v[74:75], v[144:145] op_sel_hi:[1,0] neg_lo:[0,1] neg_hi:[0,1]
    s_nop 0
    v_cvt_pk_bf16_f32 v150, v150, v151
    v_and_b32 v151, 0xffff0000, v150
    v_lshlrev_b32 v150, 16, v150
    v_pk_mul_f32 v[150:151], v[150:151], v[146:147] op_sel_hi:[1,0]
    s_nop 0
    v_cvt_pk_bf16_f32 v215, v150, v151
    v_pk_add_f32 v[148:149], v[76:77], v[144:145] op_sel_hi:[1,0] neg_lo:[0,1] neg_hi:[0,1]
    s_nop 0
    v_cvt_pk_bf16_f32 v148, v148, v149
    v_and_b32 v149, 0xffff0000, v148
    v_lshlrev_b32 v148, 16, v148
    v_pk_mul_f32 v[148:149], v[148:149], v[146:147] op_sel_hi:[1,0]
    s_nop 0
    v_cvt_pk_bf16_f32 v217, v148, v149
    v_pk_add_f32 v[150:151], v[78:79], v[144:145] op_sel_hi:[1,0] neg_lo:[0,1] neg_hi:[0,1]
    s_nop 0
    v_cvt_pk_bf16_f32 v150, v150, v151
    v_and_b32 v151, 0xffff0000, v150
    v_lshlrev_b32 v150, 16, v150
    v_pk_mul_f32 v[150:151], v[150:151], v[146:147] op_sel_hi:[1,0]
    s_nop 0
    v_cvt_pk_bf16_f32 v219, v150, v151
    v_pk_add_f32 v[148:149], v[80:81], v[144:145] op_sel_hi:[1,0] neg_lo:[0,1] neg_hi:[0,1]
    s_nop 0
    v_cvt_pk_bf16_f32 v148, v148, v149
    v_and_b32 v149, 0xffff0000, v148
    v_lshlrev_b32 v148, 16, v148
    v_pk_mul_f32 v[148:149], v[148:149], v[146:147] op_sel_hi:[1,0]
    s_nop 0
    v_cvt_pk_bf16_f32 v220, v148, v149
    v_pk_add_f32 v[150:151], v[82:83], v[144:145] op_sel_hi:[1,0] neg_lo:[0,1] neg_hi:[0,1]
    s_nop 0
    v_cvt_pk_bf16_f32 v150, v150, v151
    v_and_b32 v151, 0xffff0000, v150
    v_lshlrev_b32 v150, 16, v150
    v_pk_mul_f32 v[150:151], v[150:151], v[146:147] op_sel_hi:[1,0]
    s_nop 0
    v_cvt_pk_bf16_f32 v222, v150, v151
    v_pk_add_f32 v[148:149], v[84:85], v[144:145] op_sel_hi:[1,0] neg_lo:[0,1] neg_hi:[0,1]
    s_nop 0
    v_cvt_pk_bf16_f32 v148, v148, v149
    v_and_b32 v149, 0xffff0000, v148
    v_lshlrev_b32 v148, 16, v148
    v_pk_mul_f32 v[148:149], v[148:149], v[146:147] op_sel_hi:[1,0]
    s_nop 0
    v_cvt_pk_bf16_f32 v224, v148, v149
    v_pk_add_f32 v[150:151], v[86:87], v[144:145] op_sel_hi:[1,0] neg_lo:[0,1] neg_hi:[0,1]
    s_nop 0
    v_cvt_pk_bf16_f32 v150, v150, v151
    v_and_b32 v151, 0xffff0000, v150
    v_lshlrev_b32 v150, 16, v150
    v_pk_mul_f32 v[150:151], v[150:151], v[146:147] op_sel_hi:[1,0]
    s_nop 0
    v_cvt_pk_bf16_f32 v226, v150, v151
    v_pk_add_f32 v[148:149], v[88:89], v[144:145] op_sel_hi:[1,0] neg_lo:[0,1] neg_hi:[0,1]
    s_nop 0
    v_cvt_pk_bf16_f32 v148, v148, v149
    v_and_b32 v149, 0xffff0000, v148
    v_lshlrev_b32 v148, 16, v148
    v_pk_mul_f32 v[148:149], v[148:149], v[146:147] op_sel_hi:[1,0]
    s_nop 0
    v_cvt_pk_bf16_f32 v221, v148, v149
    v_pk_add_f32 v[150:151], v[90:91], v[144:145] op_sel_hi:[1,0] neg_lo:[0,1] neg_hi:[0,1]
    s_nop 0
    v_cvt_pk_bf16_f32 v150, v150, v151
    v_and_b32 v151, 0xffff0000, v150
    v_lshlrev_b32 v150, 16, v150
    v_pk_mul_f32 v[150:151], v[150:151], v[146:147] op_sel_hi:[1,0]
    s_nop 0
    v_cvt_pk_bf16_f32 v223, v150, v151
    v_pk_add_f32 v[148:149], v[92:93], v[144:145] op_sel_hi:[1,0] neg_lo:[0,1] neg_hi:[0,1]
    s_nop 0
    v_cvt_pk_bf16_f32 v148, v148, v149
    v_and_b32 v149, 0xffff0000, v148
    v_lshlrev_b32 v148, 16, v148
    v_pk_mul_f32 v[148:149], v[148:149], v[146:147] op_sel_hi:[1,0]
    s_nop 0
    v_cvt_pk_bf16_f32 v225, v148, v149
    v_pk_add_f32 v[150:151], v[94:95], v[144:145] op_sel_hi:[1,0] neg_lo:[0,1] neg_hi:[0,1]
    s_nop 0
    v_cvt_pk_bf16_f32 v150, v150, v151
    v_and_b32 v151, 0xffff0000, v150
    v_lshlrev_b32 v150, 16, v150
    v_pk_mul_f32 v[150:151], v[150:151], v[146:147] op_sel_hi:[1,0]
    s_nop 0
    v_cvt_pk_bf16_f32 v227, v150, v151
    v_pk_add_f32 v[148:149], v[96:97], v[144:145] op_sel_hi:[1,0] neg_lo:[0,1] neg_hi:[0,1]
    s_nop 0
    v_cvt_pk_bf16_f32 v148, v148, v149
    v_and_b32 v149, 0xffff0000, v148
    v_lshlrev_b32 v148, 16, v148
    v_pk_mul_f32 v[148:149], v[148:149], v[146:147] op_sel_hi:[1,0]
    s_nop 0
    v_cvt_pk_bf16_f32 v228, v148, v149
    v_pk_add_f32 v[150:151], v[98:99], v[144:145] op_sel_hi:[1,0] neg_lo:[0,1] neg_hi:[0,1]
    s_nop 0
    v_cvt_pk_bf16_f32 v150, v150, v151
    v_and_b32 v151, 0xffff0000, v150
    v_lshlrev_b32 v150, 16, v150
    v_pk_mul_f32 v[150:151], v[150:151], v[146:147] op_sel_hi:[1,0]
    s_nop 0
    v_cvt_pk_bf16_f32 v230, v150, v151
    v_pk_add_f32 v[148:149], v[100:101], v[144:145] op_sel_hi:[1,0] neg_lo:[0,1] neg_hi:[0,1]
    s_nop 0
    v_cvt_pk_bf16_f32 v148, v148, v149
    v_and_b32 v149, 0xffff0000, v148
    v_lshlrev_b32 v148, 16, v148
    v_pk_mul_f32 v[148:149], v[148:149], v[146:147] op_sel_hi:[1,0]
    s_nop 0
    v_cvt_pk_bf16_f32 v232, v148, v149
    v_pk_add_f32 v[150:151], v[102:103], v[144:145] op_sel_hi:[1,0] neg_lo:[0,1] neg_hi:[0,1]
    s_nop 0
    v_cvt_pk_bf16_f32 v150, v150, v151
    v_and_b32 v151, 0xffff0000, v150
    v_lshlrev_b32 v150, 16, v150
    v_pk_mul_f32 v[150:151], v[150:151], v[146:147] op_sel_hi:[1,0]
    s_nop 0
    v_cvt_pk_bf16_f32 v234, v150, v151
    v_pk_add_f32 v[148:149], v[104:105], v[144:145] op_sel_hi:[1,0] neg_lo:[0,1] neg_hi:[0,1]
    s_nop 0
    v_cvt_pk_bf16_f32 v148, v148, v149
    v_and_b32 v149, 0xffff0000, v148
    v_lshlrev_b32 v148, 16, v148
    v_pk_mul_f32 v[148:149], v[148:149], v[146:147] op_sel_hi:[1,0]
    s_nop 0
    v_cvt_pk_bf16_f32 v229, v148, v149
    v_pk_add_f32 v[150:151], v[106:107], v[144:145] op_sel_hi:[1,0] neg_lo:[0,1] neg_hi:[0,1]
    s_nop 0
    v_cvt_pk_bf16_f32 v150, v150, v151
    v_and_b32 v151, 0xffff0000, v150
    v_lshlrev_b32 v150, 16, v150
    v_pk_mul_f32 v[150:151], v[150:151], v[146:147] op_sel_hi:[1,0]
    s_nop 0
    v_cvt_pk_bf16_f32 v231, v150, v151
    v_pk_add_f32 v[148:149], v[108:109], v[144:145] op_sel_hi:[1,0] neg_lo:[0,1] neg_hi:[0,1]
    s_nop 0
    v_cvt_pk_bf16_f32 v148, v148, v149
    v_and_b32 v149, 0xffff0000, v148
    v_lshlrev_b32 v148, 16, v148
    v_pk_mul_f32 v[148:149], v[148:149], v[146:147] op_sel_hi:[1,0]
    s_nop 0
    v_cvt_pk_bf16_f32 v233, v148, v149
    v_pk_add_f32 v[150:151], v[110:111], v[144:145] op_sel_hi:[1,0] neg_lo:[0,1] neg_hi:[0,1]
    s_nop 0
    v_cvt_pk_bf16_f32 v150, v150, v151
    v_and_b32 v151, 0xffff0000, v150
    v_lshlrev_b32 v150, 16, v150
    v_pk_mul_f32 v[150:151], v[150:151], v[146:147] op_sel_hi:[1,0]
    s_nop 0
    v_cvt_pk_bf16_f32 v235, v150, v151
    v_pk_add_f32 v[148:149], v[112:113], v[144:145] op_sel_hi:[1,0] neg_lo:[0,1] neg_hi:[0,1]
    s_nop 0
    v_cvt_pk_bf16_f32 v148, v148, v149
    v_and_b32 v149, 0xffff0000, v148
    v_lshlrev_b32 v148, 16, v148
    v_pk_mul_f32 v[148:149], v[148:149], v[146:147] op_sel_hi:[1,0]
    s_nop 0
    v_cvt_pk_bf16_f32 v236, v148, v149
    v_pk_add_f32 v[150:151], v[114:115], v[144:145] op_sel_hi:[1,0] neg_lo:[0,1] neg_hi:[0,1]
    s_nop 0
    v_cvt_pk_bf16_f32 v150, v150, v151
    v_and_b32 v151, 0xffff0000, v150
    v_lshlrev_b32 v150, 16, v150
    v_pk_mul_f32 v[150:151], v[150:151], v[146:147] op_sel_hi:[1,0]
    s_nop 0
    v_cvt_pk_bf16_f32 v238, v150, v151
    v_pk_add_f32 v[148:149], v[116:117], v[144:145] op_sel_hi:[1,0] neg_lo:[0,1] neg_hi:[0,1]
    s_nop 0
    v_cvt_pk_bf16_f32 v148, v148, v149
    v_and_b32 v149, 0xffff0000, v148
    v_lshlrev_b32 v148, 16, v148
    v_pk_mul_f32 v[148:149], v[148:149], v[146:147] op_sel_hi:[1,0]
    s_nop 0
    v_cvt_pk_bf16_f32 v240, v148, v149
    v_pk_add_f32 v[150:151], v[118:119], v[144:145] op_sel_hi:[1,0] neg_lo:[0,1] neg_hi:[0,1]
    s_nop 0
    v_cvt_pk_bf16_f32 v150, v150, v151
    v_and_b32 v151, 0xffff0000, v150
    v_lshlrev_b32 v150, 16, v150
    v_pk_mul_f32 v[150:151], v[150:151], v[146:147] op_sel_hi:[1,0]
    s_nop 0
    v_cvt_pk_bf16_f32 v242, v150, v151
    v_pk_add_f32 v[148:149], v[120:121], v[144:145] op_sel_hi:[1,0] neg_lo:[0,1] neg_hi:[0,1]
    s_nop 0
    v_cvt_pk_bf16_f32 v148, v148, v149
    v_and_b32 v149, 0xffff0000, v148
    v_lshlrev_b32 v148, 16, v148
    v_pk_mul_f32 v[148:149], v[148:149], v[146:147] op_sel_hi:[1,0]
    s_nop 0
    v_cvt_pk_bf16_f32 v237, v148, v149
    v_pk_add_f32 v[150:151], v[122:123], v[144:145] op_sel_hi:[1,0] neg_lo:[0,1] neg_hi:[0,1]
    s_nop 0
    v_cvt_pk_bf16_f32 v150, v150, v151
    v_and_b32 v151, 0xffff0000, v150
    v_lshlrev_b32 v150, 16, v150
    v_pk_mul_f32 v[150:151], v[150:151], v[146:147] op_sel_hi:[1,0]
    s_nop 0
    v_cvt_pk_bf16_f32 v239, v150, v151
    v_pk_add_f32 v[148:149], v[124:125], v[144:145] op_sel_hi:[1,0] neg_lo:[0,1] neg_hi:[0,1]
    s_nop 0
    v_cvt_pk_bf16_f32 v148, v148, v149
    v_and_b32 v149, 0xffff0000, v148
    v_lshlrev_b32 v148, 16, v148
    v_pk_mul_f32 v[148:149], v[148:149], v[146:147] op_sel_hi:[1,0]
    s_nop 0
    v_cvt_pk_bf16_f32 v241, v148, v149
    v_pk_add_f32 v[150:151], v[126:127], v[144:145] op_sel_hi:[1,0] neg_lo:[0,1] neg_hi:[0,1]
    s_nop 0
    v_cvt_pk_bf16_f32 v150, v150, v151
    v_and_b32 v151, 0xffff0000, v150
    v_lshlrev_b32 v150, 16, v150
    v_pk_mul_f32 v[150:151], v[150:151], v[146:147] op_sel_hi:[1,0]
    s_nop 0
    v_cvt_pk_bf16_f32 v243, v150, v151
    v_pk_add_f32 v[148:149], v[128:129], v[144:145] op_sel_hi:[1,0] neg_lo:[0,1] neg_hi:[0,1]
    s_nop 0
    v_cvt_pk_bf16_f32 v148, v148, v149
    v_and_b32 v149, 0xffff0000, v148
    v_lshlrev_b32 v148, 16, v148
    v_pk_mul_f32 v[148:149], v[148:149], v[146:147] op_sel_hi:[1,0]
    s_nop 0
    v_cvt_pk_bf16_f32 v244, v148, v149
    v_pk_add_f32 v[150:151], v[130:131], v[144:145] op_sel_hi:[1,0] neg_lo:[0,1] neg_hi:[0,1]
    s_nop 0
    v_cvt_pk_bf16_f32 v150, v150, v151
    v_and_b32 v151, 0xffff0000, v150
    v_lshlrev_b32 v150, 16, v150
    v_pk_mul_f32 v[150:151], v[150:151], v[146:147] op_sel_hi:[1,0]
    s_nop 0
    v_cvt_pk_bf16_f32 v246, v150, v151
    v_pk_add_f32 v[148:149], v[132:133], v[144:145] op_sel_hi:[1,0] neg_lo:[0,1] neg_hi:[0,1]
    s_nop 0
    v_cvt_pk_bf16_f32 v148, v148, v149
    v_and_b32 v149, 0xffff0000, v148
    v_lshlrev_b32 v148, 16, v148
    v_pk_mul_f32 v[148:149], v[148:149], v[146:147] op_sel_hi:[1,0]
    s_nop 0
    v_cvt_pk_bf16_f32 v248, v148, v149
    v_pk_add_f32 v[150:151], v[134:135], v[144:145] op_sel_hi:[1,0] neg_lo:[0,1] neg_hi:[0,1]
    s_nop 0
    v_cvt_pk_bf16_f32 v150, v150, v151
    v_and_b32 v151, 0xffff0000, v150
    v_lshlrev_b32 v150, 16, v150
    v_pk_mul_f32 v[150:151], v[150:151], v[146:147] op_sel_hi:[1,0]
    s_nop 0
    v_cvt_pk_bf16_f32 v250, v150, v151
    v_pk_add_f32 v[148:149], v[136:137], v[144:145] op_sel_hi:[1,0] neg_lo:[0,1] neg_hi:[0,1]
    s_nop 0
    v_cvt_pk_bf16_f32 v148, v148, v149
    v_and_b32 v149, 0xffff0000, v148
    v_lshlrev_b32 v148, 16, v148
    v_pk_mul_f32 v[148:149], v[148:149], v[146:147] op_sel_hi:[1,0]
    s_nop 0
    v_cvt_pk_bf16_f32 v245, v148, v149
    v_pk_add_f32 v[150:151], v[138:139], v[144:145] op_sel_hi:[1,0] neg_lo:[0,1] neg_hi:[0,1]
    s_nop 0
    v_cvt_pk_bf16_f32 v150, v150, v151
    v_and_b32 v151, 0xffff0000, v150
    v_lshlrev_b32 v150, 16, v150
    v_pk_mul_f32 v[150:151], v[150:151], v[146:147] op_sel_hi:[1,0]
    s_nop 0
    v_cvt_pk_bf16_f32 v247, v150, v151
    v_pk_add_f32 v[148:149], v[140:141], v[144:145] op_sel_hi:[1,0] neg_lo:[0,1] neg_hi:[0,1]
    s_nop 0
    v_cvt_pk_bf16_f32 v148, v148, v149
    v_and_b32 v149, 0xffff0000, v148
    v_lshlrev_b32 v148, 16, v148
    v_pk_mul_f32 v[148:149], v[148:149], v[146:147] op_sel_hi:[1,0]
    s_nop 0
    v_cvt_pk_bf16_f32 v249, v148, v149
    v_pk_add_f32 v[150:151], v[142:143], v[144:145] op_sel_hi:[1,0] neg_lo:[0,1] neg_hi:[0,1]
    s_nop 0
    v_cvt_pk_bf16_f32 v150, v150, v151
    v_and_b32 v151, 0xffff0000, v150
    v_lshlrev_b32 v150, 16, v150
    v_pk_mul_f32 v[150:151], v[150:151], v[146:147] op_sel_hi:[1,0]
    s_nop 0
    v_cvt_pk_bf16_f32 v251, v150, v151
    s_branch WR_A
PRO_G:
    s_cmp_ge_u32 s28, 18
    s_cbranch_scc1 PRO_C
    s_cmp_lt_u32 s28, 12
    s_cbranch_scc0 PRO_PV
    s_mov_b32 s12, s68
    s_mov_b32 s13, s69
    s_mov_b32 s14, 7864320
    s_mov_b32 s15, 0x00020000
    s_mov_b32 s16, s70
    s_mov_b32 s17, s71
    s_mov_b32 s18, 7864320
    s_mov_b32 s19, 0x00020000
    s_mul_i32 s3, s27, 1536
    s_lshl_b32 s4, s28, 7
    s_add_u32 s3, s3, s4
    s_mov_b32 s4, s3
    s_branch PRO_P2
PRO_PV:
    s_mov_b32 s12, s72
    s_mov_b32 s13, s73
    s_mov_b32 s14, 7864320
    s_mov_b32 s15, 0x00020000
    s_mov_b32 s16, s72
    s_mov_b32 s17, s73
    s_mov_b32 s18, 7864320
    s_mov_b32 s19, 0x00020000
    s_mul_i32 s3, s27, 1536
    s_sub_u32 s4, s28, 12
    s_lshl_b32 s4, s4, 8
    s_add_u32 s3, s3, s4
    s_add_u32 s4, s3, 128
PRO_P2:
    v_lshrrev_b32 v4, 3, v0
    v_mul_u32_u24 v4, 12288, v4
    s_and_b32 s5, s26, 1
    s_lshl_b32 s5, s5, 1
    v_lshrrev_b32 v5, 5, v0
    v_add_u32 v5, s5, v5
    v_bfe_u32 v6, v0, 1, 2
    v_xor_b32 v5, v5, v6
    v_lshlrev_b32 v5, 5, v5
    v_and_b32 v6, 1, v0
    v_lshlrev_b32 v6, 4, v6
    v_add3_u32 v4, v4, v5, v6
    s_mul_i32 s5, s26, 98304
    s_add_u32 s3, s3, s5
    s_add_u32 s4, s4, s5
    s_lshl_b32 s6, s26, 10
    s_mov_b32 m0, s6
    s_nop 0
    buffer_load_dwordx4 v4, s[12:15], s3 offen nt lds
    s_add_u32 s7, s6, 40960
    s_mov_b32 m0, s7
    s_nop 0
    buffer_load_dwordx4 v4, s[16:19], s4 offen nt lds
    s_add_u32 s3, s3, 393216
    s_add_u32 s4, s4, 393216
    s_add_u32 s6, s6, 4096
    s_mov_b32 m0, s6
    s_nop 0
    buffer_load_dwordx4 v4, s[12:15], s3 offen nt lds
    s_add_u32 s7, s6, 40960
    s_mov_b32 m0, s7
    s_nop 0
    buffer_load_dwordx4 v4, s[16:19], s4 offen nt lds
    s_add_u32 s3, s3, 393216
    s_add_u32 s4, s4, 393216
    s_add_u32 s6, s6, 4096
    s_mov_b32 m0, s6
    s_nop 0
    buffer_load_dwordx4 v4, s[12:15], s3 offen nt lds
    s_add_u32 s7, s6, 40960
    s_mov_b32 m0, s7
    s_nop 0
    buffer_load_dwordx4 v4, s[16:19], s4 offen nt lds
    s_add_u32 s3, s3, 393216
    s_add_u32 s4, s4, 393216
    s_add_u32 s6, s6, 4096
    s_mov_b32 m0, s6
    s_nop 0
    buffer_load_dwordx4 v4, s[12:15], s3 offen nt lds
    s_add_u32 s7, s6, 40960
    s_mov_b32 m0, s7
    s_nop 0
    buffer_load_dwordx4 v4, s[16:19], s4 offen nt lds
    s_add_u32 s3, s3, 393216
    s_add_u32 s4, s4, 393216
    s_add_u32 s6, s6, 4096
    s_mov_b32 m0, s6
    s_nop 0
    buffer_load_dwordx4 v4, s[12:15], s3 offen nt lds
    s_add_u32 s7, s6, 40960
    s_mov_b32 m0, s7
    s_nop 0
    buffer_load_dwordx4 v4, s[16:19], s4 offen nt lds
    s_add_u32 s3, s3, 393216
    s_add_u32 s4, s4, 393216
    s_add_u32 s6, s6, 4096
    s_mov_b32 m0, s6
    s_nop 0
    buffer_load_dwordx4 v4, s[12:15], s3 offen nt lds
    s_add_u32 s7, s6, 40960
    s_mov_b32 m0, s7
    s_nop 0
    buffer_load_dwordx4 v4, s[16:19], s4 offen nt lds
    s_add_u32 s3, s3, 393216
    s_add_u32 s4, s4, 393216
    s_add_u32 s6, s6, 4096
    s_mov_b32 m0, s6
    s_nop 0
    buffer_load_dwordx4 v4, s[12:15], s3 offen nt lds
    s_add_u32 s7, s6, 40960
    s_mov_b32 m0, s7
    s_nop 0
    buffer_load_dwordx4 v4, s[16:19], s4 offen nt lds
    s_add_u32 s3, s3, 393216
    s_add_u32 s4, s4, 393216
    s_add_u32 s6, s6, 4096
    s_mov_b32 m0, s6
    s_nop 0
    buffer_load_dwordx4 v4, s[12:15], s3 offen nt lds
    s_add_u32 s7, s6, 40960
    s_mov_b32 m0, s7
    s_nop 0
    buffer_load_dwordx4 v4, s[16:19], s4 offen nt lds
    s_add_u32 s3, s3, 393216
    s_add_u32 s4, s4, 393216
    s_add_u32 s6, s6, 4096
    s_mov_b32 m0, s6
    s_nop 0
    buffer_load_dwordx4 v4, s[12:15], s3 offen nt lds
    s_add_u32 s7, s6, 40960
    s_mov_b32 m0, s7
    s_nop 0
    buffer_load_dwordx4 v4, s[16:19], s4 offen nt lds
    s_add_u32 s3, s3, 393216
    s_add_u32 s4, s4, 393216
    s_add_u32 s6, s6, 4096
    s_mov_b32 m0, s6
    s_nop 0
    buffer_load_dwordx4 v4, s[12:15], s3 offen nt lds
    s_add_u32 s7, s6, 40960
    s_mov_b32 m0, s7
    s_nop 0
    buffer_load_dwordx4 v4, s[16:19], s4 offen nt lds
    s_add_u32 s3, s3, 393216
    s_add_u32 s4, s4, 393216
    s_add_u32 s6, s6, 45056
    s_mov_b32 m0, s6
    s_nop 0
    buffer_load_dwordx4 v4, s[12:15], s3 offen nt lds
    s_add_u32 s7, s6, 40960
    s_mov_b32 m0, s7
    s_nop 0
    buffer_load_dwordx4 v4, s[16:19], s4 offen nt lds
    s_add_u32 s3, s3, 393216
    s_add_u32 s4, s4, 393216
    s_add_u32 s6, s6, 4096
    s_mov_b32 m0, s6
    s_nop 0
    buffer_load_dwordx4 v4, s[12:15], s3 offen nt lds
    s_add_u32 s7, s6, 40960
    s_mov_b32 m0, s7
    s_nop 0
    buffer_load_dwordx4 v4, s[16:19], s4 offen nt lds
    s_add_u32 s3, s3, 393216
    s_add_u32 s4, s4, 393216
    s_add_u32 s6, s6, 4096
    s_mov_b32 m0, s6
    s_nop 0
    buffer_load_dwordx4 v4, s[12:15], s3 offen nt lds
    s_add_u32 s7, s6, 40960
    s_mov_b32 m0, s7
    s_nop 0
    buffer_load_dwordx4 v4, s[16:19], s4 offen nt lds
    s_add_u32 s3, s3, 393216
    s_add_u32 s4, s4, 393216
    s_add_u32 s6, s6, 4096
    s_mov_b32 m0, s6
    s_nop 0
    buffer_load_dwordx4 v4, s[12:15], s3 offen nt lds
    s_add_u32 s7, s6, 40960
    s_mov_b32 m0, s7
    s_nop 0
    buffer_load_dwordx4 v4, s[16:19], s4 offen nt lds
    s_add_u32 s3, s3, 393216
    s_add_u32 s4, s4, 393216
    s_add_u32 s6, s6, 4096
    s_mov_b32 m0, s6
    s_nop 0
    buffer_load_dwordx4 v4, s[12:15], s3 offen nt lds
    s_add_u32 s7, s6, 40960
    s_mov_b32 m0, s7
    s_nop 0
    buffer_load_dwordx4 v4, s[16:19], s4 offen nt lds
    s_add_u32 s3, s3, 393216
    s_add_u32 s4, s4, 393216
    s_add_u32 s6, s6, 4096
    s_mov_b32 m0, s6
    s_nop 0
    buffer_load_dwordx4 v4, s[12:15], s3 offen nt lds
    s_add_u32 s7, s6, 40960
    s_mov_b32 m0, s7
    s_nop 0
    buffer_load_dwordx4 v4, s[16:19], s4 offen nt lds
    s_add_u32 s3, s3, 393216
    s_add_u32 s4, s4, 393216
    s_add_u32 s6, s6, 4096
    s_mov_b32 m0, s6
    s_nop 0
    buffer_load_dwordx4 v4, s[12:15], s3 offen nt lds
    s_add_u32 s7, s6, 40960
    s_mov_b32 m0, s7
    s_nop 0
    buffer_load_dwordx4 v4, s[16:19], s4 offen nt lds
    s_add_u32 s3, s3, 393216
    s_add_u32 s4, s4, 393216
    s_add_u32 s6, s6, 4096
    s_mov_b32 m0, s6
    s_nop 0
    buffer_load_dwordx4 v4, s[12:15], s3 offen nt lds
    s_add_u32 s7, s6, 40960
    s_mov_b32 m0, s7
    s_nop 0
    buffer_load_dwordx4 v4, s[16:19], s4 offen nt lds
    s_add_u32 s3, s3, 393216
    s_add_u32 s4, s4, 393216
    s_add_u32 s6, s6, 4096
    s_mov_b32 m0, s6
    s_nop 0
    buffer_load_dwordx4 v4, s[12:15], s3 offen nt lds
    s_add_u32 s7, s6, 40960
    s_mov_b32 m0, s7
    s_nop 0
    buffer_load_dwordx4 v4, s[16:19], s4 offen nt lds
    s_add_u32 s3, s3, 393216
    s_add_u32 s4, s4, 393216
    s_add_u32 s6, s6, 4096
    s_mov_b32 m0, s6
    s_nop 0
    buffer_load_dwordx4 v4, s[12:15], s3 offen nt lds
    s_add_u32 s7, s6, 40960
    s_mov_b32 m0, s7
    s_nop 0
    buffer_load_dwordx4 v4, s[16:19], s4 offen nt lds
    s_branch WR_P
PRO_C:
    s_mov_b32 s12, s74
    s_mov_b32 s13, s75
    s_mov_b32 s14, 7864320
    s_mov_b32 s15, 0x00020000
    v_lshrrev_b32 v4, 3, v0
    v_mul_u32_u24 v4, 1280, v4
    v_lshrrev_b32 v5, 4, v0
    v_bfe_u32 v6, v0, 1, 2
    v_xor_b32 v5, v5, v6
    v_lshlrev_b32 v5, 5, v5
    v_and_b32 v6, 1, v0
    v_lshlrev_b32 v6, 4, v6
    v_add3_u32 v4, v4, v5, v6
    s_mul_i32 s3, s27, 983040
    s_sub_u32 s4, s28, 18
    s_lshl_b32 s4, s4, 7
    s_add_u32 s3, s3, s4
    s_mul_i32 s5, s26, 10240
    s_add_u32 s3, s3, s5
    s_lshl_b32 s6, s26, 10
    s_barrier
    s_mov_b32 m0, s6
    s_nop 0
    buffer_load_dwordx4 v4, s[12:15], s3 offen nt lds
    s_add_u32 s3, s3, 40960
    s_add_u32 s6, s6, 4096
    s_mov_b32 m0, s6
    s_nop 0
    buffer_load_dwordx4 v4, s[12:15], s3 offen nt lds
    s_add_u32 s3, s3, 40960
    s_add_u32 s6, s6, 4096
    s_mov_b32 m0, s6
    s_nop 0
    buffer_load_dwordx4 v4, s[12:15], s3 offen nt lds
    s_add_u32 s3, s3, 40960
    s_add_u32 s6, s6, 4096
    s_mov_b32 m0, s6
    s_nop 0
    buffer_load_dwordx4 v4, s[12:15], s3 offen nt lds
    s_add_u32 s3, s3, 40960
    s_add_u32 s6, s6, 4096
    s_mov_b32 m0, s6
    s_nop 0
    buffer_load_dwordx4 v4, s[12:15], s3 offen nt lds
    s_add_u32 s3, s3, 40960
    s_add_u32 s6, s6, 4096
    s_mov_b32 m0, s6
    s_nop 0
    buffer_load_dwordx4 v4, s[12:15], s3 offen nt lds
    s_add_u32 s3, s3, 40960
    s_add_u32 s6, s6, 4096
    s_mov_b32 m0, s6
    s_nop 0
    buffer_load_dwordx4 v4, s[12:15], s3 offen nt lds
    s_add_u32 s3, s3, 40960
    s_add_u32 s6, s6, 4096
    s_mov_b32 m0, s6
    s_nop 0
    buffer_load_dwordx4 v4, s[12:15], s3 offen nt lds
    s_add_u32 s3, s3, 40960
    s_add_u32 s6, s6, 4096
    s_mov_b32 m0, s6
    s_nop 0
    buffer_load_dwordx4 v4, s[12:15], s3 offen nt lds
    s_add_u32 s3, s3, 40960
    s_add_u32 s6, s6, 4096
    s_mov_b32 m0, s6
    s_nop 0
    buffer_load_dwordx4 v4, s[12:15], s3 offen nt lds
    s_add_u32 s3, s3, 40960
    s_add_u32 s6, s6, 4096
    s_mov_b32 m0, s6
    s_nop 0
    buffer_load_dwordx4 v4, s[12:15], s3 offen nt lds
    s_add_u32 s3, s3, 40960
    s_add_u32 s6, s6, 4096
    s_mov_b32 m0, s6
    s_nop 0
    buffer_load_dwordx4 v4, s[12:15], s3 offen nt lds
    s_add_u32 s3, s3, 40960
    s_add_u32 s6, s6, 4096
    s_mov_b32 m0, s6
    s_nop 0
    buffer_load_dwordx4 v4, s[12:15], s3 offen nt lds
    s_add_u32 s3, s3, 40960
    s_add_u32 s6, s6, 4096
    s_mov_b32 m0, s6
    s_nop 0
    buffer_load_dwordx4 v4, s[12:15], s3 offen nt lds
    s_add_u32 s3, s3, 40960
    s_add_u32 s6, s6, 4096
    s_mov_b32 m0, s6
    s_nop 0
    buffer_load_dwordx4 v4, s[12:15], s3 offen nt lds
    s_add_u32 s3, s3, 40960
    s_add_u32 s6, s6, 4096
    s_mov_b32 m0, s6
    s_nop 0
    buffer_load_dwordx4 v4, s[12:15], s3 offen nt lds
    s_add_u32 s3, s3, 40960
    s_add_u32 s6, s6, 4096
    s_mov_b32 m0, s6
    s_nop 0
    buffer_load_dwordx4 v4, s[12:15], s3 offen nt lds
    s_add_u32 s3, s3, 40960
    s_add_u32 s6, s6, 4096
    s_mov_b32 m0, s6
    s_nop 0
    buffer_load_dwordx4 v4, s[12:15], s3 offen nt lds
    s_add_u32 s3, s3, 40960
    s_add_u32 s6, s6, 4096
    s_mov_b32 m0, s6
    s_nop 0
    buffer_load_dwordx4 v4, s[12:15], s3 offen nt lds
    s_add_u32 s3, s3, 40960
    s_add_u32 s6, s6, 4096
    s_mov_b32 m0, s6
    s_nop 0
    buffer_load_dwordx4 v4, s[12:15], s3 offen nt lds
    s_add_u32 s3, s3, 40960
    s_add_u32 s6, s6, 4096
    s_mov_b32 m0, s6
    s_nop 0
    buffer_load_dwordx4 v4, s[12:15], s3 offen nt lds
    s_add_u32 s3, s3, 40960
    s_add_u32 s6, s6, 4096
    s_mov_b32 m0, s6
    s_nop 0
    buffer_load_dwordx4 v4, s[12:15], s3 offen nt lds
    s_add_u32 s3, s3, 40960
    s_add_u32 s6, s6, 4096
    s_mov_b32 m0, s6
    s_nop 0
    buffer_load_dwordx4 v4, s[12:15], s3 offen nt lds
    s_add_u32 s3, s3, 40960
    s_add_u32 s6, s6, 4096
    s_mov_b32 m0, s6
    s_nop 0
    buffer_load_dwordx4 v4, s[12:15], s3 offen nt lds
    s_branch WR_C
PRO_F:
    s_lshl_b32 s33, s27, 2
    s_add_u32 s33, s33, s28
    s_sub_u32 s33, s33, 28
    v_and_b32 v4, 7, v0
    s_lshl_b32 s3, s26, 3
    v_add_u32 v4, s3, v4
    v_mul_u32_u24 v4, 40960, v4
    v_lshrrev_b32 v5, 3, v0
    v_lshlrev_b32 v5, 5, v5
    v_add_u32 v4, v4, v5
    s_mul_i32 s3, s33, 1280
    v_add_u32 v4, s3, v4
    buffer_load_dwordx4 v[200:203], v4, s[20:23], 0 offen offset:0
    buffer_load_dwordx4 v[204:207], v4, s[20:23], 0 offen offset:16
    buffer_load_dwordx4 v[208:211], v4, s[20:23], 0 offen offset:256
    buffer_load_dwordx4 v[212:215], v4, s[20:23], 0 offen offset:272
    buffer_load_dwordx4 v[216:219], v4, s[20:23], 0 offen offset:512
    buffer_load_dwordx4 v[220:223], v4, s[20:23], 0 offen offset:528
    buffer_load_dwordx4 v[224:227], v4, s[20:23], 0 offen offset:768
    buffer_load_dwordx4 v[228:231], v4, s[20:23], 0 offen offset:784
    buffer_load_dwordx4 v[232:235], v4, s[20:23], 0 offen offset:1024
    buffer_load_dwordx4 v[236:239], v4, s[20:23], 0 offen offset:1040
    s_barrier
    s_cmp_lg_u32 s26, 7
    s_cbranch_scc1 PRO_F1
    s_cmp_lg_u32 s31, 0
    s_cbranch_scc1 PRO_F1
    s_waitcnt vmcnt(10)
    v_readfirstlane_b32 s88, v10
    v_readfirstlane_b32 s3, v11
    s_lshr_b32 s3, s3, s28
    s_and_b32 s3, s3, 1
    s_lshl_b32 s3, s3, 12
    s_cmp_lt_u32 s88, 32
    s_cselect_b32 s89, 1, 4194305
    s_add_u32 s89, s89, s3
    v_mov_b32 v12, 16
    v_mov_b32 v13, s89
    s_mov_b64 exec, 1
    global_atomic_add v14, v12, v13, s[84:85] sc0 sc1
    s_mov_b64 exec, -1
    s_waitcnt vmcnt(0)
    v_readfirstlane_b32 s4, v14
    s_add_u32 s3, s89, s4
    s_and_b32 s4, s3, 0xfff
    s_cmp_lg_u32 s4, 256
    s_cbranch_scc1 PUB_1
    s_cmp_eq_u32 s3, 256
    s_cselect_b32 s4, 1, 3
    s_cmp_lt_u32 s3, 4194304
    s_cselect_b32 s4, s4, 2
    v_mov_b32 v12, 16
    v_mov_b32 v13, s4
    s_mov_b64 exec, 1
    global_store_dword v12, v13, s[84:85] offset:128 sc1
    s_mov_b64 exec, -1
PUB_1:
PRO_F1:
    s_setprio 0
    s_waitcnt vmcnt(0)
    v_lshlrev_b32 v64, 16, v200
    v_and_b32 v65, 0xffff0000, v200
    v_lshlrev_b32 v66, 16, v201
    v_and_b32 v67, 0xffff0000, v201
    v_lshlrev_b32 v68, 16, v202
    v_and_b32 v69, 0xffff0000, v202
    v_lshlrev_b32 v70, 16, v203
    v_and_b32 v71, 0xffff0000, v203
    v_lshlrev_b32 v72, 16, v204
    v_and_b32 v73, 0xffff0000, v204
    v_lshlrev_b32 v74, 16, v205
    v_and_b32 v75, 0xffff0000, v205
    v_lshlrev_b32 v76, 16, v206
    v_and_b32 v77, 0xffff0000, v206
    v_lshlrev_b32 v78, 16, v207
    v_and_b32 v79, 0xffff0000, v207
    v_lshlrev_b32 v80, 16, v208
    v_and_b32 v81, 0xffff0000, v208
    v_lshlrev_b32 v82, 16, v209
    v_and_b32 v83, 0xffff0000, v209
    v_lshlrev_b32 v84, 16, v210
    v_and_b32 v85, 0xffff0000, v210
    v_lshlrev_b32 v86, 16, v211
    v_and_b32 v87, 0xffff0000, v211
    v_lshlrev_b32 v88, 16, v212
    v_and_b32 v89, 0xffff0000, v212
    v_lshlrev_b32 v90, 16, v213
    v_and_b32 v91, 0xffff0000, v213
    v_lshlrev_b32 v92, 16, v214
    v_and_b32 v93, 0xffff0000, v214
    v_lshlrev_b32 v94, 16, v215
    v_and_b32 v95, 0xffff0000, v215
    v_lshlrev_b32 v96, 16, v216
    v_and_b32 v97, 0xffff0000, v216
    v_lshlrev_b32 v98, 16, v217
    v_and_b32 v99, 0xffff0000, v217
    v_lshlrev_b32 v100, 16, v218
    v_and_b32 v101, 0xffff0000, v218
    v_lshlrev_b32 v102, 16, v219
    v_and_b32 v103, 0xffff0000, v219
    v_lshlrev_b32 v104, 16, v220
    v_and_b32 v105, 0xffff0000, v220
    v_lshlrev_b32 v106, 16, v221
    v_and_b32 v107, 0xffff0000, v221
    v_lshlrev_b32 v108, 16, v222
    v_and_b32 v109, 0xffff0000, v222
    v_lshlrev_b32 v110, 16, v223
    v_and_b32 v111, 0xffff0000, v223
    v_lshlrev_b32 v112, 16, v224
    v_and_b32 v113, 0xffff0000, v224
    v_lshlrev_b32 v114, 16, v225
    v_and_b32 v115, 0xffff0000, v225
    v_lshlrev_b32 v116, 16, v226
    v_and_b32 v117, 0xffff0000, v226
    v_lshlrev_b32 v118, 16, v227
    v_and_b32 v119, 0xffff0000, v227
    v_lshlrev_b32 v120, 16, v228
    v_and_b32 v121, 0xffff0000, v228
    v_lshlrev_b32 v122, 16, v229
    v_and_b32 v123, 0xffff0000, v229
    v_lshlrev_b32 v124, 16, v230
    v_and_b32 v125, 0xffff0000, v230
    v_lshlrev_b32 v126, 16, v231
    v_and_b32 v127, 0xffff0000, v231
    v_lshlrev_b32 v128, 16, v232
    v_and_b32 v129, 0xffff0000, v232
    v_lshlrev_b32 v130, 16, v233
    v_and_b32 v131, 0xffff0000, v233
    v_lshlrev_b32 v132, 16, v234
    v_and_b32 v133, 0xffff0000, v234
    v_lshlrev_b32 v134, 16, v235
    v_and_b32 v135, 0xffff0000, v235
    v_lshlrev_b32 v136, 16, v236
    v_and_b32 v137, 0xffff0000, v236
    v_lshlrev_b32 v138, 16, v237
    v_and_b32 v139, 0xffff0000, v237
    v_lshlrev_b32 v140, 16, v238
    v_and_b32 v141, 0xffff0000, v238
    v_lshlrev_b32 v142, 16, v239
    v_and_b32 v143, 0xffff0000, v239
    v_pk_add_f32 v[144:145], v[64:65], v[66:67]
    v_pk_add_f32 v[146:147], v[68:69], v[70:71]
    v_pk_add_f32 v[144:145], v[144:145], v[72:73]
    v_pk_add_f32 v[146:147], v[146:147], v[74:75]
    v_pk_add_f32 v[144:145], v[144:145], v[76:77]
    v_pk_add_f32 v[146:147], v[146:147], v[78:79]
    v_pk_add_f32 v[144:145], v[144:145], v[80:81]
    v_pk_add_f32 v[146:147], v[146:147], v[82:83]
    v_pk_add_f32 v[144:145], v[144:145], v[84:85]
    v_pk_add_f32 v[146:147], v[146:147], v[86:87]
    v_pk_add_f32 v[144:145], v[144:145], v[88:89]
    v_pk_add_f32 v[146:147], v[146:147], v[90:91]
    v_pk_add_f32 v[144:145], v[144:145], v[92:93]
    v_pk_add_f32 v[146:147], v[146:147], v[94:95]
    v_pk_add_f32 v[144:145], v[144:145], v[96:97]
    v_pk_add_f32 v[146:147], v[146:147], v[98:99]
    v_pk_add_f32 v[144:145], v[144:145], v[100:101]
    v_pk_add_f32 v[146:147], v[146:147], v[102:103]
    v_pk_add_f32 v[144:145], v[144:145], v[104:105]
    v_pk_add_f32 v[146:147], v[146:147], v[106:107]
    v_pk_add_f32 v[144:145], v[144:145], v[108:109]
    v_pk_add_f32 v[146:147], v[146:147], v[110:111]
    v_pk_add_f32 v[144:145], v[144:145], v[112:113]
    v_pk_add_f32 v[146:147], v[146:147], v[114:115]
    v_pk_add_f32 v[144:145], v[144:145], v[116:117]
    v_pk_add_f32 v[146:147], v[146:147], v[118:119]
    v_pk_add_f32 v[144:145], v[144:145], v[120:121]
    v_pk_add_f32 v[146:147], v[146:147], v[122:123]
    v_pk_add_f32 v[144:145], v[144:145], v[124:125]
    v_pk_add_f32 v[146:147], v[146:147], v[126:127]
    v_pk_add_f32 v[144:145], v[144:145], v[128:129]
    v_pk_add_f32 v[146:147], v[146:147], v[130:131]
    v_pk_add_f32 v[144:145], v[144:145], v[132:133]
    v_pk_add_f32 v[146:147], v[146:147], v[134:135]
    v_pk_add_f32 v[144:145], v[144:145], v[136:137]
    v_pk_add_f32 v[146:147], v[146:147], v[138:139]
    v_pk_add_f32 v[144:145], v[144:145], v[140:141]
    v_pk_add_f32 v[146:147], v[146:147], v[142:143]
    v_pk_add_f32 v[144:145], v[144:145], v[146:147]
    v_add_f32 v144, v144, v145
    s_nop 1
    v_add_f32_dpp v144, v144, v144 row_ror:8 row_mask:0xf bank_mask:0xf
    v_mov_b32 v145, v144
    s_nop 1
    v_permlane16_swap_b32 v144, v145
    v_add_f32 v144, v144, v145
    v_mov_b32 v145, v144
    s_nop 1
    v_permlane32_swap_b32 v144, v145
    v_add_f32 v144, v144, v145
    v_mul_f32 v144, 0x3acccccd, v144
    v_pk_add_f32 v[146:147], v[64:65], v[144:145] op_sel_hi:[1,0] neg_lo:[0,1] neg_hi:[0,1]
    s_nop 0
    v_pk_mul_f32 v[150:151], v[146:147], v[146:147]
    v_pk_add_f32 v[148:149], v[66:67], v[144:145] op_sel_hi:[1,0] neg_lo:[0,1] neg_hi:[0,1]
    s_nop 0
    v_pk_mul_f32 v[152:153], v[148:149], v[148:149]
    v_pk_add_f32 v[146:147], v[68:69], v[144:145] op_sel_hi:[1,0] neg_lo:[0,1] neg_hi:[0,1]
    s_nop 0
    v_pk_fma_f32 v[150:151], v[146:147], v[146:147], v[150:151]
    v_pk_add_f32 v[148:149], v[70:71], v[144:145] op_sel_hi:[1,0] neg_lo:[0,1] neg_hi:[0,1]
    s_nop 0
    v_pk_fma_f32 v[152:153], v[148:149], v[148:149], v[152:153]
    v_pk_add_f32 v[146:147], v[72:73], v[144:145] op_sel_hi:[1,0] neg_lo:[0,1] neg_hi:[0,1]
    s_nop 0
    v_pk_fma_f32 v[150:151], v[146:147], v[146:147], v[150:151]
    v_pk_add_f32 v[148:149], v[74:75], v[144:145] op_sel_hi:[1,0] neg_lo:[0,1] neg_hi:[0,1]
    s_nop 0
    v_pk_fma_f32 v[152:153], v[148:149], v[148:149], v[152:153]
    v_pk_add_f32 v[146:147], v[76:77], v[144:145] op_sel_hi:[1,0] neg_lo:[0,1] neg_hi:[0,1]
    s_nop 0
    v_pk_fma_f32 v[150:151], v[146:147], v[146:147], v[150:151]
    v_pk_add_f32 v[148:149], v[78:79], v[144:145] op_sel_hi:[1,0] neg_lo:[0,1] neg_hi:[0,1]
    s_nop 0
    v_pk_fma_f32 v[152:153], v[148:149], v[148:149], v[152:153]
    v_pk_add_f32 v[146:147], v[80:81], v[144:145] op_sel_hi:[1,0] neg_lo:[0,1] neg_hi:[0,1]
    s_nop 0
    v_pk_fma_f32 v[150:151], v[146:147], v[146:147], v[150:151]
    v_pk_add_f32 v[148:149], v[82:83], v[144:145] op_sel_hi:[1,0] neg_lo:[0,1] neg_hi:[0,1]
    s_nop 0
    v_pk_fma_f32 v[152:153], v[148:149], v[148:149], v[152:153]
    v_pk_add_f32 v[146:147], v[84:85], v[144:145] op_sel_hi:[1,0] neg_lo:[0,1] neg_hi:[0,1]
    s_nop 0
    v_pk_fma_f32 v[150:151], v[146:147], v[146:147], v[150:151]
    v_pk_add_f32 v[148:149], v[86:87], v[144:145] op_sel_hi:[1,0] neg_lo:[0,1] neg_hi:[0,1]
    s_nop 0
    v_pk_fma_f32 v[152:153], v[148:149], v[148:149], v[152:153]
    v_pk_add_f32 v[146:147], v[88:89], v[144:145] op_sel_hi:[1,0] neg_lo:[0,1] neg_hi:[0,1]
    s_nop 0
    v_pk_fma_f32 v[150:151], v[146:147], v[146:147], v[150:151]
    v_pk_add_f32 v[148:149], v[90:91], v[144:145] op_sel_hi:[1,0] neg_lo:[0,1] neg_hi:[0,1]
    s_nop 0
    v_pk_fma_f32 v[152:153], v[148:149], v[148:149], v[152:153]
    v_pk_add_f32 v[146:147], v[92:93], v[144:145] op_sel_hi:[1,0] neg_lo:[0,1] neg_hi:[0,1]
    s_nop 0
    v_pk_fma_f32 v[150:151], v[146:147], v[146:147], v[150:151]
    v_pk_add_f32 v[148:149], v[94:95], v[144:145] op_sel_hi:[1,0] neg_lo:[0,1] neg_hi:[0,1]
    s_nop 0
    v_pk_fma_f32 v[152:153], v[148:149], v[148:149], v[152:153]
    v_pk_add_f32 v[146:147], v[96:97], v[144:145] op_sel_hi:[1,0] neg_lo:[0,1] neg_hi:[0,1]
    s_nop 0
    v_pk_fma_f32 v[150:151], v[146:147], v[146:147], v[150:151]
    v_pk_add_f32 v[148:149], v[98:99], v[144:145] op_sel_hi:[1,0] neg_lo:[0,1] neg_hi:[0,1]
    s_nop 0
    v_pk_fma_f32 v[152:153], v[148:149], v[148:149], v[152:153]
    v_pk_add_f32 v[146:147], v[100:101], v[144:145] op_sel_hi:[1,0] neg_lo:[0,1] neg_hi:[0,1]
    s_nop 0
    v_pk_fma_f32 v[150:151], v[146:147], v[146:147], v[150:151]
    v_pk_add_f32 v[148:149], v[102:103], v[144:145] op_sel_hi:[1,0] neg_lo:[0,1] neg_hi:[0,1]
    s_nop 0
    v_pk_fma_f32 v[152:153], v[148:149], v[148:149], v[152:153]
    v_pk_add_f32 v[146:147], v[104:105], v[144:145] op_sel_hi:[1,0] neg_lo:[0,1] neg_hi:[0,1]
    s_nop 0
    v_pk_fma_f32 v[150:151], v[146:147], v[146:147], v[150:151]
    v_pk_add_f32 v[148:149], v[106:107], v[144:145] op_sel_hi:[1,0] neg_lo:[0,1] neg_hi:[0,1]
    s_nop 0
    v_pk_fma_f32 v[152:153], v[148:149], v[148:149], v[152:153]
    v_pk_add_f32 v[146:147], v[108:109], v[144:145] op_sel_hi:[1,0] neg_lo:[0,1] neg_hi:[0,1]
    s_nop 0
    v_pk_fma_f32 v[150:151], v[146:147], v[146:147], v[150:151]
    v_pk_add_f32 v[148:149], v[110:111], v[144:145] op_sel_hi:[1,0] neg_lo:[0,1] neg_hi:[0,1]
    s_nop 0
    v_pk_fma_f32 v[152:153], v[148:149], v[148:149], v[152:153]
    v_pk_add_f32 v[146:147], v[112:113], v[144:145] op_sel_hi:[1,0] neg_lo:[0,1] neg_hi:[0,1]
    s_nop 0
    v_pk_fma_f32 v[150:151], v[146:147], v[146:147], v[150:151]
    v_pk_add_f32 v[148:149], v[114:115], v[144:145] op_sel_hi:[1,0] neg_lo:[0,1] neg_hi:[0,1]
    s_nop 0
    v_pk_fma_f32 v[152:153], v[148:149], v[148:149], v[152:153]
    v_pk_add_f32 v[146:147], v[116:117], v[144:145] op_sel_hi:[1,0] neg_lo:[0,1] neg_hi:[0,1]
    s_nop 0
    v_pk_fma_f32 v[150:151], v[146:147], v[146:147], v[150:151]
    v_pk_add_f32 v[148:149], v[118:119], v[144:145] op_sel_hi:[1,0] neg_lo:[0,1] neg_hi:[0,1]
    s_nop 0
    v_pk_fma_f32 v[152:153], v[148:149], v[148:149], v[152:153]
    v_pk_add_f32 v[146:147], v[120:121], v[144:145] op_sel_hi:[1,0] neg_lo:[0,1] neg_hi:[0,1]
    s_nop 0
    v_pk_fma_f32 v[150:151], v[146:147], v[146:147], v[150:151]
    v_pk_add_f32 v[148:149], v[122:123], v[144:145] op_sel_hi:[1,0] neg_lo:[0,1] neg_hi:[0,1]
    s_nop 0
    v_pk_fma_f32 v[152:153], v[148:149], v[148:149], v[152:153]
    v_pk_add_f32 v[146:147], v[124:125], v[144:145] op_sel_hi:[1,0] neg_lo:[0,1] neg_hi:[0,1]
    s_nop 0
    v_pk_fma_f32 v[150:151], v[146:147], v[146:147], v[150:151]
    v_pk_add_f32 v[148:149], v[126:127], v[144:145] op_sel_hi:[1,0] neg_lo:[0,1] neg_hi:[0,1]
    s_nop 0
    v_pk_fma_f32 v[152:153], v[148:149], v[148:149], v[152:153]
    v_pk_add_f32 v[146:147], v[128:129], v[144:145] op_sel_hi:[1,0] neg_lo:[0,1] neg_hi:[0,1]
    s_nop 0
    v_pk_fma_f32 v[150:151], v[146:147], v[146:147], v[150:151]
    v_pk_add_f32 v[148:149], v[130:131], v[144:145] op_sel_hi:[1,0] neg_lo:[0,1] neg_hi:[0,1]
    s_nop 0
    v_pk_fma_f32 v[152:153], v[148:149], v[148:149], v[152:153]
    v_pk_add_f32 v[146:147], v[132:133], v[144:145] op_sel_hi:[1,0] neg_lo:[0,1] neg_hi:[0,1]
    s_nop 0
    v_pk_fma_f32 v[150:151], v[146:147], v[146:147], v[150:151]
    v_pk_add_f32 v[148:149], v[134:135], v[144:145] op_sel_hi:[1,0] neg_lo:[0,1] neg_hi:[0,1]
    s_nop 0
    v_pk_fma_f32 v[152:153], v[148:149], v[148:149], v[152:153]
    v_pk_add_f32 v[146:147], v[136:137], v[144:145] op_sel_hi:[1,0] neg_lo:[0,1] neg_hi:[0,1]
    s_nop 0
    v_pk_fma_f32 v[150:151], v[146:147], v[146:147], v[150:151]
    v_pk_add_f32 v[148:149], v[138:139], v[144:145] op_sel_hi:[1,0] neg_lo:[0,1] neg_hi:[0,1]
    s_nop 0
    v_pk_fma_f32 v[152:153], v[148:149], v[148:149], v[152:153]
    v_pk_add_f32 v[146:147], v[140:141], v[144:145] op_sel_hi:[1,0] neg_lo:[0,1] neg_hi:[0,1]
    s_nop 0
    v_pk_fma_f32 v[150:151], v[146:147], v[146:147], v[150:151]
    v_pk_add_f32 v[148:149], v[142:143], v[144:145] op_sel_hi:[1,0] neg_lo:[0,1] neg_hi:[0,1]
    s_nop 0
    v_pk_fma_f32 v[152:153], v[148:149], v[148:149], v[152:153]
    v_pk_add_f32 v[150:151], v[150:151], v[152:153]
    v_add_f32 v146, v150, v151
    s_nop 1
    v_add_f32_dpp v146, v146, v146 row_ror:8 row_mask:0xf bank_mask:0xf
    v_mov_b32 v147, v146
    s_nop 1
    v_permlane16_swap_b32 v146, v147
    v_add_f32 v146, v146, v147
    v_mov_b32 v147, v146
    s_nop 1
    v_permlane32_swap_b32 v146, v147
    v_add_f32 v146, v146, v147
    v_mul_f32 v146, 0x3acccccd, v146
    v_cvt_pk_bf16_f32 v146, v146, v146
    v_lshlrev_b32 v146, 16, v146
    v_add_f32 v146, 0x3727c5ac, v146
    v_cvt_pk_bf16_f32 v146, v146, v146
    v_lshlrev_b32 v146, 16, v146
    v_sqrt_f32 v146, v146
    s_nop 0
    v_cvt_pk_bf16_f32 v146, v146, v146
    v_lshlrev_b32 v146, 16, v146
    v_rcp_f32 v146, v146
    v_cvt_pk_bf16_f32 v144, v144, v144
    v_lshlrev_b32 v144, 16, v144
    v_pk_add_f32 v[148:149], v[64:65], v[144:145] op_sel_hi:[1,0] neg_lo:[0,1] neg_hi:[0,1]
    s_nop 0
    v_cvt_pk_bf16_f32 v148, v148, v149
    v_and_b32 v149, 0xffff0000, v148
    v_lshlrev_b32 v148, 16, v148
    v_pk_mul_f32 v[148:149], v[148:149], v[146:147] op_sel_hi:[1,0]
    s_nop 0
    v_cvt_pk_bf16_f32 v16, v148, v149
    v_pk_add_f32 v[150:151], v[66:67], v[144:145] op_sel_hi:[1,0] neg_lo:[0,1] neg_hi:[0,1]
    s_nop 0
    v_cvt_pk_bf16_f32 v150, v150, v151
    v_and_b32 v151, 0xffff0000, v150
    v_lshlrev_b32 v150, 16, v150
    v_pk_mul_f32 v[150:151], v[150:151], v[146:147] op_sel_hi:[1,0]
    s_nop 0
    v_cvt_pk_bf16_f32 v17, v150, v151
    v_pk_add_f32 v[148:149], v[68:69], v[144:145] op_sel_hi:[1,0] neg_lo:[0,1] neg_hi:[0,1]
    s_nop 0
    v_cvt_pk_bf16_f32 v148, v148, v149
    v_and_b32 v149, 0xffff0000, v148
    v_lshlrev_b32 v148, 16, v148
    v_pk_mul_f32 v[148:149], v[148:149], v[146:147] op_sel_hi:[1,0]
    s_nop 0
    v_cvt_pk_bf16_f32 v18, v148, v149
    v_pk_add_f32 v[150:151], v[70:71], v[144:145] op_sel_hi:[1,0] neg_lo:[0,1] neg_hi:[0,1]
    s_nop 0
    v_cvt_pk_bf16_f32 v150, v150, v151
    v_and_b32 v151, 0xffff0000, v150
    v_lshlrev_b32 v150, 16, v150
    v_pk_mul_f32 v[150:151], v[150:151], v[146:147] op_sel_hi:[1,0]
    s_nop 0
    v_cvt_pk_bf16_f32 v19, v150, v151
    v_pk_add_f32 v[148:149], v[72:73], v[144:145] op_sel_hi:[1,0] neg_lo:[0,1] neg_hi:[0,1]
    s_nop 0
    v_cvt_pk_bf16_f32 v148, v148, v149
    v_and_b32 v149, 0xffff0000, v148
    v_lshlrev_b32 v148, 16, v148
    v_pk_mul_f32 v[148:149], v[148:149], v[146:147] op_sel_hi:[1,0]
    s_nop 0
    v_cvt_pk_bf16_f32 v20, v148, v149
    v_pk_add_f32 v[150:151], v[74:75], v[144:145] op_sel_hi:[1,0] neg_lo:[0,1] neg_hi:[0,1]
    s_nop 0
    v_cvt_pk_bf16_f32 v150, v150, v151
    v_and_b32 v151, 0xffff0000, v150
    v_lshlrev_b32 v150, 16, v150
    v_pk_mul_f32 v[150:151], v[150:151], v[146:147] op_sel_hi:[1,0]
    s_nop 0
    v_cvt_pk_bf16_f32 v21, v150, v151
    v_pk_add_f32 v[148:149], v[76:77], v[144:145] op_sel_hi:[1,0] neg_lo:[0,1] neg_hi:[0,1]
    s_nop 0
    v_cvt_pk_bf16_f32 v148, v148, v149
    v_and_b32 v149, 0xffff0000, v148
    v_lshlrev_b32 v148, 16, v148
    v_pk_mul_f32 v[148:149], v[148:149], v[146:147] op_sel_hi:[1,0]
    s_nop 0
    v_cvt_pk_bf16_f32 v22, v148, v149
    v_pk_add_f32 v[150:151], v[78:79], v[144:145] op_sel_hi:[1,0] neg_lo:[0,1] neg_hi:[0,1]
    s_nop 0
    v_cvt_pk_bf16_f32 v150, v150, v151
    v_and_b32 v151, 0xffff0000, v150
    v_lshlrev_b32 v150, 16, v150
    v_pk_mul_f32 v[150:151], v[150:151], v[146:147] op_sel_hi:[1,0]
    s_nop 0
    v_cvt_pk_bf16_f32 v23, v150, v151
    v_pk_add_f32 v[148:149], v[80:81], v[144:145] op_sel_hi:[1,0] neg_lo:[0,1] neg_hi:[0,1]
    s_nop 0
    v_cvt_pk_bf16_f32 v148, v148, v149
    v_and_b32 v149, 0xffff0000, v148
    v_lshlrev_b32 v148, 16, v148
    v_pk_mul_f32 v[148:149], v[148:149], v[146:147] op_sel_hi:[1,0]
    s_nop 0
    v_cvt_pk_bf16_f32 v24, v148, v149
    v_pk_add_f32 v[150:151], v[82:83], v[144:145] op_sel_hi:[1,0] neg_lo:[0,1] neg_hi:[0,1]
    s_nop 0
    v_cvt_pk_bf16_f32 v150, v150, v151
    v_and_b32 v151, 0xffff0000, v150
    v_lshlrev_b32 v150, 16, v150
    v_pk_mul_f32 v[150:151], v[150:151], v[146:147] op_sel_hi:[1,0]
    s_nop 0
    v_cvt_pk_bf16_f32 v25, v150, v151
    v_pk_add_f32 v[148:149], v[84:85], v[144:145] op_sel_hi:[1,0] neg_lo:[0,1] neg_hi:[0,1]
    s_nop 0
    v_cvt_pk_bf16_f32 v148, v148, v149
    v_and_b32 v149, 0xffff0000, v148
    v_lshlrev_b32 v148, 16, v148
    v_pk_mul_f32 v[148:149], v[148:149], v[146:147] op_sel_hi:[1,0]
    s_nop 0
    v_cvt_pk_bf16_f32 v26, v148, v149
    v_pk_add_f32 v[150:151], v[86:87], v[144:145] op_sel_hi:[1,0] neg_lo:[0,1] neg_hi:[0,1]
    s_nop 0
    v_cvt_pk_bf16_f32 v150, v150, v151
    v_and_b32 v151, 0xffff0000, v150
    v_lshlrev_b32 v150, 16, v150
    v_pk_mul_f32 v[150:151], v[150:151], v[146:147] op_sel_hi:[1,0]
    s_nop 0
    v_cvt_pk_bf16_f32 v27, v150, v151
    v_pk_add_f32 v[148:149], v[88:89], v[144:145] op_sel_hi:[1,0] neg_lo:[0,1] neg_hi:[0,1]
    s_nop 0
    v_cvt_pk_bf16_f32 v148, v148, v149
    v_and_b32 v149, 0xffff0000, v148
    v_lshlrev_b32 v148, 16, v148
    v_pk_mul_f32 v[148:149], v[148:149], v[146:147] op_sel_hi:[1,0]
    s_nop 0
    v_cvt_pk_bf16_f32 v28, v148, v149
    v_pk_add_f32 v[150:151], v[90:91], v[144:145] op_sel_hi:[1,0] neg_lo:[0,1] neg_hi:[0,1]
    s_nop 0
    v_cvt_pk_bf16_f32 v150, v150, v151
    v_and_b32 v151, 0xffff0000, v150
    v_lshlrev_b32 v150, 16, v150
    v_pk_mul_f32 v[150:151], v[150:151], v[146:147] op_sel_hi:[1,0]
    s_nop 0
    v_cvt_pk_bf16_f32 v29, v150, v151
    v_pk_add_f32 v[148:149], v[92:93], v[144:145] op_sel_hi:[1,0] neg_lo:[0,1] neg_hi:[0,1]
    s_nop 0
    v_cvt_pk_bf16_f32 v148, v148, v149
    v_and_b32 v149, 0xffff0000, v148
    v_lshlrev_b32 v148, 16, v148
    v_pk_mul_f32 v[148:149], v[148:149], v[146:147] op_sel_hi:[1,0]
    s_nop 0
    v_cvt_pk_bf16_f32 v30, v148, v149
    v_pk_add_f32 v[150:151], v[94:95], v[144:145] op_sel_hi:[1,0] neg_lo:[0,1] neg_hi:[0,1]
    s_nop 0
    v_cvt_pk_bf16_f32 v150, v150, v151
    v_and_b32 v151, 0xffff0000, v150
    v_lshlrev_b32 v150, 16, v150
    v_pk_mul_f32 v[150:151], v[150:151], v[146:147] op_sel_hi:[1,0]
    s_nop 0
    v_cvt_pk_bf16_f32 v31, v150, v151
    v_pk_add_f32 v[148:149], v[96:97], v[144:145] op_sel_hi:[1,0] neg_lo:[0,1] neg_hi:[0,1]
    s_nop 0
    v_cvt_pk_bf16_f32 v148, v148, v149
    v_and_b32 v149, 0xffff0000, v148
    v_lshlrev_b32 v148, 16, v148
    v_pk_mul_f32 v[148:149], v[148:149], v[146:147] op_sel_hi:[1,0]
    s_nop 0
    v_cvt_pk_bf16_f32 v32, v148, v149
    v_pk_add_f32 v[150:151], v[98:99], v[144:145] op_sel_hi:[1,0] neg_lo:[0,1] neg_hi:[0,1]
    s_nop 0
    v_cvt_pk_bf16_f32 v150, v150, v151
    v_and_b32 v151, 0xffff0000, v150
    v_lshlrev_b32 v150, 16, v150
    v_pk_mul_f32 v[150:151], v[150:151], v[146:147] op_sel_hi:[1,0]
    s_nop 0
    v_cvt_pk_bf16_f32 v33, v150, v151
    v_pk_add_f32 v[148:149], v[100:101], v[144:145] op_sel_hi:[1,0] neg_lo:[0,1] neg_hi:[0,1]
    s_nop 0
    v_cvt_pk_bf16_f32 v148, v148, v149
    v_and_b32 v149, 0xffff0000, v148
    v_lshlrev_b32 v148, 16, v148
    v_pk_mul_f32 v[148:149], v[148:149], v[146:147] op_sel_hi:[1,0]
    s_nop 0
    v_cvt_pk_bf16_f32 v34, v148, v149
    v_pk_add_f32 v[150:151], v[102:103], v[144:145] op_sel_hi:[1,0] neg_lo:[0,1] neg_hi:[0,1]
    s_nop 0
    v_cvt_pk_bf16_f32 v150, v150, v151
    v_and_b32 v151, 0xffff0000, v150
    v_lshlrev_b32 v150, 16, v150
    v_pk_mul_f32 v[150:151], v[150:151], v[146:147] op_sel_hi:[1,0]
    s_nop 0
    v_cvt_pk_bf16_f32 v35, v150, v151
    v_pk_add_f32 v[148:149], v[104:105], v[144:145] op_sel_hi:[1,0] neg_lo:[0,1] neg_hi:[0,1]
    s_nop 0
    v_cvt_pk_bf16_f32 v148, v148, v149
    v_and_b32 v149, 0xffff0000, v148
    v_lshlrev_b32 v148, 16, v148
    v_pk_mul_f32 v[148:149], v[148:149], v[146:147] op_sel_hi:[1,0]
    s_nop 0
    v_cvt_pk_bf16_f32 v36, v148, v149
    v_pk_add_f32 v[150:151], v[106:107], v[144:145] op_sel_hi:[1,0] neg_lo:[0,1] neg_hi:[0,1]
    s_nop 0
    v_cvt_pk_bf16_f32 v150, v150, v151
    v_and_b32 v151, 0xffff0000, v150
    v_lshlrev_b32 v150, 16, v150
    v_pk_mul_f32 v[150:151], v[150:151], v[146:147] op_sel_hi:[1,0]
    s_nop 0
    v_cvt_pk_bf16_f32 v37, v150, v151
    v_pk_add_f32 v[148:149], v[108:109], v[144:145] op_sel_hi:[1,0] neg_lo:[0,1] neg_hi:[0,1]
    s_nop 0
    v_cvt_pk_bf16_f32 v148, v148, v149
    v_and_b32 v149, 0xffff0000, v148
    v_lshlrev_b32 v148, 16, v148
    v_pk_mul_f32 v[148:149], v[148:149], v[146:147] op_sel_hi:[1,0]
    s_nop 0
    v_cvt_pk_bf16_f32 v38, v148, v149
    v_pk_add_f32 v[150:151], v[110:111], v[144:145] op_sel_hi:[1,0] neg_lo:[0,1] neg_hi:[0,1]
    s_nop 0
    v_cvt_pk_bf16_f32 v150, v150, v151
    v_and_b32 v151, 0xffff0000, v150
    v_lshlrev_b32 v150, 16, v150
    v_pk_mul_f32 v[150:151], v[150:151], v[146:147] op_sel_hi:[1,0]
    s_nop 0
    v_cvt_pk_bf16_f32 v39, v150, v151
    v_pk_add_f32 v[148:149], v[112:113], v[144:145] op_sel_hi:[1,0] neg_lo:[0,1] neg_hi:[0,1]
    s_nop 0
    v_cvt_pk_bf16_f32 v148, v148, v149
    v_and_b32 v149, 0xffff0000, v148
    v_lshlrev_b32 v148, 16, v148
    v_pk_mul_f32 v[148:149], v[148:149], v[146:147] op_sel_hi:[1,0]
    s_nop 0
    v_cvt_pk_bf16_f32 v40, v148, v149
    v_pk_add_f32 v[150:151], v[114:115], v[144:145] op_sel_hi:[1,0] neg_lo:[0,1] neg_hi:[0,1]
    s_nop 0
    v_cvt_pk_bf16_f32 v150, v150, v151
    v_and_b32 v151, 0xffff0000, v150
    v_lshlrev_b32 v150, 16, v150
    v_pk_mul_f32 v[150:151], v[150:151], v[146:147] op_sel_hi:[1,0]
    s_nop 0
    v_cvt_pk_bf16_f32 v41, v150, v151
    v_pk_add_f32 v[148:149], v[116:117], v[144:145] op_sel_hi:[1,0] neg_lo:[0,1] neg_hi:[0,1]
    s_nop 0
    v_cvt_pk_bf16_f32 v148, v148, v149
    v_and_b32 v149, 0xffff0000, v148
    v_lshlrev_b32 v148, 16, v148
    v_pk_mul_f32 v[148:149], v[148:149], v[146:147] op_sel_hi:[1,0]
    s_nop 0
    v_cvt_pk_bf16_f32 v42, v148, v149
    v_pk_add_f32 v[150:151], v[118:119], v[144:145] op_sel_hi:[1,0] neg_lo:[0,1] neg_hi:[0,1]
    s_nop 0
    v_cvt_pk_bf16_f32 v150, v150, v151
    v_and_b32 v151, 0xffff0000, v150
    v_lshlrev_b32 v150, 16, v150
    v_pk_mul_f32 v[150:151], v[150:151], v[146:147] op_sel_hi:[1,0]
    s_nop 0
    v_cvt_pk_bf16_f32 v43, v150, v151
    v_pk_add_f32 v[148:149], v[120:121], v[144:145] op_sel_hi:[1,0] neg_lo:[0,1] neg_hi:[0,1]
    s_nop 0
    v_cvt_pk_bf16_f32 v148, v148, v149
    v_and_b32 v149, 0xffff0000, v148
    v_lshlrev_b32 v148, 16, v148
    v_pk_mul_f32 v[148:149], v[148:149], v[146:147] op_sel_hi:[1,0]
    s_nop 0
    v_cvt_pk_bf16_f32 v44, v148, v149
    v_pk_add_f32 v[150:151], v[122:123], v[144:145] op_sel_hi:[1,0] neg_lo:[0,1] neg_hi:[0,1]
    s_nop 0
    v_cvt_pk_bf16_f32 v150, v150, v151
    v_and_b32 v151, 0xffff0000, v150
    v_lshlrev_b32 v150, 16, v150
    v_pk_mul_f32 v[150:151], v[150:151], v[146:147] op_sel_hi:[1,0]
    s_nop 0
    v_cvt_pk_bf16_f32 v45, v150, v151
    v_pk_add_f32 v[148:149], v[124:125], v[144:145] op_sel_hi:[1,0] neg_lo:[0,1] neg_hi:[0,1]
    s_nop 0
    v_cvt_pk_bf16_f32 v148, v148, v149
    v_and_b32 v149, 0xffff0000, v148
    v_lshlrev_b32 v148, 16, v148
    v_pk_mul_f32 v[148:149], v[148:149], v[146:147] op_sel_hi:[1,0]
    s_nop 0
    v_cvt_pk_bf16_f32 v46, v148, v149
    v_pk_add_f32 v[150:151], v[126:127], v[144:145] op_sel_hi:[1,0] neg_lo:[0,1] neg_hi:[0,1]
    s_nop 0
    v_cvt_pk_bf16_f32 v150, v150, v151
    v_and_b32 v151, 0xffff0000, v150
    v_lshlrev_b32 v150, 16, v150
    v_pk_mul_f32 v[150:151], v[150:151], v[146:147] op_sel_hi:[1,0]
    s_nop 0
    v_cvt_pk_bf16_f32 v47, v150, v151
    v_pk_add_f32 v[148:149], v[128:129], v[144:145] op_sel_hi:[1,0] neg_lo:[0,1] neg_hi:[0,1]
    s_nop 0
    v_cvt_pk_bf16_f32 v148, v148, v149
    v_and_b32 v149, 0xffff0000, v148
    v_lshlrev_b32 v148, 16, v148
    v_pk_mul_f32 v[148:149], v[148:149], v[146:147] op_sel_hi:[1,0]
    s_nop 0
    v_cvt_pk_bf16_f32 v48, v148, v149
    v_pk_add_f32 v[150:151], v[130:131], v[144:145] op_sel_hi:[1,0] neg_lo:[0,1] neg_hi:[0,1]
    s_nop 0
    v_cvt_pk_bf16_f32 v150, v150, v151
    v_and_b32 v151, 0xffff0000, v150
    v_lshlrev_b32 v150, 16, v150
    v_pk_mul_f32 v[150:151], v[150:151], v[146:147] op_sel_hi:[1,0]
    s_nop 0
    v_cvt_pk_bf16_f32 v49, v150, v151
    v_pk_add_f32 v[148:149], v[132:133], v[144:145] op_sel_hi:[1,0] neg_lo:[0,1] neg_hi:[0,1]
    s_nop 0
    v_cvt_pk_bf16_f32 v148, v148, v149
    v_and_b32 v149, 0xffff0000, v148
    v_lshlrev_b32 v148, 16, v148
    v_pk_mul_f32 v[148:149], v[148:149], v[146:147] op_sel_hi:[1,0]
    s_nop 0
    v_cvt_pk_bf16_f32 v50, v148, v149
    v_pk_add_f32 v[150:151], v[134:135], v[144:145] op_sel_hi:[1,0] neg_lo:[0,1] neg_hi:[0,1]
    s_nop 0
    v_cvt_pk_bf16_f32 v150, v150, v151
    v_and_b32 v151, 0xffff0000, v150
    v_lshlrev_b32 v150, 16, v150
    v_pk_mul_f32 v[150:151], v[150:151], v[146:147] op_sel_hi:[1,0]
    s_nop 0
    v_cvt_pk_bf16_f32 v51, v150, v151
    v_pk_add_f32 v[148:149], v[136:137], v[144:145] op_sel_hi:[1,0] neg_lo:[0,1] neg_hi:[0,1]
    s_nop 0
    v_cvt_pk_bf16_f32 v148, v148, v149
    v_and_b32 v149, 0xffff0000, v148
    v_lshlrev_b32 v148, 16, v148
    v_pk_mul_f32 v[148:149], v[148:149], v[146:147] op_sel_hi:[1,0]
    s_nop 0
    v_cvt_pk_bf16_f32 v52, v148, v149
    v_pk_add_f32 v[150:151], v[138:139], v[144:145] op_sel_hi:[1,0] neg_lo:[0,1] neg_hi:[0,1]
    s_nop 0
    v_cvt_pk_bf16_f32 v150, v150, v151
    v_and_b32 v151, 0xffff0000, v150
    v_lshlrev_b32 v150, 16, v150
    v_pk_mul_f32 v[150:151], v[150:151], v[146:147] op_sel_hi:[1,0]
    s_nop 0
    v_cvt_pk_bf16_f32 v53, v150, v151
    v_pk_add_f32 v[148:149], v[140:141], v[144:145] op_sel_hi:[1,0] neg_lo:[0,1] neg_hi:[0,1]
    s_nop 0
    v_cvt_pk_bf16_f32 v148, v148, v149
    v_and_b32 v149, 0xffff0000, v148
    v_lshlrev_b32 v148, 16, v148
    v_pk_mul_f32 v[148:149], v[148:149], v[146:147] op_sel_hi:[1,0]
    s_nop 0
    v_cvt_pk_bf16_f32 v54, v148, v149
    v_pk_add_f32 v[150:151], v[142:143], v[144:145] op_sel_hi:[1,0] neg_lo:[0,1] neg_hi:[0,1]
    s_nop 0
    v_cvt_pk_bf16_f32 v150, v150, v151
    v_and_b32 v151, 0xffff0000, v150
    v_lshlrev_b32 v150, 16, v150
    v_pk_mul_f32 v[150:151], v[150:151], v[146:147] op_sel_hi:[1,0]
    s_nop 0
    v_cvt_pk_bf16_f32 v55, v150, v151
    v_lshrrev_b32 v4, 3, v0
    v_lshlrev_b32 v4, 10, v4
    v_and_b32 v5, 7, v0
    v_lshl_add_u32 v4, v5, 4, v4
    s_lshr_b32 s3, s26, 2
    s_mul_i32 s3, s3, 40960
    s_and_b32 s4, s26, 3
    s_lshl_b32 s4, s4, 7
    s_add_u32 s3, s3, s4
    v_add_u32 v4, s3, v4
    ds_write_b128 v4, v[16:19] offset:0
    ds_write_b128 v4, v[20:23] offset:512
    ds_write_b128 v4, v[24:27] offset:8192
    ds_write_b128 v4, v[28:31] offset:8704
    ds_write_b128 v4, v[32:35] offset:16384
    ds_write_b128 v4, v[36:39] offset:16896
    ds_write_b128 v4, v[40:43] offset:24576
    ds_write_b128 v4, v[44:47] offset:25088
    ds_write_b128 v4, v[48:51] offset:32768
    ds_write_b128 v4, v[52:55] offset:33280
    s_waitcnt lgkmcnt(0)
    s_cmp_lg_u32 s26, 7
    s_cbranch_scc1 VW_2
    v_mov_b32 v62, 1
    s_cmp_lg_u32 s31, 0
    s_cbranch_scc1 VK_4
    v_mov_b32 v62, 2
    s_cmp_ge_u32 s88, 32
    s_cbranch_scc1 VK_4x
    v_mov_b32 v63, 16
VG_3:
    global_load_dword v62, v63, s[84:85] offset:128 sc1
    s_waitcnt vmcnt(0)
    v_cmp_ne_u32 vcc, 0, v62
    s_cbranch_vccnz VK_4
    s_sleep 40
    s_sub_u32 s30, s30, 1
    s_cbranch_scc0 VG_3
    s_branch END
VK_4x:
    v_mov_b32 v63, 16
VG_3x:
    global_load_dword v61, v63, s[84:85] offset:128 sc1
    s_waitcnt vmcnt(0)
    v_cmp_ne_u32 vcc, 0, v61
    s_cbranch_vccnz VK_4
    s_sleep 40
    s_sub_u32 s30, s30, 1
    s_cbranch_scc0 VG_3x
    s_branch END
VK_4:
    v_mov_b32 v63, 163832
    ds_write_b32 v63, v62
    s_waitcnt lgkmcnt(0)
VW_2:
    s_barrier
    v_mov_b32 v63, 163832
    ds_read_b32 v62, v63
    s_waitcnt lgkmcnt(0)
    v_readfirstlane_b32 s3, v62
    s_cmp_lg_u32 s3, 1
    s_cbranch_scc1 REROLE
    s_barrier
    s_branch GO
WR_P:
    v_lshrrev_b32 v4, 5, v0
    v_lshlrev_b32 v4, 4, v4
    v_bfe_u32 v5, v0, 4, 1
    v_lshl_add_u32 v4, v5, 2, v4
    v_bfe_u32 v6, v0, 2, 1
    v_add_u32 v4, v4, v6
    v_bfe_u32 v6, v0, 3, 1
    v_lshl_add_u32 v4, v6, 3, v4
    v_lshlrev_b32 v4, 7, v4
    v_lshl_add_u32 v5, v6, 1, v5
    v_and_b32 v6, 3, v0
    v_lshl_add_u32 v4, v6, 3, v4
    s_and_b32 s3, s26, 1
    s_lshl_b32 s3, s3, 1
    s_add_u32 s4, s3, 1
    s_lshr_b32 s5, s26, 1
    s_mul_i32 s5, s5, 40960
    s_mov_b32 s6, s5
    s_cmp_lt_u32 s28, 12
    s_cselect_b32 s3, s26, s3
    s_cselect_b32 s4, s26, s4
    s_cselect_b32 s5, 0, s5
    s_cselect_b32 s6, 40960, s6
    v_xor_b32 v6, s3, v5
    v_lshl_add_u32 v6, v6, 5, v4
    v_add_u32 v6, s5, v6
    v_add_u32 v8, 81920, v6
    v_xor_b32 v7, s4, v5
    v_lshl_add_u32 v7, v7, 5, v4
    v_add_u32 v7, s6, v7
    v_add_u32 v9, 81920, v7
    s_waitcnt vmcnt(20)
    s_barrier
    ds_read_b64_tr_b16 v[64:65], v6 offset:0
    ds_read_b64_tr_b16 v[66:67], v6 offset:256
    ds_read_b64_tr_b16 v[68:69], v6 offset:4096
    ds_read_b64_tr_b16 v[70:71], v6 offset:4352
    ds_read_b64_tr_b16 v[72:73], v7 offset:0
    ds_read_b64_tr_b16 v[74:75], v7 offset:256
    ds_read_b64_tr_b16 v[76:77], v7 offset:4096
    ds_read_b64_tr_b16 v[78:79], v7 offset:4352
    ds_read_b64_tr_b16 v[80:81], v6 offset:8192
    ds_read_b64_tr_b16 v[82:83], v6 offset:8448
    ds_read_b64_tr_b16 v[84:85], v6 offset:12288
    ds_read_b64_tr_b16 v[86:87], v6 offset:12544
    ds_read_b64_tr_b16 v[88:89], v7 offset:8192
    ds_read_b64_tr_b16 v[90:91], v7 offset:8448
    ds_read_b64_tr_b16 v[92:93], v7 offset:12288
    ds_read_b64_tr_b16 v[94:95], v7 offset:12544
    s_waitcnt lgkmcnt(8)
    ds_read_b64_tr_b16 v[96:97], v6 offset:16384
    ds_read_b64_tr_b16 v[98:99], v6 offset:16640
    ds_read_b64_tr_b16 v[100:101], v6 offset:20480
    ds_read_b64_tr_b16 v[102:103], v6 offset:20736
    ds_read_b64_tr_b16 v[104:105], v7 offset:16384
    ds_read_b64_tr_b16 v[106:107], v7 offset:16640
    ds_read_b64_tr_b16 v[108:109], v7 offset:20480
    ds_read_b64_tr_b16 v[110:111], v7 offset:20736
    s_waitcnt lgkmcnt(8)
    ds_read_b64_tr_b16 v[112:113], v6 offset:24576
    ds_read_b64_tr_b16 v[114:115], v6 offset:24832
    ds_read_b64_tr_b16 v[116:117], v6 offset:28672
    ds_read_b64_tr_b16 v[118:119], v6 offset:28928
    ds_read_b64_tr_b16 v[120:121], v7 offset:24576
    ds_read_b64_tr_b16 v[122:123], v7 offset:24832
    ds_read_b64_tr_b16 v[124:125], v7 offset:28672
    ds_read_b64_tr_b16 v[126:127], v7 offset:28928
    s_waitcnt lgkmcnt(8)
    ds_read_b64_tr_b16 v[128:129], v6 offset:32768
    ds_read_b64_tr_b16 v[130:131], v6 offset:33024
    ds_read_b64_tr_b16 v[132:133], v6 offset:36864
    ds_read_b64_tr_b16 v[134:135], v6 offset:37120
    ds_read_b64_tr_b16 v[136:137], v7 offset:32768
    ds_read_b64_tr_b16 v[138:139], v7 offset:33024
    ds_read_b64_tr_b16 v[140:141], v7 offset:36864
    ds_read_b64_tr_b16 v[142:143], v7 offset:37120
    s_waitcnt lgkmcnt(8)
    s_waitcnt lgkmcnt(0)
    s_barrier
    s_waitcnt vmcnt(0)
    s_barrier
    ds_read_b64_tr_b16 v[144:145], v8 offset:0
    ds_read_b64_tr_b16 v[146:147], v8 offset:256
    ds_read_b64_tr_b16 v[148:149], v8 offset:4096
    ds_read_b64_tr_b16 v[150:151], v8 offset:4352
    ds_read_b64_tr_b16 v[152:153], v9 offset:0
    ds_read_b64_tr_b16 v[154:155], v9 offset:256
    ds_read_b64_tr_b16 v[156:157], v9 offset:4096
    ds_read_b64_tr_b16 v[158:159], v9 offset:4352
    ds_read_b64_tr_b16 v[160:161], v8 offset:8192
    ds_read_b64_tr_b16 v[162:163], v8 offset:8448
    ds_read_b64_tr_b16 v[164:165], v8 offset:12288
    ds_read_b64_tr_b16 v[166:167], v8 offset:12544
    ds_read_b64_tr_b16 v[168:169], v9 offset:8192
    ds_read_b64_tr_b16 v[170:171], v9 offset:8448
    ds_read_b64_tr_b16 v[172:173], v9 offset:12288
    ds_read_b64_tr_b16 v[174:175], v9 offset:12544
    s_waitcnt lgkmcnt(8)
    ds_read_b64_tr_b16 v[176:177], v8 offset:16384
    ds_read_b64_tr_b16 v[178:179], v8 offset:16640
    ds_read_b64_tr_b16 v[180:181], v8 offset:20480
    ds_read_b64_tr_b16 v[182:183], v8 offset:20736
    ds_read_b64_tr_b16 v[184:185], v9 offset:16384
    ds_read_b64_tr_b16 v[186:187], v9 offset:16640
    ds_read_b64_tr_b16 v[188:189], v9 offset:20480
    ds_read_b64_tr_b16 v[190:191], v9 offset:20736
    s_waitcnt lgkmcnt(8)
    ds_read_b64_tr_b16 v[192:193], v8 offset:24576
    ds_read_b64_tr_b16 v[194:195], v8 offset:24832
    ds_read_b64_tr_b16 v[196:197], v8 offset:28672
    ds_read_b64_tr_b16 v[198:199], v8 offset:28928
    ds_read_b64_tr_b16 v[200:201], v9 offset:24576
    ds_read_b64_tr_b16 v[202:203], v9 offset:24832
    ds_read_b64_tr_b16 v[204:205], v9 offset:28672
    ds_read_b64_tr_b16 v[206:207], v9 offset:28928
    s_waitcnt lgkmcnt(8)
    ds_read_b64_tr_b16 v[208:209], v8 offset:32768
    ds_read_b64_tr_b16 v[210:211], v8 offset:33024
    ds_read_b64_tr_b16 v[212:213], v8 offset:36864
    ds_read_b64_tr_b16 v[214:215], v8 offset:37120
    ds_read_b64_tr_b16 v[216:217], v9 offset:32768
    ds_read_b64_tr_b16 v[218:219], v9 offset:33024
    ds_read_b64_tr_b16 v[220:221], v9 offset:36864
    ds_read_b64_tr_b16 v[222:223], v9 offset:37120
    s_waitcnt lgkmcnt(8)
    s_waitcnt lgkmcnt(0)
    s_barrier
    s_branch GO
WR_A:
    v_lshrrev_b32 v4, 4, v0
    v_lshlrev_b32 v4, 10, v4
    v_bfe_u32 v5, v0, 3, 1
    v_lshlrev_b32 v5, 9, v5
    v_and_b32 v6, 7, v0
    v_lshlrev_b32 v6, 4, v6
    v_add3_u32 v4, v4, v5, v6
    s_lshr_b32 s3, s14, 1
    s_mul_i32 s3, s3, 20480
    s_and_b32 s4, s14, 1
    s_lshl_b32 s4, s4, 7
    s_add_u32 s3, s3, s4
    v_add_u32 v4, s3, v4
    s_barrier
    s_barrier
    ds_write_b128 v4, v[160:163] offset:0
    ds_write_b128 v4, v[164:167] offset:256
    ds_write_b128 v4, v[168:171] offset:4096
    ds_write_b128 v4, v[172:175] offset:4352
    ds_write_b128 v4, v[176:179] offset:8192
    ds_write_b128 v4, v[180:183] offset:8448
    ds_write_b128 v4, v[184:187] offset:12288
    ds_write_b128 v4, v[188:191] offset:12544
    ds_write_b128 v4, v[192:195] offset:16384
    ds_write_b128 v4, v[196:199] offset:16640
    v_add_u32 v4, 40960, v4
    ds_write_b128 v4, v[212:215] offset:0
    ds_write_b128 v4, v[216:219] offset:256
    ds_write_b128 v4, v[220:223] offset:4096
    ds_write_b128 v4, v[224:227] offset:4352
    ds_write_b128 v4, v[228:231] offset:8192
    ds_write_b128 v4, v[232:235] offset:8448
    ds_write_b128 v4, v[236:239] offset:12288
    ds_write_b128 v4, v[240:243] offset:12544
    ds_write_b128 v4, v[244:247] offset:16384
    ds_write_b128 v4, v[248:251] offset:16640
    s_cmp_lg_u32 s26, 7
    s_cbranch_scc1 WR_A2
    s_cmp_lg_u32 s31, 0
    s_cbranch_scc1 WR_A2
    s_waitcnt vmcnt(0)
    v_readfirstlane_b32 s4, v14
    s_add_u32 s3, s89, s4
    s_and_b32 s4, s3, 0xfff
    s_cmp_lg_u32 s4, 256
    s_cbranch_scc1 PUB_5
    s_cmp_eq_u32 s3, 256
    s_cselect_b32 s4, 1, 3
    s_cmp_lt_u32 s3, 4194304
    s_cselect_b32 s4, s4, 2
    v_mov_b32 v12, 16
    v_mov_b32 v13, s4
    s_mov_b64 exec, 1
    global_store_dword v12, v13, s[84:85] offset:128 sc1
    s_mov_b64 exec, -1
PUB_5:
WR_A2:
    s_waitcnt vmcnt(0) lgkmcnt(0)
    s_barrier
    s_barrier
    s_branch GO
WR_C:
    v_lshrrev_b32 v4, 2, v0
    v_lshlrev_b32 v4, 7, v4
    v_and_b32 v5, 3, v0
    v_lshl_add_u32 v4, v5, 3, v4
    s_mul_i32 s3, s26, 24576
    v_add_u32 v4, s3, v4
    v_bfe_u32 v5, v0, 3, 2
    v_xor_b32 v6, 0, v5
    v_lshl_add_u32 v6, v6, 5, v4
    v_xor_b32 v7, 1, v5
    v_lshl_add_u32 v7, v7, 5, v4
    v_xor_b32 v8, 2, v5
    v_lshl_add_u32 v8, v8, 5, v4
    v_xor_b32 v9, 3, v5
    v_lshl_add_u32 v9, v9, 5, v4
    s_waitcnt vmcnt(0)
    s_barrier
    ds_read_b64_tr_b16 v[64:65], v6 offset:0
    ds_read_b64_tr_b16 v[66:67], v6 offset:2048
    ds_read_b64_tr_b16 v[68:69], v6 offset:4096
    ds_read_b64_tr_b16 v[70:71], v6 offset:6144
    ds_read_b64_tr_b16 v[72:73], v7 offset:0
    ds_read_b64_tr_b16 v[74:75], v7 offset:2048
    ds_read_b64_tr_b16 v[76:77], v7 offset:4096
    ds_read_b64_tr_b16 v[78:79], v7 offset:6144
    ds_read_b64_tr_b16 v[80:81], v8 offset:0
    ds_read_b64_tr_b16 v[82:83], v8 offset:2048
    ds_read_b64_tr_b16 v[84:85], v8 offset:4096
    ds_read_b64_tr_b16 v[86:87], v8 offset:6144
    ds_read_b64_tr_b16 v[88:89], v9 offset:0
    ds_read_b64_tr_b16 v[90:91], v9 offset:2048
    ds_read_b64_tr_b16 v[92:93], v9 offset:4096
    ds_read_b64_tr_b16 v[94:95], v9 offset:6144
    s_waitcnt lgkmcnt(8)
    ds_read_b64_tr_b16 v[96:97], v6 offset:8192
    ds_read_b64_tr_b16 v[98:99], v6 offset:10240
    ds_read_b64_tr_b16 v[100:101], v6 offset:12288
    ds_read_b64_tr_b16 v[102:103], v6 offset:14336
    ds_read_b64_tr_b16 v[104:105], v7 offset:8192
    ds_read_b64_tr_b16 v[106:107], v7 offset:10240
    ds_read_b64_tr_b16 v[108:109], v7 offset:12288
    ds_read_b64_tr_b16 v[110:111], v7 offset:14336
    s_waitcnt lgkmcnt(8)
    ds_read_b64_tr_b16 v[112:113], v8 offset:8192
    ds_read_b64_tr_b16 v[114:115], v8 offset:10240
    ds_read_b64_tr_b16 v[116:117], v8 offset:12288
    ds_read_b64_tr_b16 v[118:119], v8 offset:14336
    ds_read_b64_tr_b16 v[120:121], v9 offset:8192
    ds_read_b64_tr_b16 v[122:123], v9 offset:10240
    ds_read_b64_tr_b16 v[124:125], v9 offset:12288
    ds_read_b64_tr_b16 v[126:127], v9 offset:14336
    s_waitcnt lgkmcnt(8)
    ds_read_b64_tr_b16 v[128:129], v6 offset:16384
    ds_read_b64_tr_b16 v[130:131], v6 offset:18432
    ds_read_b64_tr_b16 v[132:133], v6 offset:20480
    ds_read_b64_tr_b16 v[134:135], v6 offset:22528
    ds_read_b64_tr_b16 v[136:137], v7 offset:16384
    ds_read_b64_tr_b16 v[138:139], v7 offset:18432
    ds_read_b64_tr_b16 v[140:141], v7 offset:20480
    ds_read_b64_tr_b16 v[142:143], v7 offset:22528
    s_waitcnt lgkmcnt(8)
    ds_read_b64_tr_b16 v[144:145], v8 offset:16384
    ds_read_b64_tr_b16 v[146:147], v8 offset:18432
    ds_read_b64_tr_b16 v[148:149], v8 offset:20480
    ds_read_b64_tr_b16 v[150:151], v8 offset:22528
    ds_read_b64_tr_b16 v[152:153], v9 offset:16384
    ds_read_b64_tr_b16 v[154:155], v9 offset:18432
    ds_read_b64_tr_b16 v[156:157], v9 offset:20480
    ds_read_b64_tr_b16 v[158:159], v9 offset:22528
    s_waitcnt lgkmcnt(8)
    s_waitcnt lgkmcnt(0)
    s_barrier
    v_mov_b32 v63, 163832
    ds_read_b32 v62, v63
    s_waitcnt lgkmcnt(0)
    v_readfirstlane_b32 s3, v62
    s_cmp_lg_u32 s3, 1
    s_cbranch_scc1 REROLE
    s_branch GO
PRO_D:
    s_cmp_eq_u32 s31, 0
    s_cbranch_scc1 PRO_D1
    s_barrier
    s_branch WR_CA
PRO_D1:
    s_sub_u32 s15, s28, 18
    s_lshl_b32 s15, s15, 2
    s_add_u32 s15, s15, s14
    s_and_b32 s12, s2, 7
    s_lshl_b32 s13, s15, 3
    s_add_u32 s13, s13, s12
    s_mul_i32 s3, s13, 10240
    v_add_u32 v4, s3, v4
    buffer_load_dwordx4 v[16:19], v4, s[20:23], 0 offen offset:0
    buffer_load_dwordx4 v[20:23], v4, s[20:23], 0 offen offset:16
    buffer_load_dwordx4 v[24:27], v4, s[20:23], 0 offen offset:256
    buffer_load_dwordx4 v[28:31], v4, s[20:23], 0 offen offset:272
    buffer_load_dwordx4 v[32:35], v4, s[20:23], 0 offen offset:512
    buffer_load_dwordx4 v[36:39], v4, s[20:23], 0 offen offset:528
    buffer_load_dwordx4 v[40:43], v4, s[20:23], 0 offen offset:768
    buffer_load_dwordx4 v[44:47], v4, s[20:23], 0 offen offset:784
    buffer_load_dwordx4 v[48:51], v4, s[20:23], 0 offen offset:1024
    buffer_load_dwordx4 v[52:55], v4, s[20:23], 0 offen offset:1040
    s_mul_i32 s3, s12, 1048576
    s_lshl_b32 s6, s15, 12
    s_add_u32 s3, s3, s6
    s_cmp_lt_u32 s6, 90112
    s_cselect_b32 s7, -1, 0
    v_mov_b32 v56, s7
    v_mov_b32 v57, s7
    v_mov_b32 v58, s7
    v_mov_b32 v59, s7
    buffer_store_dwordx4 v[56:59], v2, s[8:11], s3 offen offset:0 sc1
    s_cmp_lt_u32 s6, 89088
    s_cselect_b32 s7, -1, 0
    v_mov_b32 v60, s7
    v_mov_b32 v61, s7
    v_mov_b32 v62, s7
    v_mov_b32 v63, s7
    buffer_store_dwordx4 v[60:63], v2, s[8:11], s3 offen offset:1024 sc1
    s_cmp_lt_u32 s6, 88064
    s_cselect_b32 s7, -1, 0
    v_mov_b32 v56, s7
    v_mov_b32 v57, s7
    v_mov_b32 v58, s7
    v_mov_b32 v59, s7
    buffer_store_dwordx4 v[56:59], v2, s[8:11], s3 offen offset:2048 sc1
    s_cmp_lt_u32 s6, 87040
    s_cselect_b32 s7, -1, 0
    v_mov_b32 v60, s7
    v_mov_b32 v61, s7
    v_mov_b32 v62, s7
    v_mov_b32 v63, s7
    buffer_store_dwordx4 v[60:63], v2, s[8:11], s3 offen offset:3072 sc1
    v_mov_b32 v64, 0
    v_mov_b32 v65, 0
    v_mov_b32 v66, 0
    v_mov_b32 v67, 0
    s_mul_i32 s3, s13, 4096
    s_add_u32 s3, s3, 8388608
    buffer_store_dwordx4 v[64:67], v2, s[8:11], s3 offen offset:0 sc1
    buffer_store_dwordx4 v[64:67], v2, s[8:11], s3 offen offset:1024 sc1
    buffer_store_dwordx4 v[64:67], v2, s[8:11], s3 offen offset:2048 sc1
    buffer_store_dwordx4 v[64:67], v2, s[8:11], s3 offen offset:3072 sc1
    s_cmp_ge_u32 s13, 256
    s_cbranch_scc1 PRO_D2
    v_and_b32 v6, 15, v0
    v_lshlrev_b32 v6, 3, v6
    s_lshl_b32 s3, s13, 7
    s_add_u32 s3, s3, 13631488
    buffer_store_dwordx2 v[64:65], v6, s[8:11], s3 offen sc1
    s_waitcnt vmcnt(9)
    v_lshlrev_b32 v64, 16, v16
    v_and_b32 v65, 0xffff0000, v16
    v_lshlrev_b32 v66, 16, v17
    v_and_b32 v67, 0xffff0000, v17
    v_lshlrev_b32 v68, 16, v18
    v_and_b32 v69, 0xffff0000, v18
    v_lshlrev_b32 v70, 16, v19
    v_and_b32 v71, 0xffff0000, v19
    v_lshlrev_b32 v72, 16, v20
    v_and_b32 v73, 0xffff0000, v20
    v_lshlrev_b32 v74, 16, v21
    v_and_b32 v75, 0xffff0000, v21
    v_lshlrev_b32 v76, 16, v22
    v_and_b32 v77, 0xffff0000, v22
    v_lshlrev_b32 v78, 16, v23
    v_and_b32 v79, 0xffff0000, v23
    v_lshlrev_b32 v80, 16, v24
    v_and_b32 v81, 0xffff0000, v24
    v_lshlrev_b32 v82, 16, v25
    v_and_b32 v83, 0xffff0000, v25
    v_lshlrev_b32 v84, 16, v26
    v_and_b32 v85, 0xffff0000, v26
    v_lshlrev_b32 v86, 16, v27
    v_and_b32 v87, 0xffff0000, v27
    v_lshlrev_b32 v88, 16, v28
    v_and_b32 v89, 0xffff0000, v28
    v_lshlrev_b32 v90, 16, v29
    v_and_b32 v91, 0xffff0000, v29
    v_lshlrev_b32 v92, 16, v30
    v_and_b32 v93, 0xffff0000, v30
    v_lshlrev_b32 v94, 16, v31
    v_and_b32 v95, 0xffff0000, v31
    v_lshlrev_b32 v96, 16, v32
    v_and_b32 v97, 0xffff0000, v32
    v_lshlrev_b32 v98, 16, v33
    v_and_b32 v99, 0xffff0000, v33
    v_lshlrev_b32 v100, 16, v34
    v_and_b32 v101, 0xffff0000, v34
    v_lshlrev_b32 v102, 16, v35
    v_and_b32 v103, 0xffff0000, v35
    v_lshlrev_b32 v104, 16, v36
    v_and_b32 v105, 0xffff0000, v36
    v_lshlrev_b32 v106, 16, v37
    v_and_b32 v107, 0xffff0000, v37
    v_lshlrev_b32 v108, 16, v38
    v_and_b32 v109, 0xffff0000, v38
    v_lshlrev_b32 v110, 16, v39
    v_and_b32 v111, 0xffff0000, v39
    v_lshlrev_b32 v112, 16, v40
    v_and_b32 v113, 0xffff0000, v40
    v_lshlrev_b32 v114, 16, v41
    v_and_b32 v115, 0xffff0000, v41
    v_lshlrev_b32 v116, 16, v42
    v_and_b32 v117, 0xffff0000, v42
    v_lshlrev_b32 v118, 16, v43
    v_and_b32 v119, 0xffff0000, v43
    v_lshlrev_b32 v120, 16, v44
    v_and_b32 v121, 0xffff0000, v44
    v_lshlrev_b32 v122, 16, v45
    v_and_b32 v123, 0xffff0000, v45
    v_lshlrev_b32 v124, 16, v46
    v_and_b32 v125, 0xffff0000, v46
    v_lshlrev_b32 v126, 16, v47
    v_and_b32 v127, 0xffff0000, v47
    v_lshlrev_b32 v128, 16, v48
    v_and_b32 v129, 0xffff0000, v48
    v_lshlrev_b32 v130, 16, v49
    v_and_b32 v131, 0xffff0000, v49
    v_lshlrev_b32 v132, 16, v50
    v_and_b32 v133, 0xffff0000, v50
    v_lshlrev_b32 v134, 16, v51
    v_and_b32 v135, 0xffff0000, v51
    v_lshlrev_b32 v136, 16, v52
    v_and_b32 v137, 0xffff0000, v52
    v_lshlrev_b32 v138, 16, v53
    v_and_b32 v139, 0xffff0000, v53
    v_lshlrev_b32 v140, 16, v54
    v_and_b32 v141, 0xffff0000, v54
    v_lshlrev_b32 v142, 16, v55
    v_and_b32 v143, 0xffff0000, v55
    v_pk_add_f32 v[144:145], v[64:65], v[66:67]
    v_pk_add_f32 v[146:147], v[68:69], v[70:71]
    v_pk_add_f32 v[144:145], v[144:145], v[72:73]
    v_pk_add_f32 v[146:147], v[146:147], v[74:75]
    v_pk_add_f32 v[144:145], v[144:145], v[76:77]
    v_pk_add_f32 v[146:147], v[146:147], v[78:79]
    v_pk_add_f32 v[144:145], v[144:145], v[80:81]
    v_pk_add_f32 v[146:147], v[146:147], v[82:83]
    v_pk_add_f32 v[144:145], v[144:145], v[84:85]
    v_pk_add_f32 v[146:147], v[146:147], v[86:87]
    v_pk_add_f32 v[144:145], v[144:145], v[88:89]
    v_pk_add_f32 v[146:147], v[146:147], v[90:91]
    v_pk_add_f32 v[144:145], v[144:145], v[92:93]
    v_pk_add_f32 v[146:147], v[146:147], v[94:95]
    v_pk_add_f32 v[144:145], v[144:145], v[96:97]
    v_pk_add_f32 v[146:147], v[146:147], v[98:99]
    v_pk_add_f32 v[144:145], v[144:145], v[100:101]
    v_pk_add_f32 v[146:147], v[146:147], v[102:103]
    v_pk_add_f32 v[144:145], v[144:145], v[104:105]
    v_pk_add_f32 v[146:147], v[146:147], v[106:107]
    v_pk_add_f32 v[144:145], v[144:145], v[108:109]
    v_pk_add_f32 v[146:147], v[146:147], v[110:111]
    v_pk_add_f32 v[144:145], v[144:145], v[112:113]
    v_pk_add_f32 v[146:147], v[146:147], v[114:115]
    v_pk_add_f32 v[144:145], v[144:145], v[116:117]
    v_pk_add_f32 v[146:147], v[146:147], v[118:119]
    v_pk_add_f32 v[144:145], v[144:145], v[120:121]
    v_pk_add_f32 v[146:147], v[146:147], v[122:123]
    v_pk_add_f32 v[144:145], v[144:145], v[124:125]
    v_pk_add_f32 v[146:147], v[146:147], v[126:127]
    v_pk_add_f32 v[144:145], v[144:145], v[128:129]
    v_pk_add_f32 v[146:147], v[146:147], v[130:131]
    v_pk_add_f32 v[144:145], v[144:145], v[132:133]
    v_pk_add_f32 v[146:147], v[146:147], v[134:135]
    v_pk_add_f32 v[144:145], v[144:145], v[136:137]
    v_pk_add_f32 v[146:147], v[146:147], v[138:139]
    v_pk_add_f32 v[144:145], v[144:145], v[140:141]
    v_pk_add_f32 v[146:147], v[146:147], v[142:143]
    v_pk_add_f32 v[144:145], v[144:145], v[146:147]
    v_add_f32 v144, v144, v145
    s_nop 1
    v_add_f32_dpp v144, v144, v144 row_ror:8 row_mask:0xf bank_mask:0xf
    v_mov_b32 v145, v144
    s_nop 1
    v_permlane16_swap_b32 v144, v145
    v_add_f32 v144, v144, v145
    v_mov_b32 v145, v144
    s_nop 1
    v_permlane32_swap_b32 v144, v145
    v_add_f32 v144, v144, v145
    v_mul_f32 v144, 0x3acccccd, v144
    v_pk_add_f32 v[146:147], v[64:65], v[144:145] op_sel_hi:[1,0] neg_lo:[0,1] neg_hi:[0,1]
    s_nop 0
    v_pk_mul_f32 v[150:151], v[146:147], v[146:147]
    v_pk_add_f32 v[148:149], v[66:67], v[144:145] op_sel_hi:[1,0] neg_lo:[0,1] neg_hi:[0,1]
    s_nop 0
    v_pk_mul_f32 v[152:153], v[148:149], v[148:149]
    v_pk_add_f32 v[146:147], v[68:69], v[144:145] op_sel_hi:[1,0] neg_lo:[0,1] neg_hi:[0,1]
    s_nop 0
    v_pk_fma_f32 v[150:151], v[146:147], v[146:147], v[150:151]
    v_pk_add_f32 v[148:149], v[70:71], v[144:145] op_sel_hi:[1,0] neg_lo:[0,1] neg_hi:[0,1]
    s_nop 0
    v_pk_fma_f32 v[152:153], v[148:149], v[148:149], v[152:153]
    v_pk_add_f32 v[146:147], v[72:73], v[144:145] op_sel_hi:[1,0] neg_lo:[0,1] neg_hi:[0,1]
    s_nop 0
    v_pk_fma_f32 v[150:151], v[146:147], v[146:147], v[150:151]
    v_pk_add_f32 v[148:149], v[74:75], v[144:145] op_sel_hi:[1,0] neg_lo:[0,1] neg_hi:[0,1]
    s_nop 0
    v_pk_fma_f32 v[152:153], v[148:149], v[148:149], v[152:153]
    v_pk_add_f32 v[146:147], v[76:77], v[144:145] op_sel_hi:[1,0] neg_lo:[0,1] neg_hi:[0,1]
    s_nop 0
    v_pk_fma_f32 v[150:151], v[146:147], v[146:147], v[150:151]
    v_pk_add_f32 v[148:149], v[78:79], v[144:145] op_sel_hi:[1,0] neg_lo:[0,1] neg_hi:[0,1]
    s_nop 0
    v_pk_fma_f32 v[152:153], v[148:149], v[148:149], v[152:153]
    v_pk_add_f32 v[146:147], v[80:81], v[144:145] op_sel_hi:[1,0] neg_lo:[0,1] neg_hi:[0,1]
    s_nop 0
    v_pk_fma_f32 v[150:151], v[146:147], v[146:147], v[150:151]
    v_pk_add_f32 v[148:149], v[82:83], v[144:145] op_sel_hi:[1,0] neg_lo:[0,1] neg_hi:[0,1]
    s_nop 0
    v_pk_fma_f32 v[152:153], v[148:149], v[148:149], v[152:153]
    v_pk_add_f32 v[146:147], v[84:85], v[144:145] op_sel_hi:[1,0] neg_lo:[0,1] neg_hi:[0,1]
    s_nop 0
    v_pk_fma_f32 v[150:151], v[146:147], v[146:147], v[150:151]
    v_pk_add_f32 v[148:149], v[86:87], v[144:145] op_sel_hi:[1,0] neg_lo:[0,1] neg_hi:[0,1]
    s_nop 0
    v_pk_fma_f32 v[152:153], v[148:149], v[148:149], v[152:153]
    v_pk_add_f32 v[146:147], v[88:89], v[144:145] op_sel_hi:[1,0] neg_lo:[0,1] neg_hi:[0,1]
    s_nop 0
    v_pk_fma_f32 v[150:151], v[146:147], v[146:147], v[150:151]
    v_pk_add_f32 v[148:149], v[90:91], v[144:145] op_sel_hi:[1,0] neg_lo:[0,1] neg_hi:[0,1]
    s_nop 0
    v_pk_fma_f32 v[152:153], v[148:149], v[148:149], v[152:153]
    v_pk_add_f32 v[146:147], v[92:93], v[144:145] op_sel_hi:[1,0] neg_lo:[0,1] neg_hi:[0,1]
    s_nop 0
    v_pk_fma_f32 v[150:151], v[146:147], v[146:147], v[150:151]
    v_pk_add_f32 v[148:149], v[94:95], v[144:145] op_sel_hi:[1,0] neg_lo:[0,1] neg_hi:[0,1]
    s_nop 0
    v_pk_fma_f32 v[152:153], v[148:149], v[148:149], v[152:153]
    v_pk_add_f32 v[146:147], v[96:97], v[144:145] op_sel_hi:[1,0] neg_lo:[0,1] neg_hi:[0,1]
    s_nop 0
    v_pk_fma_f32 v[150:151], v[146:147], v[146:147], v[150:151]
    v_pk_add_f32 v[148:149], v[98:99], v[144:145] op_sel_hi:[1,0] neg_lo:[0,1] neg_hi:[0,1]
    s_nop 0
    v_pk_fma_f32 v[152:153], v[148:149], v[148:149], v[152:153]
    v_pk_add_f32 v[146:147], v[100:101], v[144:145] op_sel_hi:[1,0] neg_lo:[0,1] neg_hi:[0,1]
    s_nop 0
    v_pk_fma_f32 v[150:151], v[146:147], v[146:147], v[150:151]
    v_pk_add_f32 v[148:149], v[102:103], v[144:145] op_sel_hi:[1,0] neg_lo:[0,1] neg_hi:[0,1]
    s_nop 0
    v_pk_fma_f32 v[152:153], v[148:149], v[148:149], v[152:153]
    v_pk_add_f32 v[146:147], v[104:105], v[144:145] op_sel_hi:[1,0] neg_lo:[0,1] neg_hi:[0,1]
    s_nop 0
    v_pk_fma_f32 v[150:151], v[146:147], v[146:147], v[150:151]
    v_pk_add_f32 v[148:149], v[106:107], v[144:145] op_sel_hi:[1,0] neg_lo:[0,1] neg_hi:[0,1]
    s_nop 0
    v_pk_fma_f32 v[152:153], v[148:149], v[148:149], v[152:153]
    v_pk_add_f32 v[146:147], v[108:109], v[144:145] op_sel_hi:[1,0] neg_lo:[0,1] neg_hi:[0,1]
    s_nop 0
    v_pk_fma_f32 v[150:151], v[146:147], v[146:147], v[150:151]
    v_pk_add_f32 v[148:149], v[110:111], v[144:145] op_sel_hi:[1,0] neg_lo:[0,1] neg_hi:[0,1]
    s_nop 0
    v_pk_fma_f32 v[152:153], v[148:149], v[148:149], v[152:153]
    v_pk_add_f32 v[146:147], v[112:113], v[144:145] op_sel_hi:[1,0] neg_lo:[0,1] neg_hi:[0,1]
    s_nop 0
    v_pk_fma_f32 v[150:151], v[146:147], v[146:147], v[150:151]
    v_pk_add_f32 v[148:149], v[114:115], v[144:145] op_sel_hi:[1,0] neg_lo:[0,1] neg_hi:[0,1]
    s_nop 0
    v_pk_fma_f32 v[152:153], v[148:149], v[148:149], v[152:153]
    v_pk_add_f32 v[146:147], v[116:117], v[144:145] op_sel_hi:[1,0] neg_lo:[0,1] neg_hi:[0,1]
    s_nop 0
    v_pk_fma_f32 v[150:151], v[146:147], v[146:147], v[150:151]
    v_pk_add_f32 v[148:149], v[118:119], v[144:145] op_sel_hi:[1,0] neg_lo:[0,1] neg_hi:[0,1]
    s_nop 0
    v_pk_fma_f32 v[152:153], v[148:149], v[148:149], v[152:153]
    v_pk_add_f32 v[146:147], v[120:121], v[144:145] op_sel_hi:[1,0] neg_lo:[0,1] neg_hi:[0,1]
    s_nop 0
    v_pk_fma_f32 v[150:151], v[146:147], v[146:147], v[150:151]
    v_pk_add_f32 v[148:149], v[122:123], v[144:145] op_sel_hi:[1,0] neg_lo:[0,1] neg_hi:[0,1]
    s_nop 0
    v_pk_fma_f32 v[152:153], v[148:149], v[148:149], v[152:153]
    v_pk_add_f32 v[146:147], v[124:125], v[144:145] op_sel_hi:[1,0] neg_lo:[0,1] neg_hi:[0,1]
    s_nop 0
    v_pk_fma_f32 v[150:151], v[146:147], v[146:147], v[150:151]
    v_pk_add_f32 v[148:149], v[126:127], v[144:145] op_sel_hi:[1,0] neg_lo:[0,1] neg_hi:[0,1]
    s_nop 0
    v_pk_fma_f32 v[152:153], v[148:149], v[148:149], v[152:153]
    v_pk_add_f32 v[146:147], v[128:129], v[144:145] op_sel_hi:[1,0] neg_lo:[0,1] neg_hi:[0,1]
    s_nop 0
    v_pk_fma_f32 v[150:151], v[146:147], v[146:147], v[150:151]
    v_pk_add_f32 v[148:149], v[130:131], v[144:145] op_sel_hi:[1,0] neg_lo:[0,1] neg_hi:[0,1]
    s_nop 0
    v_pk_fma_f32 v[152:153], v[148:149], v[148:149], v[152:153]
    v_pk_add_f32 v[146:147], v[132:133], v[144:145] op_sel_hi:[1,0] neg_lo:[0,1] neg_hi:[0,1]
    s_nop 0
    v_pk_fma_f32 v[150:151], v[146:147], v[146:147], v[150:151]
    v_pk_add_f32 v[148:149], v[134:135], v[144:145] op_sel_hi:[1,0] neg_lo:[0,1] neg_hi:[0,1]
    s_nop 0
    v_pk_fma_f32 v[152:153], v[148:149], v[148:149], v[152:153]
    v_pk_add_f32 v[146:147], v[136:137], v[144:145] op_sel_hi:[1,0] neg_lo:[0,1] neg_hi:[0,1]
    s_nop 0
    v_pk_fma_f32 v[150:151], v[146:147], v[146:147], v[150:151]
    v_pk_add_f32 v[148:149], v[138:139], v[144:145] op_sel_hi:[1,0] neg_lo:[0,1] neg_hi:[0,1]
    s_nop 0
    v_pk_fma_f32 v[152:153], v[148:149], v[148:149], v[152:153]
    v_pk_add_f32 v[146:147], v[140:141], v[144:145] op_sel_hi:[1,0] neg_lo:[0,1] neg_hi:[0,1]
    s_nop 0
    v_pk_fma_f32 v[150:151], v[146:147], v[146:147], v[150:151]
    v_pk_add_f32 v[148:149], v[142:143], v[144:145] op_sel_hi:[1,0] neg_lo:[0,1] neg_hi:[0,1]
    s_nop 0
    v_pk_fma_f32 v[152:153], v[148:149], v[148:149], v[152:153]
    v_pk_add_f32 v[150:151], v[150:151], v[152:153]
    v_add_f32 v146, v150, v151
    s_nop 1
    v_add_f32_dpp v146, v146, v146 row_ror:8 row_mask:0xf bank_mask:0xf
    v_mov_b32 v147, v146
    s_nop 1
    v_permlane16_swap_b32 v146, v147
    v_add_f32 v146, v146, v147
    v_mov_b32 v147, v146
    s_nop 1
    v_permlane32_swap_b32 v146, v147
    v_add_f32 v146, v146, v147
    v_mul_f32 v146, 0x3acccccd, v146
    v_cvt_pk_bf16_f32 v146, v146, v146
    v_lshlrev_b32 v146, 16, v146
    v_add_f32 v146, 0x3727c5ac, v146
    v_cvt_pk_bf16_f32 v146, v146, v146
    v_lshlrev_b32 v146, 16, v146
    v_sqrt_f32 v146, v146
    s_nop 0
    v_cvt_pk_bf16_f32 v146, v146, v146
    v_lshlrev_b32 v146, 16, v146
    v_rcp_f32 v146, v146
    v_cvt_pk_bf16_f32 v144, v144, v144
    v_lshlrev_b32 v144, 16, v144
    v_pk_add_f32 v[148:149], v[64:65], v[144:145] op_sel_hi:[1,0] neg_lo:[0,1] neg_hi:[0,1]
    s_nop 0
    v_cvt_pk_bf16_f32 v148, v148, v149
    v_and_b32 v149, 0xffff0000, v148
    v_lshlrev_b32 v148, 16, v148
    v_pk_mul_f32 v[148:149], v[148:149], v[146:147] op_sel_hi:[1,0]
    s_nop 0
    v_cvt_pk_bf16_f32 v16, v148, v149
    v_pk_add_f32 v[150:151], v[66:67], v[144:145] op_sel_hi:[1,0] neg_lo:[0,1] neg_hi:[0,1]
    s_nop 0
    v_cvt_pk_bf16_f32 v150, v150, v151
    v_and_b32 v151, 0xffff0000, v150
    v_lshlrev_b32 v150, 16, v150
    v_pk_mul_f32 v[150:151], v[150:151], v[146:147] op_sel_hi:[1,0]
    s_nop 0
    v_cvt_pk_bf16_f32 v18, v150, v151
    v_pk_add_f32 v[148:149], v[68:69], v[144:145] op_sel_hi:[1,0] neg_lo:[0,1] neg_hi:[0,1]
    s_nop 0
    v_cvt_pk_bf16_f32 v148, v148, v149
    v_and_b32 v149, 0xffff0000, v148
    v_lshlrev_b32 v148, 16, v148
    v_pk_mul_f32 v[148:149], v[148:149], v[146:147] op_sel_hi:[1,0]
    s_nop 0
    v_cvt_pk_bf16_f32 v20, v148, v149
    v_pk_add_f32 v[150:151], v[70:71], v[144:145] op_sel_hi:[1,0] neg_lo:[0,1] neg_hi:[0,1]
    s_nop 0
    v_cvt_pk_bf16_f32 v150, v150, v151
    v_and_b32 v151, 0xffff0000, v150
    v_lshlrev_b32 v150, 16, v150
    v_pk_mul_f32 v[150:151], v[150:151], v[146:147] op_sel_hi:[1,0]
    s_nop 0
    v_cvt_pk_bf16_f32 v22, v150, v151
    v_pk_add_f32 v[148:149], v[72:73], v[144:145] op_sel_hi:[1,0] neg_lo:[0,1] neg_hi:[0,1]
    s_nop 0
    v_cvt_pk_bf16_f32 v148, v148, v149
    v_and_b32 v149, 0xffff0000, v148
    v_lshlrev_b32 v148, 16, v148
    v_pk_mul_f32 v[148:149], v[148:149], v[146:147] op_sel_hi:[1,0]
    s_nop 0
    v_cvt_pk_bf16_f32 v17, v148, v149
    v_pk_add_f32 v[150:151], v[74:75], v[144:145] op_sel_hi:[1,0] neg_lo:[0,1] neg_hi:[0,1]
    s_nop 0
    v_cvt_pk_bf16_f32 v150, v150, v151
    v_and_b32 v151, 0xffff0000, v150
    v_lshlrev_b32 v150, 16, v150
    v_pk_mul_f32 v[150:151], v[150:151], v[146:147] op_sel_hi:[1,0]
    s_nop 0
    v_cvt_pk_bf16_f32 v19, v150, v151
    v_pk_add_f32 v[148:149], v[76:77], v[144:145] op_sel_hi:[1,0] neg_lo:[0,1] neg_hi:[0,1]
    s_nop 0
    v_cvt_pk_bf16_f32 v148, v148, v149
    v_and_b32 v149, 0xffff0000, v148
    v_lshlrev_b32 v148, 16, v148
    v_pk_mul_f32 v[148:149], v[148:149], v[146:147] op_sel_hi:[1,0]
    s_nop 0
    v_cvt_pk_bf16_f32 v21, v148, v149
    v_pk_add_f32 v[150:151], v[78:79], v[144:145] op_sel_hi:[1,0] neg_lo:[0,1] neg_hi:[0,1]
    s_nop 0
    v_cvt_pk_bf16_f32 v150, v150, v151
    v_and_b32 v151, 0xffff0000, v150
    v_lshlrev_b32 v150, 16, v150
    v_pk_mul_f32 v[150:151], v[150:151], v[146:147] op_sel_hi:[1,0]
    s_nop 0
    v_cvt_pk_bf16_f32 v23, v150, v151
    v_pk_add_f32 v[148:149], v[80:81], v[144:145] op_sel_hi:[1,0] neg_lo:[0,1] neg_hi:[0,1]
    s_nop 0
    v_cvt_pk_bf16_f32 v148, v148, v149
    v_and_b32 v149, 0xffff0000, v148
    v_lshlrev_b32 v148, 16, v148
    v_pk_mul_f32 v[148:149], v[148:149], v[146:147] op_sel_hi:[1,0]
    s_nop 0
    v_cvt_pk_bf16_f32 v24, v148, v149
    v_pk_add_f32 v[150:151], v[82:83], v[144:145] op_sel_hi:[1,0] neg_lo:[0,1] neg_hi:[0,1]
    s_nop 0
    v_cvt_pk_bf16_f32 v150, v150, v151
    v_and_b32 v151, 0xffff0000, v150
    v_lshlrev_b32 v150, 16, v150
    v_pk_mul_f32 v[150:151], v[150:151], v[146:147] op_sel_hi:[1,0]
    s_nop 0
    v_cvt_pk_bf16_f32 v26, v150, v151
    v_pk_add_f32 v[148:149], v[84:85], v[144:145] op_sel_hi:[1,0] neg_lo:[0,1] neg_hi:[0,1]
    s_nop 0
    v_cvt_pk_bf16_f32 v148, v148, v149
    v_and_b32 v149, 0xffff0000, v148
    v_lshlrev_b32 v148, 16, v148
    v_pk_mul_f32 v[148:149], v[148:149], v[146:147] op_sel_hi:[1,0]
    s_nop 0
    v_cvt_pk_bf16_f32 v28, v148, v149
    v_pk_add_f32 v[150:151], v[86:87], v[144:145] op_sel_hi:[1,0] neg_lo:[0,1] neg_hi:[0,1]
    s_nop 0
    v_cvt_pk_bf16_f32 v150, v150, v151
    v_and_b32 v151, 0xffff0000, v150
    v_lshlrev_b32 v150, 16, v150
    v_pk_mul_f32 v[150:151], v[150:151], v[146:147] op_sel_hi:[1,0]
    s_nop 0
    v_cvt_pk_bf16_f32 v30, v150, v151
    v_pk_add_f32 v[148:149], v[88:89], v[144:145] op_sel_hi:[1,0] neg_lo:[0,1] neg_hi:[0,1]
    s_nop 0
    v_cvt_pk_bf16_f32 v148, v148, v149
    v_and_b32 v149, 0xffff0000, v148
    v_lshlrev_b32 v148, 16, v148
    v_pk_mul_f32 v[148:149], v[148:149], v[146:147] op_sel_hi:[1,0]
    s_nop 0
    v_cvt_pk_bf16_f32 v25, v148, v149
    v_pk_add_f32 v[150:151], v[90:91], v[144:145] op_sel_hi:[1,0] neg_lo:[0,1] neg_hi:[0,1]
    s_nop 0
    v_cvt_pk_bf16_f32 v150, v150, v151
    v_and_b32 v151, 0xffff0000, v150
    v_lshlrev_b32 v150, 16, v150
    v_pk_mul_f32 v[150:151], v[150:151], v[146:147] op_sel_hi:[1,0]
    s_nop 0
    v_cvt_pk_bf16_f32 v27, v150, v151
    v_pk_add_f32 v[148:149], v[92:93], v[144:145] op_sel_hi:[1,0] neg_lo:[0,1] neg_hi:[0,1]
    s_nop 0
    v_cvt_pk_bf16_f32 v148, v148, v149
    v_and_b32 v149, 0xffff0000, v148
    v_lshlrev_b32 v148, 16, v148
    v_pk_mul_f32 v[148:149], v[148:149], v[146:147] op_sel_hi:[1,0]
    s_nop 0
    v_cvt_pk_bf16_f32 v29, v148, v149
    v_pk_add_f32 v[150:151], v[94:95], v[144:145] op_sel_hi:[1,0] neg_lo:[0,1] neg_hi:[0,1]
    s_nop 0
    v_cvt_pk_bf16_f32 v150, v150, v151
    v_and_b32 v151, 0xffff0000, v150
    v_lshlrev_b32 v150, 16, v150
    v_pk_mul_f32 v[150:151], v[150:151], v[146:147] op_sel_hi:[1,0]
    s_nop 0
    v_cvt_pk_bf16_f32 v31, v150, v151
    v_pk_add_f32 v[148:149], v[96:97], v[144:145] op_sel_hi:[1,0] neg_lo:[0,1] neg_hi:[0,1]
    s_nop 0
    v_cvt_pk_bf16_f32 v148, v148, v149
    v_and_b32 v149, 0xffff0000, v148
    v_lshlrev_b32 v148, 16, v148
    v_pk_mul_f32 v[148:149], v[148:149], v[146:147] op_sel_hi:[1,0]
    s_nop 0
    v_cvt_pk_bf16_f32 v32, v148, v149
    v_pk_add_f32 v[150:151], v[98:99], v[144:145] op_sel_hi:[1,0] neg_lo:[0,1] neg_hi:[0,1]
    s_nop 0
    v_cvt_pk_bf16_f32 v150, v150, v151
    v_and_b32 v151, 0xffff0000, v150
    v_lshlrev_b32 v150, 16, v150
    v_pk_mul_f32 v[150:151], v[150:151], v[146:147] op_sel_hi:[1,0]
    s_nop 0
    v_cvt_pk_bf16_f32 v34, v150, v151
    v_pk_add_f32 v[148:149], v[100:101], v[144:145] op_sel_hi:[1,0] neg_lo:[0,1] neg_hi:[0,1]
    s_nop 0
    v_cvt_pk_bf16_f32 v148, v148, v149
    v_and_b32 v149, 0xffff0000, v148
    v_lshlrev_b32 v148, 16, v148
    v_pk_mul_f32 v[148:149], v[148:149], v[146:147] op_sel_hi:[1,0]
    s_nop 0
    v_cvt_pk_bf16_f32 v36, v148, v149
    v_pk_add_f32 v[150:151], v[102:103], v[144:145] op_sel_hi:[1,0] neg_lo:[0,1] neg_hi:[0,1]
    s_nop 0
    v_cvt_pk_bf16_f32 v150, v150, v151
    v_and_b32 v151, 0xffff0000, v150
    v_lshlrev_b32 v150, 16, v150
    v_pk_mul_f32 v[150:151], v[150:151], v[146:147] op_sel_hi:[1,0]
    s_nop 0
    v_cvt_pk_bf16_f32 v38, v150, v151
    v_pk_add_f32 v[148:149], v[104:105], v[144:145] op_sel_hi:[1,0] neg_lo:[0,1] neg_hi:[0,1]
    s_nop 0
    v_cvt_pk_bf16_f32 v148, v148, v149
    v_and_b32 v149, 0xffff0000, v148
    v_lshlrev_b32 v148, 16, v148
    v_pk_mul_f32 v[148:149], v[148:149], v[146:147] op_sel_hi:[1,0]
    s_nop 0
    v_cvt_pk_bf16_f32 v33, v148, v149
    v_pk_add_f32 v[150:151], v[106:107], v[144:145] op_sel_hi:[1,0] neg_lo:[0,1] neg_hi:[0,1]
    s_nop 0
    v_cvt_pk_bf16_f32 v150, v150, v151
    v_and_b32 v151, 0xffff0000, v150
    v_lshlrev_b32 v150, 16, v150
    v_pk_mul_f32 v[150:151], v[150:151], v[146:147] op_sel_hi:[1,0]
    s_nop 0
    v_cvt_pk_bf16_f32 v35, v150, v151
    v_pk_add_f32 v[148:149], v[108:109], v[144:145] op_sel_hi:[1,0] neg_lo:[0,1] neg_hi:[0,1]
    s_nop 0
    v_cvt_pk_bf16_f32 v148, v148, v149
    v_and_b32 v149, 0xffff0000, v148
    v_lshlrev_b32 v148, 16, v148
    v_pk_mul_f32 v[148:149], v[148:149], v[146:147] op_sel_hi:[1,0]
    s_nop 0
    v_cvt_pk_bf16_f32 v37, v148, v149
    v_pk_add_f32 v[150:151], v[110:111], v[144:145] op_sel_hi:[1,0] neg_lo:[0,1] neg_hi:[0,1]
    s_nop 0
    v_cvt_pk_bf16_f32 v150, v150, v151
    v_and_b32 v151, 0xffff0000, v150
    v_lshlrev_b32 v150, 16, v150
    v_pk_mul_f32 v[150:151], v[150:151], v[146:147] op_sel_hi:[1,0]
    s_nop 0
    v_cvt_pk_bf16_f32 v39, v150, v151
    v_pk_add_f32 v[148:149], v[112:113], v[144:145] op_sel_hi:[1,0] neg_lo:[0,1] neg_hi:[0,1]
    s_nop 0
    v_cvt_pk_bf16_f32 v148, v148, v149
    v_and_b32 v149, 0xffff0000, v148
    v_lshlrev_b32 v148, 16, v148
    v_pk_mul_f32 v[148:149], v[148:149], v[146:147] op_sel_hi:[1,0]
    s_nop 0
    v_cvt_pk_bf16_f32 v40, v148, v149
    v_pk_add_f32 v[150:151], v[114:115], v[144:145] op_sel_hi:[1,0] neg_lo:[0,1] neg_hi:[0,1]
    s_nop 0
    v_cvt_pk_bf16_f32 v150, v150, v151
    v_and_b32 v151, 0xffff0000, v150
    v_lshlrev_b32 v150, 16, v150
    v_pk_mul_f32 v[150:151], v[150:151], v[146:147] op_sel_hi:[1,0]
    s_nop 0
    v_cvt_pk_bf16_f32 v42, v150, v151
    v_pk_add_f32 v[148:149], v[116:117], v[144:145] op_sel_hi:[1,0] neg_lo:[0,1] neg_hi:[0,1]
    s_nop 0
    v_cvt_pk_bf16_f32 v148, v148, v149
    v_and_b32 v149, 0xffff0000, v148
    v_lshlrev_b32 v148, 16, v148
    v_pk_mul_f32 v[148:149], v[148:149], v[146:147] op_sel_hi:[1,0]
    s_nop 0
    v_cvt_pk_bf16_f32 v44, v148, v149
    v_pk_add_f32 v[150:151], v[118:119], v[144:145] op_sel_hi:[1,0] neg_lo:[0,1] neg_hi:[0,1]
    s_nop 0
    v_cvt_pk_bf16_f32 v150, v150, v151
    v_and_b32 v151, 0xffff0000, v150
    v_lshlrev_b32 v150, 16, v150
    v_pk_mul_f32 v[150:151], v[150:151], v[146:147] op_sel_hi:[1,0]
    s_nop 0
    v_cvt_pk_bf16_f32 v46, v150, v151
    v_pk_add_f32 v[148:149], v[120:121], v[144:145] op_sel_hi:[1,0] neg_lo:[0,1] neg_hi:[0,1]
    s_nop 0
    v_cvt_pk_bf16_f32 v148, v148, v149
    v_and_b32 v149, 0xffff0000, v148
    v_lshlrev_b32 v148, 16, v148
    v_pk_mul_f32 v[148:149], v[148:149], v[146:147] op_sel_hi:[1,0]
    s_nop 0
    v_cvt_pk_bf16_f32 v41, v148, v149
    v_pk_add_f32 v[150:151], v[122:123], v[144:145] op_sel_hi:[1,0] neg_lo:[0,1] neg_hi:[0,1]
    s_nop 0
    v_cvt_pk_bf16_f32 v150, v150, v151
    v_and_b32 v151, 0xffff0000, v150
    v_lshlrev_b32 v150, 16, v150
    v_pk_mul_f32 v[150:151], v[150:151], v[146:147] op_sel_hi:[1,0]
    s_nop 0
    v_cvt_pk_bf16_f32 v43, v150, v151
    v_pk_add_f32 v[148:149], v[124:125], v[144:145] op_sel_hi:[1,0] neg_lo:[0,1] neg_hi:[0,1]
    s_nop 0
    v_cvt_pk_bf16_f32 v148, v148, v149
    v_and_b32 v149, 0xffff0000, v148
    v_lshlrev_b32 v148, 16, v148
    v_pk_mul_f32 v[148:149], v[148:149], v[146:147] op_sel_hi:[1,0]
    s_nop 0
    v_cvt_pk_bf16_f32 v45, v148, v149
    v_pk_add_f32 v[150:151], v[126:127], v[144:145] op_sel_hi:[1,0] neg_lo:[0,1] neg_hi:[0,1]
    s_nop 0
    v_cvt_pk_bf16_f32 v150, v150, v151
    v_and_b32 v151, 0xffff0000, v150
    v_lshlrev_b32 v150, 16, v150
    v_pk_mul_f32 v[150:151], v[150:151], v[146:147] op_sel_hi:[1,0]
    s_nop 0
    v_cvt_pk_bf16_f32 v47, v150, v151
    v_pk_add_f32 v[148:149], v[128:129], v[144:145] op_sel_hi:[1,0] neg_lo:[0,1] neg_hi:[0,1]
    s_nop 0
    v_cvt_pk_bf16_f32 v148, v148, v149
    v_and_b32 v149, 0xffff0000, v148
    v_lshlrev_b32 v148, 16, v148
    v_pk_mul_f32 v[148:149], v[148:149], v[146:147] op_sel_hi:[1,0]
    s_nop 0
    v_cvt_pk_bf16_f32 v48, v148, v149
    v_pk_add_f32 v[150:151], v[130:131], v[144:145] op_sel_hi:[1,0] neg_lo:[0,1] neg_hi:[0,1]
    s_nop 0
    v_cvt_pk_bf16_f32 v150, v150, v151
    v_and_b32 v151, 0xffff0000, v150
    v_lshlrev_b32 v150, 16, v150
    v_pk_mul_f32 v[150:151], v[150:151], v[146:147] op_sel_hi:[1,0]
    s_nop 0
    v_cvt_pk_bf16_f32 v50, v150, v151
    v_pk_add_f32 v[148:149], v[132:133], v[144:145] op_sel_hi:[1,0] neg_lo:[0,1] neg_hi:[0,1]
    s_nop 0
    v_cvt_pk_bf16_f32 v148, v148, v149
    v_and_b32 v149, 0xffff0000, v148
    v_lshlrev_b32 v148, 16, v148
    v_pk_mul_f32 v[148:149], v[148:149], v[146:147] op_sel_hi:[1,0]
    s_nop 0
    v_cvt_pk_bf16_f32 v52, v148, v149
    v_pk_add_f32 v[150:151], v[134:135], v[144:145] op_sel_hi:[1,0] neg_lo:[0,1] neg_hi:[0,1]
    s_nop 0
    v_cvt_pk_bf16_f32 v150, v150, v151
    v_and_b32 v151, 0xffff0000, v150
    v_lshlrev_b32 v150, 16, v150
    v_pk_mul_f32 v[150:151], v[150:151], v[146:147] op_sel_hi:[1,0]
    s_nop 0
    v_cvt_pk_bf16_f32 v54, v150, v151
    v_pk_add_f32 v[148:149], v[136:137], v[144:145] op_sel_hi:[1,0] neg_lo:[0,1] neg_hi:[0,1]
    s_nop 0
    v_cvt_pk_bf16_f32 v148, v148, v149
    v_and_b32 v149, 0xffff0000, v148
    v_lshlrev_b32 v148, 16, v148
    v_pk_mul_f32 v[148:149], v[148:149], v[146:147] op_sel_hi:[1,0]
    s_nop 0
    v_cvt_pk_bf16_f32 v49, v148, v149
    v_pk_add_f32 v[150:151], v[138:139], v[144:145] op_sel_hi:[1,0] neg_lo:[0,1] neg_hi:[0,1]
    s_nop 0
    v_cvt_pk_bf16_f32 v150, v150, v151
    v_and_b32 v151, 0xffff0000, v150
    v_lshlrev_b32 v150, 16, v150
    v_pk_mul_f32 v[150:151], v[150:151], v[146:147] op_sel_hi:[1,0]
    s_nop 0
    v_cvt_pk_bf16_f32 v51, v150, v151
    v_pk_add_f32 v[148:149], v[140:141], v[144:145] op_sel_hi:[1,0] neg_lo:[0,1] neg_hi:[0,1]
    s_nop 0
    v_cvt_pk_bf16_f32 v148, v148, v149
    v_and_b32 v149, 0xffff0000, v148
    v_lshlrev_b32 v148, 16, v148
    v_pk_mul_f32 v[148:149], v[148:149], v[146:147] op_sel_hi:[1,0]
    s_nop 0
    v_cvt_pk_bf16_f32 v53, v148, v149
    v_pk_add_f32 v[150:151], v[142:143], v[144:145] op_sel_hi:[1,0] neg_lo:[0,1] neg_hi:[0,1]
    s_nop 0
    v_cvt_pk_bf16_f32 v150, v150, v151
    v_and_b32 v151, 0xffff0000, v150
    v_lshlrev_b32 v150, 16, v150
    v_pk_mul_f32 v[150:151], v[150:151], v[146:147] op_sel_hi:[1,0]
    s_nop 0
    v_cvt_pk_bf16_f32 v55, v150, v151
    v_lshrrev_b32 v4, 4, v0
    v_lshlrev_b32 v4, 10, v4
    v_bfe_u32 v5, v0, 3, 1
    v_lshlrev_b32 v5, 9, v5
    v_and_b32 v6, 7, v0
    v_lshlrev_b32 v6, 4, v6
    v_add3_u32 v4, v4, v5, v6
    s_lshr_b32 s3, s13, 1
    s_mul_i32 s3, s3, 20480
    s_and_b32 s4, s13, 1
    s_lshl_b32 s4, s4, 7
    s_add_u32 s3, s3, s4
    s_add_u32 s3, s3, 10485760
    buffer_store_dwordx4 v[16:19], v4, s[8:11], s3 offen sc1
    buffer_store_dwordx4 v[20:23], v4, s[8:11], s3 offen offset:256 sc1
    s_add_u32 s3, s3, 4096
    buffer_store_dwordx4 v[24:27], v4, s[8:11], s3 offen sc1
    buffer_store_dwordx4 v[28:31], v4, s[8:11], s3 offen offset:256 sc1
    s_add_u32 s3, s3, 4096
    buffer_store_dwordx4 v[32:35], v4, s[8:11], s3 offen sc1
    buffer_store_dwordx4 v[36:39], v4, s[8:11], s3 offen offset:256 sc1
    s_add_u32 s3, s3, 4096
    buffer_store_dwordx4 v[40:43], v4, s[8:11], s3 offen sc1
    buffer_store_dwordx4 v[44:47], v4, s[8:11], s3 offen offset:256 sc1
    s_add_u32 s3, s3, 4096
    buffer_store_dwordx4 v[48:51], v4, s[8:11], s3 offen sc1
    buffer_store_dwordx4 v[52:55], v4, s[8:11], s3 offen offset:256 sc1
PRO_D2:
    s_waitcnt vmcnt(0)
    s_barrier
    s_cmp_lg_u32 s26, 7
    s_cbranch_scc1 WR_CA
    v_readfirstlane_b32 s88, v10
    v_readfirstlane_b32 s3, v11
    s_lshr_b32 s3, s3, s28
    s_and_b32 s3, s3, 1
    s_lshl_b32 s3, s3, 12
    s_cmp_lt_u32 s88, 32
    s_cselect_b32 s89, 1, 4194305
    s_add_u32 s89, s89, s3
    v_mov_b32 v12, 16
    v_mov_b32 v13, s89
    s_mov_b64 exec, 1
    global_atomic_add v14, v12, v13, s[84:85] sc0 sc1
    s_mov_b64 exec, -1
    s_waitcnt vmcnt(0)
    v_readfirstlane_b32 s4, v14
    s_add_u32 s3, s89, s4
    s_and_b32 s4, s3, 0xfff
    s_cmp_lg_u32 s4, 256
    s_cbranch_scc1 PUB_6
    s_cmp_eq_u32 s3, 256
    s_cselect_b32 s4, 1, 3
    s_cmp_lt_u32 s3, 4194304
    s_cselect_b32 s4, s4, 2
    v_mov_b32 v12, 16
    v_mov_b32 v13, s4
    s_mov_b64 exec, 1
    global_store_dword v12, v13, s[84:85] offset:128 sc1
    s_mov_b64 exec, -1
PUB_6:
WR_CA:
    s_setprio 0
    s_barrier
    s_cmp_lg_u32 s26, 7
    s_cbranch_scc1 VW_7
    v_mov_b32 v62, 1
    s_cmp_lg_u32 s31, 0
    s_cbranch_scc1 VK_9
    v_mov_b32 v62, 2
    s_cmp_ge_u32 s88, 32
    s_cbranch_scc1 VK_9x
    v_mov_b32 v63, 16
VG_8:
    global_load_dword v62, v63, s[84:85] offset:128 sc1
    s_waitcnt vmcnt(0)
    v_cmp_ne_u32 vcc, 0, v62
    s_cbranch_vccnz VK_9
    s_sleep 8
    s_sub_u32 s30, s30, 1
    s_cbranch_scc0 VG_8
    s_branch END
VK_9x:
    v_mov_b32 v63, 16
VG_8x:
    global_load_dword v61, v63, s[84:85] offset:128 sc1
    s_waitcnt vmcnt(0)
    v_cmp_ne_u32 vcc, 0, v61
    s_cbranch_vccnz VK_9
    s_sleep 8
    s_sub_u32 s30, s30, 1
    s_cbranch_scc0 VG_8x
    s_branch END
VK_9:
    v_mov_b32 v63, 163832
    ds_write_b32 v63, v62
    s_waitcnt lgkmcnt(0)
VW_7:
    s_barrier
    v_mov_b32 v63, 163832
    ds_read_b32 v62, v63
    s_waitcnt lgkmcnt(0)
    v_readfirstlane_b32 s3, v62
    s_cmp_lg_u32 s3, 1
    s_cbranch_scc1 REROLE
    s_branch GO
REROLE:
    s_setprio 0
    s_waitcnt vmcnt(0) lgkmcnt(0)
    s_barrier
    v_mov_b32 v63, 0
    s_cmp_lg_u32 s26, 7
    s_cbranch_scc1 RR1
    v_mov_b32 v62, s88
    ds_write_b32 v63, v62
    s_waitcnt lgkmcnt(0)
RR1:
    s_barrier
    ds_read_b32 v62, v63
    s_waitcnt lgkmcnt(0)
    v_readfirstlane_b32 s28, v62
    s_barrier
    s_mov_b32 s31, 2
    s_cmp_eq_u32 s3, 3
    s_cbranch_scc1 ROLE
    s_mov_b32 s31, 1
    s_lshr_b32 s27, s2, 5
    s_and_b32 s28, s2, 31
    s_branch ROLE
GO:
    s_mov_b32 s29, 0
    s_cmp_ge_u32 s28, 28
    s_cbranch_scc1 FFN
    s_cmp_eq_u32 s31, 1
    s_cbranch_scc1 CHAIN_S
    s_lshl_b32 s33, s27, 12
    s_add_u32 s33, s33, 13631488
    s_cmp_ge_u32 s28, 18
    s_cbranch_scc1 COMB_F
    s_cmp_ge_u32 s26, 4
    s_cbranch_scc1 PAUX_F
    v_and_b32 v4, 15, v0
    v_cmp_gt_u32 vcc, 8, v4
    v_mov_b32 v5, 0xeeee
    v_mov_b32 v6, 0x4444
    v_cndmask_b32 v5, v5, v6, vcc
    v_add_u32 v11, 81920, v2
    s_cmp_ge_u32 s28, 12
    s_cbranch_scc1 VG_F
    v_and_b32 v4, 15, v0
    v_lshlrev_b32 v6, 5, v4
    v_lshrrev_b32 v7, 4, v0
    v_lshl_add_u32 v6, v7, 3, v6
    s_lshl_b32 s3, s26, 9
    s_add_u32 s3, s3, 92160
    v_add_u32 v6, s3, v6
    s_lshr_b32 s3, s26, 1
    s_lshl_b32 s3, s3, 10
    s_and_b32 s4, s26, 1
    s_lshl_b32 s4, s4, 3
    s_add_u32 s3, s3, s4
    s_add_u32 s3, s3, 94208
    v_add_u32 v7, s3, v2
    s_mov_b32 s29, -1
    s_branch SG_TOK_F
SG_LOOP_F:
    v_mov_b32 v56, 0
    v_mov_b32 v57, 0
    v_mov_b32 v58, 0
    v_mov_b32 v59, 0
    v_mov_b32 v60, 0
    v_mov_b32 v61, 0
    v_mov_b32 v62, 0
    v_mov_b32 v63, 0
    s_waitcnt lgkmcnt(0)
    s_barrier
    ds_read_b128 v[16:19], v11 offset:0
    ds_read_b128 v[20:23], v11 offset:1024
    ds_read_b128 v[24:27], v11 offset:2048
    ds_read_b128 v[28:31], v11 offset:3072
    ds_read_b128 v[32:35], v11 offset:4096
    ds_read_b128 v[36:39], v11 offset:5120
    ds_read_b128 v[40:43], v11 offset:6144
    ds_read_b128 v[44:47], v11 offset:7168
    ds_read_b128 v[48:51], v11 offset:8192
    ds_read_b128 v[52:55], v11 offset:9216
    s_waitcnt lgkmcnt(9)
    v_smfmac_f32_16x16x64_bf16 v[56:59], v[16:19], v[64:71], v5
    v_smfmac_f32_16x16x64_bf16 v[60:63], v[16:19], v[72:79], v5
    s_waitcnt lgkmcnt(8)
    v_smfmac_f32_16x16x64_bf16 v[56:59], v[20:23], v[80:87], v5
    v_smfmac_f32_16x16x64_bf16 v[60:63], v[20:23], v[88:95], v5
    s_waitcnt lgkmcnt(7)
    v_smfmac_f32_16x16x64_bf16 v[56:59], v[24:27], v[96:103], v5
    v_smfmac_f32_16x16x64_bf16 v[60:63], v[24:27], v[104:111], v5
    s_waitcnt lgkmcnt(6)
    v_smfmac_f32_16x16x64_bf16 v[56:59], v[28:31], v[112:119], v5
    v_smfmac_f32_16x16x64_bf16 v[60:63], v[28:31], v[120:127], v5
    s_waitcnt lgkmcnt(5)
    v_smfmac_f32_16x16x64_bf16 v[56:59], v[32:35], v[128:135], v5
    v_smfmac_f32_16x16x64_bf16 v[60:63], v[32:35], v[136:143], v5
    s_waitcnt lgkmcnt(4)
    v_smfmac_f32_16x16x64_bf16 v[56:59], v[36:39], v[144:151], v5
    v_smfmac_f32_16x16x64_bf16 v[60:63], v[36:39], v[152:159], v5
    s_waitcnt lgkmcnt(3)
    v_smfmac_f32_16x16x64_bf16 v[56:59], v[40:43], v[160:167], v5
    v_smfmac_f32_16x16x64_bf16 v[60:63], v[40:43], v[168:175], v5
    s_waitcnt lgkmcnt(2)
    v_smfmac_f32_16x16x64_bf16 v[56:59], v[44:47], v[176:183], v5
    v_smfmac_f32_16x16x64_bf16 v[60:63], v[44:47], v[184:191], v5
    s_waitcnt lgkmcnt(1)
    v_smfmac_f32_16x16x64_bf16 v[56:59], v[48:51], v[192:199], v5
    v_smfmac_f32_16x16x64_bf16 v[60:63], v[48:51], v[200:207], v5
    s_waitcnt lgkmcnt(0)
    v_smfmac_f32_16x16x64_bf16 v[56:59], v[52:55], v[208:215], v5
    v_smfmac_f32_16x16x64_bf16 v[60:63], v[52:55], v[216:223], v5
    s_nop 7
    v_permlane32_swap_b32 v56, v60
    v_permlane32_swap_b32 v57, v61
    v_permlane32_swap_b32 v58, v62
    v_permlane32_swap_b32 v59, v63
    v_pk_add_f32 v[56:57], v[56:57], v[60:61]
    v_pk_add_f32 v[58:59], v[58:59], v[62:63]
    v_cvt_pk_bf16_f32 v56, v56, v57
    v_cvt_pk_bf16_f32 v57, v58, v59
    ds_write_b64 v6, v[56:57]
    s_waitcnt lgkmcnt(0)
    s_barrier
    s_cmp_eq_u32 s29, 63
    s_cbranch_scc1 SG_END_F
SG_TOK_F:
    s_add_u32 s29, s29, 1
    s_and_b32 s3, s29, 1
    s_mul_i32 s3, s3, 40960
    v_add_u32 v9, s3, v2
    ds_read_b128 v[16:19], v9 offset:0
    ds_read_b128 v[20:23], v9 offset:20480
    ds_read_b128 v[24:27], v9 offset:1024
    ds_read_b128 v[28:31], v9 offset:21504
    ds_read_b128 v[32:35], v9 offset:2048
    s_waitcnt lgkmcnt(4)
    v_mfma_f32_16x16x32_bf16 v[224:227], v[64:67], v[16:19], 0
    v_mfma_f32_16x16x32_bf16 v[232:235], v[72:75], v[16:19], 0
    ds_read_b128 v[16:19], v9 offset:22528
    s_waitcnt lgkmcnt(4)
    v_mfma_f32_16x16x32_bf16 v[228:231], v[64:67], v[20:23], 0
    v_mfma_f32_16x16x32_bf16 v[236:239], v[72:75], v[20:23], 0
    ds_read_b128 v[20:23], v9 offset:3072
    s_waitcnt lgkmcnt(4)
    v_mfma_f32_16x16x32_bf16 v[224:227], v[68:71], v[24:27], v[224:227]
    v_mfma_f32_16x16x32_bf16 v[232:235], v[76:79], v[24:27], v[232:235]
    ds_read_b128 v[24:27], v9 offset:23552
    s_waitcnt lgkmcnt(4)
    v_mfma_f32_16x16x32_bf16 v[228:231], v[68:71], v[28:31], v[228:231]
    v_mfma_f32_16x16x32_bf16 v[236:239], v[76:79], v[28:31], v[236:239]
    ds_read_b128 v[28:31], v9 offset:4096
    s_waitcnt lgkmcnt(4)
    v_mfma_f32_16x16x32_bf16 v[224:227], v[80:83], v[32:35], v[224:227]
    v_mfma_f32_16x16x32_bf16 v[232:235], v[88:91], v[32:35], v[232:235]
    ds_read_b128 v[32:35], v9 offset:24576
    s_waitcnt lgkmcnt(4)
    v_mfma_f32_16x16x32_bf16 v[228:231], v[80:83], v[16:19], v[228:231]
    v_mfma_f32_16x16x32_bf16 v[236:239], v[88:91], v[16:19], v[236:239]
    ds_read_b128 v[16:19], v9 offset:5120
    s_waitcnt lgkmcnt(4)
    v_mfma_f32_16x16x32_bf16 v[224:227], v[84:87], v[20:23], v[224:227]
    v_mfma_f32_16x16x32_bf16 v[232:235], v[92:95], v[20:23], v[232:235]
    ds_read_b128 v[20:23], v9 offset:25600
    s_waitcnt lgkmcnt(4)
    v_mfma_f32_16x16x32_bf16 v[228:231], v[84:87], v[24:27], v[228:231]
    v_mfma_f32_16x16x32_bf16 v[236:239], v[92:95], v[24:27], v[236:239]
    ds_read_b128 v[24:27], v9 offset:6144
    s_waitcnt lgkmcnt(4)
    v_mfma_f32_16x16x32_bf16 v[224:227], v[96:99], v[28:31], v[224:227]
    v_mfma_f32_16x16x32_bf16 v[232:235], v[104:107], v[28:31], v[232:235]
    ds_read_b128 v[28:31], v9 offset:26624
    s_waitcnt lgkmcnt(4)
    v_mfma_f32_16x16x32_bf16 v[228:231], v[96:99], v[32:35], v[228:231]
    v_mfma_f32_16x16x32_bf16 v[236:239], v[104:107], v[32:35], v[236:239]
    ds_read_b128 v[32:35], v9 offset:7168
    s_waitcnt lgkmcnt(4)
    v_mfma_f32_16x16x32_bf16 v[224:227], v[100:103], v[16:19], v[224:227]
    v_mfma_f32_16x16x32_bf16 v[232:235], v[108:111], v[16:19], v[232:235]
    ds_read_b128 v[16:19], v9 offset:27648
    s_waitcnt lgkmcnt(4)
    v_mfma_f32_16x16x32_bf16 v[228:231], v[100:103], v[20:23], v[228:231]
    v_mfma_f32_16x16x32_bf16 v[236:239], v[108:111], v[20:23], v[236:239]
    ds_read_b128 v[20:23], v9 offset:8192
    s_waitcnt lgkmcnt(4)
    v_mfma_f32_16x16x32_bf16 v[224:227], v[112:115], v[24:27], v[224:227]
    v_mfma_f32_16x16x32_bf16 v[232:235], v[120:123], v[24:27], v[232:235]
    ds_read_b128 v[24:27], v9 offset:28672
    s_waitcnt lgkmcnt(4)
    v_mfma_f32_16x16x32_bf16 v[228:231], v[112:115], v[28:31], v[228:231]
    v_mfma_f32_16x16x32_bf16 v[236:239], v[120:123], v[28:31], v[236:239]
    ds_read_b128 v[28:31], v9 offset:9216
    s_waitcnt lgkmcnt(4)
    v_mfma_f32_16x16x32_bf16 v[224:227], v[116:119], v[32:35], v[224:227]
    v_mfma_f32_16x16x32_bf16 v[232:235], v[124:127], v[32:35], v[232:235]
    ds_read_b128 v[32:35], v9 offset:29696
    s_waitcnt lgkmcnt(4)
    v_mfma_f32_16x16x32_bf16 v[228:231], v[116:119], v[16:19], v[228:231]
    v_mfma_f32_16x16x32_bf16 v[236:239], v[124:127], v[16:19], v[236:239]
    ds_read_b128 v[16:19], v9 offset:10240
    s_waitcnt lgkmcnt(4)
    v_mfma_f32_16x16x32_bf16 v[224:227], v[128:131], v[20:23], v[224:227]
    v_mfma_f32_16x16x32_bf16 v[232:235], v[136:139], v[20:23], v[232:235]
    ds_read_b128 v[20:23], v9 offset:30720
    s_waitcnt lgkmcnt(4)
    v_mfma_f32_16x16x32_bf16 v[228:231], v[128:131], v[24:27], v[228:231]
    v_mfma_f32_16x16x32_bf16 v[236:239], v[136:139], v[24:27], v[236:239]
    ds_read_b128 v[24:27], v9 offset:11264
    s_waitcnt lgkmcnt(4)
    v_mfma_f32_16x16x32_bf16 v[224:227], v[132:135], v[28:31], v[224:227]
    v_mfma_f32_16x16x32_bf16 v[232:235], v[140:143], v[28:31], v[232:235]
    ds_read_b128 v[28:31], v9 offset:31744
    s_waitcnt lgkmcnt(4)
    v_mfma_f32_16x16x32_bf16 v[228:231], v[132:135], v[32:35], v[228:231]
    v_mfma_f32_16x16x32_bf16 v[236:239], v[140:143], v[32:35], v[236:239]
    ds_read_b128 v[32:35], v9 offset:12288
    s_waitcnt lgkmcnt(4)
    v_mfma_f32_16x16x32_bf16 v[224:227], v[144:147], v[16:19], v[224:227]
    v_mfma_f32_16x16x32_bf16 v[232:235], v[152:155], v[16:19], v[232:235]
    ds_read_b128 v[16:19], v9 offset:32768
    s_waitcnt lgkmcnt(4)
    v_mfma_f32_16x16x32_bf16 v[228:231], v[144:147], v[20:23], v[228:231]
    v_mfma_f32_16x16x32_bf16 v[236:239], v[152:155], v[20:23], v[236:239]
    ds_read_b128 v[20:23], v9 offset:13312
    s_waitcnt lgkmcnt(4)
    v_mfma_f32_16x16x32_bf16 v[224:227], v[148:151], v[24:27], v[224:227]
    v_mfma_f32_16x16x32_bf16 v[232:235], v[156:159], v[24:27], v[232:235]
    ds_read_b128 v[24:27], v9 offset:33792
    s_waitcnt lgkmcnt(4)
    v_mfma_f32_16x16x32_bf16 v[228:231], v[148:151], v[28:31], v[228:231]
    v_mfma_f32_16x16x32_bf16 v[236:239], v[156:159], v[28:31], v[236:239]
    ds_read_b128 v[28:31], v9 offset:14336
    s_waitcnt lgkmcnt(4)
    v_mfma_f32_16x16x32_bf16 v[224:227], v[160:163], v[32:35], v[224:227]
    v_mfma_f32_16x16x32_bf16 v[232:235], v[168:171], v[32:35], v[232:235]
    ds_read_b128 v[32:35], v9 offset:34816
    s_waitcnt lgkmcnt(4)
    v_mfma_f32_16x16x32_bf16 v[228:231], v[160:163], v[16:19], v[228:231]
    v_mfma_f32_16x16x32_bf16 v[236:239], v[168:171], v[16:19], v[236:239]
    ds_read_b128 v[16:19], v9 offset:15360
    s_waitcnt lgkmcnt(4)
    v_mfma_f32_16x16x32_bf16 v[224:227], v[164:167], v[20:23], v[224:227]
    v_mfma_f32_16x16x32_bf16 v[232:235], v[172:175], v[20:23], v[232:235]
    ds_read_b128 v[20:23], v9 offset:35840
    s_waitcnt lgkmcnt(4)
    v_mfma_f32_16x16x32_bf16 v[228:231], v[164:167], v[24:27], v[228:231]
    v_mfma_f32_16x16x32_bf16 v[236:239], v[172:175], v[24:27], v[236:239]
    ds_read_b128 v[24:27], v9 offset:16384
    s_waitcnt lgkmcnt(4)
    v_mfma_f32_16x16x32_bf16 v[224:227], v[176:179], v[28:31], v[224:227]
    v_mfma_f32_16x16x32_bf16 v[232:235], v[184:187], v[28:31], v[232:235]
    ds_read_b128 v[28:31], v9 offset:36864
    s_waitcnt lgkmcnt(4)
    v_mfma_f32_16x16x32_bf16 v[228:231], v[176:179], v[32:35], v[228:231]
    v_mfma_f32_16x16x32_bf16 v[236:239], v[184:187], v[32:35], v[236:239]
    ds_read_b128 v[32:35], v9 offset:17408
    s_waitcnt lgkmcnt(4)
    v_mfma_f32_16x16x32_bf16 v[224:227], v[180:183], v[16:19], v[224:227]
    v_mfma_f32_16x16x32_bf16 v[232:235], v[188:191], v[16:19], v[232:235]
    ds_read_b128 v[16:19], v9 offset:37888
    s_waitcnt lgkmcnt(4)
    v_mfma_f32_16x16x32_bf16 v[228:231], v[180:183], v[20:23], v[228:231]
    v_mfma_f32_16x16x32_bf16 v[236:239], v[188:191], v[20:23], v[236:239]
    ds_read_b128 v[20:23], v9 offset:18432
    s_waitcnt lgkmcnt(4)
    v_mfma_f32_16x16x32_bf16 v[224:227], v[192:195], v[24:27], v[224:227]
    v_mfma_f32_16x16x32_bf16 v[232:235], v[200:203], v[24:27], v[232:235]
    ds_read_b128 v[24:27], v9 offset:38912
    s_waitcnt lgkmcnt(4)
    v_mfma_f32_16x16x32_bf16 v[228:231], v[192:195], v[28:31], v[228:231]
    v_mfma_f32_16x16x32_bf16 v[236:239], v[200:203], v[28:31], v[236:239]
    ds_read_b128 v[28:31], v9 offset:19456
    s_waitcnt lgkmcnt(4)
    v_mfma_f32_16x16x32_bf16 v[224:227], v[196:199], v[32:35], v[224:227]
    v_mfma_f32_16x16x32_bf16 v[232:235], v[204:207], v[32:35], v[232:235]
    ds_read_b128 v[32:35], v9 offset:39936
    s_waitcnt lgkmcnt(4)
    v_mfma_f32_16x16x32_bf16 v[228:231], v[196:199], v[16:19], v[228:231]
    v_mfma_f32_16x16x32_bf16 v[236:239], v[204:207], v[16:19], v[236:239]
    s_waitcnt lgkmcnt(3)
    v_mfma_f32_16x16x32_bf16 v[224:227], v[208:211], v[20:23], v[224:227]
    v_mfma_f32_16x16x32_bf16 v[232:235], v[216:219], v[20:23], v[232:235]
    s_waitcnt lgkmcnt(2)
    v_mfma_f32_16x16x32_bf16 v[228:231], v[208:211], v[24:27], v[228:231]
    v_mfma_f32_16x16x32_bf16 v[236:239], v[216:219], v[24:27], v[236:239]
    s_waitcnt lgkmcnt(1)
    v_mfma_f32_16x16x32_bf16 v[224:227], v[212:215], v[28:31], v[224:227]
    v_mfma_f32_16x16x32_bf16 v[232:235], v[220:223], v[28:31], v[232:235]
    s_waitcnt lgkmcnt(0)
    v_mfma_f32_16x16x32_bf16 v[228:231], v[212:215], v[32:35], v[228:231]
    v_mfma_f32_16x16x32_bf16 v[236:239], v[220:223], v[32:35], v[236:239]
    s_nop 3
    v_cvt_pk_bf16_f32 v224, v224, v225
    v_cvt_pk_bf16_f32 v225, v226, v227
    ds_write_b64 v7, v[224:225] offset:0
    v_cvt_pk_bf16_f32 v228, v228, v229
    v_cvt_pk_bf16_f32 v229, v230, v231
    ds_write_b64 v7, v[228:229] offset:2048
    v_cvt_pk_bf16_f32 v232, v232, v233
    v_cvt_pk_bf16_f32 v233, v234, v235
    ds_write_b64 v7, v[232:233] offset:4096
    v_cvt_pk_bf16_f32 v236, v236, v237
    v_cvt_pk_bf16_f32 v237, v238, v239
    ds_write_b64 v7, v[236:237] offset:6144
    s_cmp_lg_u32 s29, 0
    s_cbranch_scc1 SG_LOOP_F
    s_barrier
    v_mov_b32 v63, 163832
    ds_read_b32 v62, v63
    s_waitcnt lgkmcnt(0)
    v_readfirstlane_b32 s3, v62
    s_cmp_lg_u32 s3, 1
    s_cbranch_scc1 REROLE
    s_branch SG_LOOP_F
SG_END_F:
    s_waitcnt vmcnt(0)
    s_waitcnt vmcnt(0)
    s_branch END
VG_F:
    v_bfe_u32 v6, v0, 3, 1
    v_lshlrev_b32 v6, 8, v6
    v_bfe_u32 v7, v0, 2, 1
    v_lshl_add_u32 v6, v7, 7, v6
    v_lshrrev_b32 v7, 5, v0
    v_lshl_add_u32 v6, v7, 6, v6
    v_and_b32 v7, 1, v0
    v_lshl_add_u32 v6, v7, 5, v6
    v_bfe_u32 v7, v0, 1, 1
    v_lshl_add_u32 v6, v7, 4, v6
    v_bfe_u32 v7, v0, 4, 1
    v_lshl_add_u32 v6, v7, 3, v6
    s_lshl_b32 s3, s26, 9
    s_add_u32 s3, s3, 92160
    v_add_u32 v6, s3, v6
    v_bfe_u32 v7, v0, 4, 1
    v_lshlrev_b32 v7, 8, v7
    v_and_b32 v8, 15, v0
    v_lshl_add_u32 v7, v8, 3, v7
    v_add_u32 v7, s3, v7
    s_sub_u32 s4, s28, 12
    s_lshl_b32 s4, s4, 2
    s_add_u32 s4, s4, s26
    s_lshl_b32 s3, s4, 9
    v_add_u32 v10, s3, v2
    v_mov_b32 v8, 2147483392
    v_cmp_gt_u32 vcc, 32, v0
    s_nop 1
    v_cndmask_b32 v10, v8, v10, vcc
    s_lshl_b32 s3, s4, 11
    v_add_u32 v8, s3, v2
    s_lshl_b32 s3, s4, 2
    v_mov_b32 v15, 2147483392
    s_nop 0
    v_writelane_b32 v15, s3, 0
    v_mov_b32 v240, -1
    v_mov_b32 v241, -1
    v_mov_b32 v242, -1
    v_mov_b32 v243, -1
    s_mov_b32 s29, -1
    s_mov_b32 s37, 0
    s_branch VG_TOK_F
VG_LOOP_F:
    v_mov_b32 v56, 0
    v_mov_b32 v57, 0
    v_mov_b32 v58, 0
    v_mov_b32 v59, 0
    v_mov_b32 v60, 0
    v_mov_b32 v61, 0
    v_mov_b32 v62, 0
    v_mov_b32 v63, 0
    s_and_b32 s34, s29, 3
    s_mul_i32 s34, s34, 12288
    s_add_u32 s34, s34, 40960
    s_add_u32 s34, s34, s32
    s_add_u32 s35, s29, 3
    s_and_b32 s35, s35, 3
    s_mul_i32 s35, s35, 12288
    s_add_u32 s35, s35, 40960
    s_add_u32 s35, s35, s32
    s_barrier
    ds_read_b128 v[16:19], v11 offset:0
    ds_read_b128 v[20:23], v11 offset:1024
    ds_read_b128 v[24:27], v11 offset:2048
    ds_read_b128 v[28:31], v11 offset:3072
    ds_read_b128 v[32:35], v11 offset:4096
    ds_read_b128 v[36:39], v11 offset:5120
    ds_read_b128 v[40:43], v11 offset:6144
    ds_read_b128 v[44:47], v11 offset:7168
    ds_read_b128 v[48:51], v11 offset:8192
    ds_read_b128 v[52:55], v11 offset:9216
    s_waitcnt lgkmcnt(9)
    v_smfmac_f32_16x16x64_bf16 v[56:59], v[16:19], v[64:71], v5
    v_smfmac_f32_16x16x64_bf16 v[60:63], v[16:19], v[72:79], v5
    s_waitcnt lgkmcnt(8)
    v_smfmac_f32_16x16x64_bf16 v[56:59], v[20:23], v[80:87], v5
    v_smfmac_f32_16x16x64_bf16 v[60:63], v[20:23], v[88:95], v5
    s_waitcnt lgkmcnt(7)
    v_smfmac_f32_16x16x64_bf16 v[56:59], v[24:27], v[96:103], v5
    v_smfmac_f32_16x16x64_bf16 v[60:63], v[24:27], v[104:111], v5
    s_waitcnt lgkmcnt(6)
    v_smfmac_f32_16x16x64_bf16 v[56:59], v[28:31], v[112:119], v5
    v_smfmac_f32_16x16x64_bf16 v[60:63], v[28:31], v[120:127], v5
    s_waitcnt lgkmcnt(5)
    v_smfmac_f32_16x16x64_bf16 v[56:59], v[32:35], v[128:135], v5
    v_smfmac_f32_16x16x64_bf16 v[60:63], v[32:35], v[136:143], v5
    s_waitcnt lgkmcnt(4)
    v_smfmac_f32_16x16x64_bf16 v[56:59], v[36:39], v[144:151], v5
    v_smfmac_f32_16x16x64_bf16 v[60:63], v[36:39], v[152:159], v5
    s_waitcnt lgkmcnt(3)
    v_smfmac_f32_16x16x64_bf16 v[56:59], v[40:43], v[160:167], v5
    v_smfmac_f32_16x16x64_bf16 v[60:63], v[40:43], v[168:175], v5
    s_waitcnt lgkmcnt(2)
    v_smfmac_f32_16x16x64_bf16 v[56:59], v[44:47], v[176:183], v5
    v_smfmac_f32_16x16x64_bf16 v[60:63], v[44:47], v[184:191], v5
    s_waitcnt lgkmcnt(1)
    v_smfmac_f32_16x16x64_bf16 v[56:59], v[48:51], v[192:199], v5
    v_smfmac_f32_16x16x64_bf16 v[60:63], v[48:51], v[200:207], v5
    s_waitcnt lgkmcnt(0)
    v_smfmac_f32_16x16x64_bf16 v[56:59], v[52:55], v[208:215], v5
    v_smfmac_f32_16x16x64_bf16 v[60:63], v[52:55], v[216:223], v5
    s_nop 7
    v_permlane32_swap_b32 v56, v60
    v_permlane32_swap_b32 v57, v61
    v_permlane32_swap_b32 v58, v62
    v_permlane32_swap_b32 v59, v63
    v_pk_add_f32 v[56:57], v[56:57], v[60:61]
    v_pk_add_f32 v[58:59], v[58:59], v[62:63]
    v_cvt_pk_bf16_f32 v56, v56, v57
    v_cvt_pk_bf16_f32 v57, v58, v59
    ds_write_b64 v6, v[56:57]
    ds_read_b64_tr_b16 v[56:57], v7
    ds_read_b64_tr_b16 v[58:59], v7 offset:128
    s_waitcnt lgkmcnt(1)
    v_min_u32 v56, -2, v56
    v_min_u32 v57, -2, v57
    s_waitcnt lgkmcnt(0)
    v_min_u32 v58, -2, v58
    v_min_u32 v59, -2, v59
    buffer_store_dwordx4 v[56:59], v10, s[8:11], s34 offen
    buffer_store_dwordx4 v[240:243], v10, s[8:11], s35 offen
    s_barrier
    s_cmp_lt_u32 s29, 61
    s_cbranch_scc1 VG_TOK_F
    s_cmp_eq_u32 s29, 63
    s_cbranch_scc1 VG_END_F
    s_add_u32 s29, s29, 1
    s_waitcnt vmcnt(0)
    s_branch VG_LOOP_F
VG_TOK_F:
    s_and_b32 s3, s37, 1
    s_mul_i32 s3, s3, 40960
    v_add_u32 v9, s3, v2
    s_and_b32 s36, s37, 3
    s_mul_i32 s36, s36, 49152
    s_add_u32 s36, s36, 163840
    s_add_u32 s36, s36, s32
    s_add_u32 s37, s37, 1
    v_mov_b32 v14, s37
    ds_read_b128 v[16:19], v9 offset:0
    ds_read_b128 v[20:23], v9 offset:20480
    ds_read_b128 v[24:27], v9 offset:1024
    ds_read_b128 v[28:31], v9 offset:21504
    ds_read_b128 v[32:35], v9 offset:2048
    s_waitcnt lgkmcnt(4)
    v_mfma_f32_16x16x32_bf16 v[224:227], v[64:67], v[16:19], 0
    v_mfma_f32_16x16x32_bf16 v[232:235], v[72:75], v[16:19], 0
    ds_read_b128 v[16:19], v9 offset:22528
    s_waitcnt lgkmcnt(4)
    v_mfma_f32_16x16x32_bf16 v[228:231], v[64:67], v[20:23], 0
    v_mfma_f32_16x16x32_bf16 v[236:239], v[72:75], v[20:23], 0
    ds_read_b128 v[20:23], v9 offset:3072
    s_waitcnt lgkmcnt(4)
    v_mfma_f32_16x16x32_bf16 v[224:227], v[68:71], v[24:27], v[224:227]
    v_mfma_f32_16x16x32_bf16 v[232:235], v[76:79], v[24:27], v[232:235]
    ds_read_b128 v[24:27], v9 offset:23552
    s_waitcnt lgkmcnt(4)
    v_mfma_f32_16x16x32_bf16 v[228:231], v[68:71], v[28:31], v[228:231]
    v_mfma_f32_16x16x32_bf16 v[236:239], v[76:79], v[28:31], v[236:239]
    ds_read_b128 v[28:31], v9 offset:4096
    s_waitcnt lgkmcnt(4)
    v_mfma_f32_16x16x32_bf16 v[224:227], v[80:83], v[32:35], v[224:227]
    v_mfma_f32_16x16x32_bf16 v[232:235], v[88:91], v[32:35], v[232:235]
    ds_read_b128 v[32:35], v9 offset:24576
    s_waitcnt lgkmcnt(4)
    v_mfma_f32_16x16x32_bf16 v[228:231], v[80:83], v[16:19], v[228:231]
    v_mfma_f32_16x16x32_bf16 v[236:239], v[88:91], v[16:19], v[236:239]
    ds_read_b128 v[16:19], v9 offset:5120
    s_waitcnt lgkmcnt(4)
    v_mfma_f32_16x16x32_bf16 v[224:227], v[84:87], v[20:23], v[224:227]
    v_mfma_f32_16x16x32_bf16 v[232:235], v[92:95], v[20:23], v[232:235]
    ds_read_b128 v[20:23], v9 offset:25600
    s_waitcnt lgkmcnt(4)
    v_mfma_f32_16x16x32_bf16 v[228:231], v[84:87], v[24:27], v[228:231]
    v_mfma_f32_16x16x32_bf16 v[236:239], v[92:95], v[24:27], v[236:239]
    ds_read_b128 v[24:27], v9 offset:6144
    s_waitcnt lgkmcnt(4)
    v_mfma_f32_16x16x32_bf16 v[224:227], v[96:99], v[28:31], v[224:227]
    v_mfma_f32_16x16x32_bf16 v[232:235], v[104:107], v[28:31], v[232:235]
    ds_read_b128 v[28:31], v9 offset:26624
    s_waitcnt lgkmcnt(4)
    v_mfma_f32_16x16x32_bf16 v[228:231], v[96:99], v[32:35], v[228:231]
    v_mfma_f32_16x16x32_bf16 v[236:239], v[104:107], v[32:35], v[236:239]
    ds_read_b128 v[32:35], v9 offset:7168
    s_waitcnt lgkmcnt(4)
    v_mfma_f32_16x16x32_bf16 v[224:227], v[100:103], v[16:19], v[224:227]
    v_mfma_f32_16x16x32_bf16 v[232:235], v[108:111], v[16:19], v[232:235]
    ds_read_b128 v[16:19], v9 offset:27648
    s_waitcnt lgkmcnt(4)
    v_mfma_f32_16x16x32_bf16 v[228:231], v[100:103], v[20:23], v[228:231]
    v_mfma_f32_16x16x32_bf16 v[236:239], v[108:111], v[20:23], v[236:239]
    ds_read_b128 v[20:23], v9 offset:8192
    s_waitcnt lgkmcnt(4)
    v_mfma_f32_16x16x32_bf16 v[224:227], v[112:115], v[24:27], v[224:227]
    v_mfma_f32_16x16x32_bf16 v[232:235], v[120:123], v[24:27], v[232:235]
    ds_read_b128 v[24:27], v9 offset:28672
    s_waitcnt lgkmcnt(4)
    v_mfma_f32_16x16x32_bf16 v[228:231], v[112:115], v[28:31], v[228:231]
    v_mfma_f32_16x16x32_bf16 v[236:239], v[120:123], v[28:31], v[236:239]
    ds_read_b128 v[28:31], v9 offset:9216
    s_waitcnt lgkmcnt(4)
    v_mfma_f32_16x16x32_bf16 v[224:227], v[116:119], v[32:35], v[224:227]
    v_mfma_f32_16x16x32_bf16 v[232:235], v[124:127], v[32:35], v[232:235]
    ds_read_b128 v[32:35], v9 offset:29696
    s_waitcnt lgkmcnt(4)
    v_mfma_f32_16x16x32_bf16 v[228:231], v[116:119], v[16:19], v[228:231]
    v_mfma_f32_16x16x32_bf16 v[236:239], v[124:127], v[16:19], v[236:239]
    ds_read_b128 v[16:19], v9 offset:10240
    s_waitcnt lgkmcnt(4)
    v_mfma_f32_16x16x32_bf16 v[224:227], v[128:131], v[20:23], v[224:227]
    v_mfma_f32_16x16x32_bf16 v[232:235], v[136:139], v[20:23], v[232:235]
    ds_read_b128 v[20:23], v9 offset:30720
    s_waitcnt lgkmcnt(4)
    v_mfma_f32_16x16x32_bf16 v[228:231], v[128:131], v[24:27], v[228:231]
    v_mfma_f32_16x16x32_bf16 v[236:239], v[136:139], v[24:27], v[236:239]
    ds_read_b128 v[24:27], v9 offset:11264
    s_waitcnt lgkmcnt(4)
    v_mfma_f32_16x16x32_bf16 v[224:227], v[132:135], v[28:31], v[224:227]
    v_mfma_f32_16x16x32_bf16 v[232:235], v[140:143], v[28:31], v[232:235]
    ds_read_b128 v[28:31], v9 offset:31744
    s_waitcnt lgkmcnt(4)
    v_mfma_f32_16x16x32_bf16 v[228:231], v[132:135], v[32:35], v[228:231]
    v_mfma_f32_16x16x32_bf16 v[236:239], v[140:143], v[32:35], v[236:239]
    ds_read_b128 v[32:35], v9 offset:12288
    s_waitcnt lgkmcnt(4)
    v_mfma_f32_16x16x32_bf16 v[224:227], v[144:147], v[16:19], v[224:227]
    v_mfma_f32_16x16x32_bf16 v[232:235], v[152:155], v[16:19], v[232:235]
    ds_read_b128 v[16:19], v9 offset:32768
    s_waitcnt lgkmcnt(4)
    v_mfma_f32_16x16x32_bf16 v[228:231], v[144:147], v[20:23], v[228:231]
    v_mfma_f32_16x16x32_bf16 v[236:239], v[152:155], v[20:23], v[236:239]
    ds_read_b128 v[20:23], v9 offset:13312
    s_waitcnt lgkmcnt(4)
    v_mfma_f32_16x16x32_bf16 v[224:227], v[148:151], v[24:27], v[224:227]
    v_mfma_f32_16x16x32_bf16 v[232:235], v[156:159], v[24:27], v[232:235]
    ds_read_b128 v[24:27], v9 offset:33792
    s_waitcnt lgkmcnt(4)
    v_mfma_f32_16x16x32_bf16 v[228:231], v[148:151], v[28:31], v[228:231]
    v_mfma_f32_16x16x32_bf16 v[236:239], v[156:159], v[28:31], v[236:239]
    ds_read_b128 v[28:31], v9 offset:14336
    s_waitcnt lgkmcnt(4)
    v_mfma_f32_16x16x32_bf16 v[224:227], v[160:163], v[32:35], v[224:227]
    v_mfma_f32_16x16x32_bf16 v[232:235], v[168:171], v[32:35], v[232:235]
    ds_read_b128 v[32:35], v9 offset:34816
    s_waitcnt lgkmcnt(4)
    v_mfma_f32_16x16x32_bf16 v[228:231], v[160:163], v[16:19], v[228:231]
    v_mfma_f32_16x16x32_bf16 v[236:239], v[168:171], v[16:19], v[236:239]
    ds_read_b128 v[16:19], v9 offset:15360
    s_waitcnt lgkmcnt(4)
    v_mfma_f32_16x16x32_bf16 v[224:227], v[164:167], v[20:23], v[224:227]
    v_mfma_f32_16x16x32_bf16 v[232:235], v[172:175], v[20:23], v[232:235]
    ds_read_b128 v[20:23], v9 offset:35840
    s_waitcnt lgkmcnt(4)
    v_mfma_f32_16x16x32_bf16 v[228:231], v[164:167], v[24:27], v[228:231]
    v_mfma_f32_16x16x32_bf16 v[236:239], v[172:175], v[24:27], v[236:239]
    ds_read_b128 v[24:27], v9 offset:16384
    s_waitcnt lgkmcnt(4)
    v_mfma_f32_16x16x32_bf16 v[224:227], v[176:179], v[28:31], v[224:227]
    v_mfma_f32_16x16x32_bf16 v[232:235], v[184:187], v[28:31], v[232:235]
    ds_read_b128 v[28:31], v9 offset:36864
    s_waitcnt lgkmcnt(4)
    v_mfma_f32_16x16x32_bf16 v[228:231], v[176:179], v[32:35], v[228:231]
    v_mfma_f32_16x16x32_bf16 v[236:239], v[184:187], v[32:35], v[236:239]
    ds_read_b128 v[32:35], v9 offset:17408
    s_waitcnt lgkmcnt(4)
    v_mfma_f32_16x16x32_bf16 v[224:227], v[180:183], v[16:19], v[224:227]
    v_mfma_f32_16x16x32_bf16 v[232:235], v[188:191], v[16:19], v[232:235]
    ds_read_b128 v[16:19], v9 offset:37888
    s_waitcnt lgkmcnt(4)
    v_mfma_f32_16x16x32_bf16 v[228:231], v[180:183], v[20:23], v[228:231]
    v_mfma_f32_16x16x32_bf16 v[236:239], v[188:191], v[20:23], v[236:239]
    ds_read_b128 v[20:23], v9 offset:18432
    s_waitcnt lgkmcnt(4)
    v_mfma_f32_16x16x32_bf16 v[224:227], v[192:195], v[24:27], v[224:227]
    v_mfma_f32_16x16x32_bf16 v[232:235], v[200:203], v[24:27], v[232:235]
    ds_read_b128 v[24:27], v9 offset:38912
    s_waitcnt lgkmcnt(4)
    v_mfma_f32_16x16x32_bf16 v[228:231], v[192:195], v[28:31], v[228:231]
    v_mfma_f32_16x16x32_bf16 v[236:239], v[200:203], v[28:31], v[236:239]
    ds_read_b128 v[28:31], v9 offset:19456
    s_waitcnt lgkmcnt(4)
    v_mfma_f32_16x16x32_bf16 v[224:227], v[196:199], v[32:35], v[224:227]
    v_mfma_f32_16x16x32_bf16 v[232:235], v[204:207], v[32:35], v[232:235]
    ds_read_b128 v[32:35], v9 offset:39936
    s_waitcnt lgkmcnt(4)
    v_mfma_f32_16x16x32_bf16 v[228:231], v[196:199], v[16:19], v[228:231]
    v_mfma_f32_16x16x32_bf16 v[236:239], v[204:207], v[16:19], v[236:239]
    s_waitcnt lgkmcnt(3)
    v_mfma_f32_16x16x32_bf16 v[224:227], v[208:211], v[20:23], v[224:227]
    v_mfma_f32_16x16x32_bf16 v[232:235], v[216:219], v[20:23], v[232:235]
    s_waitcnt lgkmcnt(2)
    v_mfma_f32_16x16x32_bf16 v[228:231], v[208:211], v[24:27], v[228:231]
    v_mfma_f32_16x16x32_bf16 v[236:239], v[216:219], v[24:27], v[236:239]
    s_waitcnt lgkmcnt(1)
    v_mfma_f32_16x16x32_bf16 v[224:227], v[212:215], v[28:31], v[224:227]
    v_mfma_f32_16x16x32_bf16 v[232:235], v[220:223], v[28:31], v[232:235]
    s_waitcnt lgkmcnt(0)
    v_mfma_f32_16x16x32_bf16 v[228:231], v[212:215], v[32:35], v[228:231]
    v_mfma_f32_16x16x32_bf16 v[236:239], v[220:223], v[32:35], v[236:239]
    s_cmp_lg_u32 s37, 1
    s_cbranch_scc1 VG_ST_F
    s_barrier
    v_mov_b32 v63, 163832
    ds_read_b32 v62, v63
    s_waitcnt lgkmcnt(0)
    v_readfirstlane_b32 s3, v62
    s_cmp_lg_u32 s3, 1
    s_cbranch_scc1 REROLE
VG_ST_F:
    s_nop 1
    v_cvt_pk_bf16_f32 v16, v224, v225
    v_cvt_pk_bf16_f32 v17, v226, v227
    v_cvt_pk_bf16_f32 v18, v232, v233
    v_cvt_pk_bf16_f32 v19, v234, v235
    buffer_store_dwordx4 v[16:19], v8, s[8:11], s36 offen offset:0
    v_cvt_pk_bf16_f32 v20, v228, v229
    v_cvt_pk_bf16_f32 v21, v230, v231
    v_cvt_pk_bf16_f32 v22, v236, v237
    v_cvt_pk_bf16_f32 v23, v238, v239
    buffer_store_dwordx4 v[20:23], v8, s[8:11], s36 offen offset:1024
    s_waitcnt vmcnt(0)
    buffer_store_dword v14, v15, s[8:11], s33 offen
    s_lshl_b32 s3, s29, 1
    s_add_u32 s3, s3, 2
    s_add_u32 s4, s29, 3
    s_min_i32 s3, s3, s4
    s_cmp_le_i32 s37, s3
    s_cbranch_scc1 VG_2_F
    s_add_u32 s29, s29, 1
    s_branch VG_LOOP_F
VG_2_F:
    s_barrier
    s_branch VG_TOK_F
VG_END_F:
    s_waitcnt vmcnt(0)
    s_waitcnt vmcnt(0)
    s_branch END
PAUX_F:
    s_setprio 2
    s_sub_u32 s14, s26, 4
    s_lshl_b32 s3, s14, 10
    v_add_u32 v4, s3, v2
    v_add_u32 v12, 81920, v4
    s_cmp_lt_u32 s14, 2
    s_cselect_b64 vcc, -1, 0
    v_mov_b32 v8, 2147483392
    v_cndmask_b32 v8, v8, v4, vcc
    v_add_u32 v13, 102400, v2
    v_add_u32 v5, 8192, v12
    v_cndmask_b32 v13, v13, v5, vcc
    ds_write_b128 v12, v[200:203]
    ds_write_b128 v12, v[204:207] offset:4096
    ds_write_b128 v13, v[208:211]
    s_lshl_b32 s40, s28, 2
    s_add_u32 s40, s40, s14
    s_cmp_lt_u32 s28, 10
    s_cselect_b32 s40, s40, -1
    s_lshr_b32 s3, s28, 1
    s_lshr_b32 s4, s40, 2
    s_cmp_lt_i32 s40, 0
    s_cselect_b32 s3, s3, s4
    s_lshl_b32 s3, s3, 7
    s_add_u32 s3, s3, 2048
    v_mov_b32 v140, s3
    s_max_i32 s5, s40, 0
    s_lshr_b32 s3, s5, 2
    s_lshl_b32 s3, s3, 15
    s_and_b32 s4, s5, 3
    s_lshl_b32 s4, s4, 9
    s_add_u32 s3, s3, s4
    v_and_b32 v142, 31, v0
    v_lshlrev_b32 v141, 4, v142
    v_lshrrev_b32 v143, 5, v0
    v_lshl_add_u32 v141, v143, 11, v141
    v_add_u32 v141, s3, v141
    s_lshl_b32 s3, s5, 8
    v_lshlrev_b32 v142, 3, v142
    v_lshl_add_u32 v142, v143, 2, v142
    v_add_u32 v142, s3, v142
    v_mov_b32 v143, -1
    s_lshr_b32 s41, s27, 2
    s_lshl_b32 s41, s41, 14
    s_cmp_ge_u32 s28, 12
    s_cbranch_scc1 VA_F
    s_cmp_eq_u32 s14, 3
    s_cselect_b32 s3, 0, 4096
    s_cmp_eq_u32 s14, 1
    s_cselect_b32 s4, 2048, 0
    s_add_u32 s3, s3, s4
    s_add_u32 s3, s3, 94208
    v_add_u32 v14, s3, v2
    s_cmp_eq_u32 s14, 0
    s_cselect_b32 s3, 0, 2048
    s_add_u32 s3, s3, 94208
    v_add_u32 v15, s3, v2
    v_add_u32 v7, 92160, v3
    v_and_b32 v6, 7, v0
    v_lshrrev_b32 v9, 4, v0
    v_lshl_add_u32 v11, v6, 2, v9
    v_lshlrev_b32 v11, 4, v11
    s_lshl_b32 s3, s14, 9
    v_add_u32 v11, s3, v11
    v_lshl_add_u32 v9, v9, 3, v6
    v_lshlrev_b32 v9, 4, v9
    v_add_u32 v9, 768, v9
    s_cmp_eq_u32 s14, 2
    s_cselect_b64 vcc, -1, 0
    v_cndmask_b32 v11, v11, v9, vcc
    s_mul_i32 s3, s28, 1280
    v_add_u32 v11, s3, v11
    s_mov_b32 s5, 0x00ff00ff
    s_cselect_b32 s4, 0, s5
    s_mov_b64 vcc, s[4:5]
    v_mov_b32 v9, 2147483392
    v_cndmask_b32 v11, v9, v11, vcc
    s_lshl_b32 s3, s28, 2
    s_add_u32 s3, s3, s14
    s_lshl_b32 s4, s3, 10
    v_add_u32 v10, s4, v2
    s_lshl_b32 s3, s3, 2
    s_add_u32 s3, s3, 128
    v_mov_b32 v6, 2147483392
    s_nop 0
    v_writelane_b32 v6, s3, 0
    s_mov_b32 s29, 0
    s_cmp_lg_u32 s26, 7
    s_cbranch_scc1 VW_10
    v_mov_b32 v62, 1
    s_cmp_lg_u32 s31, 0
    s_cbranch_scc1 VK_12
    v_mov_b32 v62, 2
    s_cmp_ge_u32 s88, 32
    s_cbranch_scc1 VK_12x
    v_mov_b32 v63, 16
VG_11:
    global_load_dword v62, v63, s[84:85] offset:128 sc1
    s_waitcnt vmcnt(0)
    v_cmp_ne_u32 vcc, 0, v62
    s_cbranch_vccnz VK_12
    s_sleep 8
    s_sub_u32 s30, s30, 1
    s_cbranch_scc0 VG_11
    s_branch END
VK_12x:
    v_mov_b32 v63, 16
VG_11x:
    global_load_dword v61, v63, s[84:85] offset:128 sc1
    s_waitcnt vmcnt(0)
    v_cmp_ne_u32 vcc, 0, v61
    s_cbranch_vccnz VK_12
    s_sleep 8
    s_sub_u32 s30, s30, 1
    s_cbranch_scc0 VG_11x
    s_branch END
VK_12:
    v_mov_b32 v63, 163832
    ds_write_b32 v63, v62
    s_waitcnt lgkmcnt(0)
VW_10:
    s_barrier
    v_mov_b32 v63, 163832
    ds_read_b32 v62, v63
    s_waitcnt lgkmcnt(0)
    v_readfirstlane_b32 s3, v62
    s_cmp_lg_u32 s3, 1
    s_cbranch_scc1 REROLE
    s_branch SA_GOT_F
SA_LOOP_F:
    s_add_u32 s36, s29, 3
    s_and_b32 s36, s36, 3
    s_mul_i32 s36, s36, 327680
    s_add_u32 s36, s36, 8388608
    s_and_b32 s37, s29, 3
    s_mul_i32 s37, s37, 10240
    s_add_u32 s37, s37, s32
    s_add_u32 s35, s29, 3
    s_and_b32 s35, s35, 3
    s_mul_i32 s35, s35, 10240
    s_add_u32 s35, s35, s32
    s_sub_u32 s3, s29, 1
    s_lshr_b32 s25, s3, 2
    s_and_b32 s25, s25, 1
    s_add_u32 s25, s25, 1
    s_xor_b32 s3, s41, 16384
    s_add_u32 s16, s36, s41
    s_add_u32 s17, s16, 4096
    s_add_u32 s18, s36, s3
    s_add_u32 s19, s18, 4096
    s_lshl_b32 s43, s29, 1
    buffer_load_dword v144, v140, s[8:11], s33 offen sc1
    s_nop 15
    buffer_load_dword v145, v140, s[8:11], s33 offen sc1
    s_nop 15
H3F_15:
    buffer_load_dword v146, v140, s[8:11], s33 offen sc1
    s_waitcnt vmcnt(2)
    v_cmp_gt_u32 vcc, s43, v144
    s_cbranch_vccz H3G_16
    buffer_load_dword v144, v140, s[8:11], s33 offen sc1
    s_waitcnt vmcnt(2)
    v_cmp_gt_u32 vcc, s43, v145
    s_cbranch_vccz H3G_16
    buffer_load_dword v145, v140, s[8:11], s33 offen sc1
    s_waitcnt vmcnt(2)
    v_cmp_gt_u32 vcc, s43, v146
    s_cbranch_vccz H3G_16
    s_sub_u32 s30, s30, 1
    s_cbranch_scc0 H3F_15
    s_branch END
H3G_16:
    s_cmp_lt_i32 s40, 0
    s_cbranch_scc1 H3N_13
    s_cmp_lg_u32 s29, 1
    s_cbranch_scc1 H3G_16_c
    s_waitcnt vmcnt(0)
    v_max3_u32 v147, v144, v145, v146
    v_and_b32 v147, 1, v147
    v_lshl_add_u32 v141, v147, 13, v141
H3G_16_c:
    s_nop 15
    s_nop 15
    s_nop 15
    s_nop 15
    s_nop 3
H3P_17:
    s_sub_u32 s30, s30, 1
    s_cbranch_scc1 END
    buffer_load_dwordx4 v[148:151], v141, s[8:11], s16 offen sc1
    buffer_load_dwordx4 v[152:155], v141, s[8:11], s17 offen sc1
    buffer_load_dwordx4 v[156:159], v141, s[8:11], s18 offen sc1
    buffer_load_dwordx4 v[160:163], v141, s[8:11], s19 offen sc1
    s_waitcnt vmcnt(3)
    v_bitop3_b32 v52, s25, v148, v149 bitop3:0x80
    v_bitop3_b32 v52, v52, v150, v151 bitop3:0x80
    s_waitcnt vmcnt(2)
    v_pk_add_f32 v[164:165], v[148:149], v[152:153]
    v_pk_add_f32 v[166:167], v[150:151], v[154:155]
    v_bitop3_b32 v52, v52, v152, v153 bitop3:0x80
    v_bitop3_b32 v52, v52, v154, v155 bitop3:0x80
    s_waitcnt vmcnt(1)
    v_pk_add_f32 v[164:165], v[164:165], v[156:157]
    v_pk_add_f32 v[166:167], v[166:167], v[158:159]
    v_bitop3_b32 v52, v52, v156, v157 bitop3:0x80
    v_bitop3_b32 v52, v52, v158, v159 bitop3:0x80
    s_waitcnt vmcnt(0)
    v_pk_add_f32 v[164:165], v[164:165], v[160:161]
    v_pk_add_f32 v[166:167], v[166:167], v[162:163]
    v_bitop3_b32 v52, v52, v160, v161 bitop3:0x80
    v_bitop3_b32 v52, v52, v162, v163 bitop3:0x80
    v_permlane32_swap_b32 v164, v166
    v_permlane32_swap_b32 v165, v167
    v_cmp_eq_u32 vcc, 0, v52
    v_pk_add_f32 v[164:165], v[164:165], v[166:167]
    v_cvt_pk_bf16_f32 v166, v164, v165
    v_min_u32 v166, -2, v166
    s_cbranch_vccnz H3P_17
H3K_18:
    buffer_store_dword v166, v142, s[8:11], s37 offen
    buffer_store_dword v143, v142, s[8:11], s35 offen
    s_branch H3D_14
H3N_13:
    s_sleep 10
H3D_14:
    s_and_b32 s34, s29, 3
    s_mul_i32 s34, s34, 10240
    s_add_u32 s34, s34, s32
    s_add_u32 s35, s34, 4096
    s_add_u32 s36, s34, 8192
H1P_19:
    buffer_load_dwordx4 v[116:119], v4, s[8:11], s34 offen sc1
    buffer_load_dwordx4 v[120:123], v4, s[8:11], s35 offen sc1
    buffer_load_dwordx4 v[124:127], v8, s[8:11], s36 offen sc1
    s_waitcnt vmcnt(2)
    ds_write_b128 v12, v[116:119]
    v_max3_u32 v52, v116, v117, v118
    s_waitcnt vmcnt(1)
    ds_write_b128 v12, v[120:123] offset:4096
    v_max3_u32 v52, v119, v120, v52
    v_max3_u32 v52, v121, v122, v52
    s_waitcnt vmcnt(0)
    ds_write_b128 v13, v[124:127]
    v_max3_u32 v52, v123, v124, v52
    v_max3_u32 v52, v125, v126, v52
    v_max_u32 v52, v127, v52
    v_cmp_eq_u32 vcc, -1, v52
    s_cbranch_vccz SA_GOT_F
    s_waitcnt lgkmcnt(0)
    s_sub_u32 s30, s30, 1
    s_cbranch_scc0 H1P_19
    s_branch END
SA_GOT_F:
    s_waitcnt lgkmcnt(0)
    s_barrier
    ds_read_b128 v[24:27], v14
    ds_read_b128 v[28:31], v14 offset:1024
    ds_read_b128 v[32:35], v15
    ds_read_b128 v[36:39], v15 offset:1024
    s_and_b32 s35, s29, 3
    s_mul_i32 s35, s35, 15360
    s_add_u32 s35, s35, 90112
    s_add_u32 s35, s35, s32
    s_and_b32 s36, s29, 3
    s_mul_i32 s36, s36, 49152
    s_add_u32 s36, s36, 360448
    s_add_u32 s36, s36, s32
    s_lshr_b32 s37, s29, 2
    s_and_b32 s37, s37, 1
    s_add_u32 s37, s37, 1
    s_add_u32 s3, s29, 1
    v_mov_b32 v9, s3
    s_waitcnt lgkmcnt(0)
    s_cmp_eq_u32 s14, 2
    s_cbranch_scc1 SA_2_F
    s_cmp_eq_u32 s14, 3
    s_cbranch_scc1 SA_3_F
    s_barrier
    ds_read_b64_tr_b16 v[40:41], v7 offset:0
    ds_read_b64_tr_b16 v[42:43], v7 offset:512
    ds_read_b64_tr_b16 v[44:45], v7 offset:1024
    ds_read_b64_tr_b16 v[46:47], v7 offset:1536
    s_waitcnt lgkmcnt(2)
    v_mfma_f32_16x16x32_bf16 v[48:51], v[24:27], v[40:43], 0
    s_waitcnt lgkmcnt(0)
    v_mfma_f32_16x16x32_bf16 v[48:51], v[28:31], v[44:47], v[48:51]
    s_nop 7
    v_and_or_b32 v48, v48, -4, s37
    v_and_or_b32 v49, v49, -4, s37
    v_and_or_b32 v50, v50, -4, s37
    v_and_or_b32 v51, v51, -4, s37
    buffer_store_dwordx4 v[48:51], v11, s[8:11], s35 offen
    s_branch SA_X_F
SA_2_F:
    s_barrier
    ds_read_b64_tr_b16 v[40:41], v7 offset:0
    ds_read_b64_tr_b16 v[42:43], v7 offset:512
    ds_read_b64_tr_b16 v[44:45], v7 offset:1024
    ds_read_b64_tr_b16 v[46:47], v7 offset:1536
    s_waitcnt lgkmcnt(2)
    v_mfma_f32_16x16x32_bf16 v[48:51], v[40:43], v[40:43], 0
    s_waitcnt lgkmcnt(0)
    v_mfma_f32_16x16x32_bf16 v[48:51], v[44:47], v[44:47], v[48:51]
    s_nop 7
    v_and_or_b32 v48, v48, -4, s37
    v_and_or_b32 v49, v49, -4, s37
    v_and_or_b32 v50, v50, -4, s37
    v_and_or_b32 v51, v51, -4, s37
    buffer_store_dwordx4 v[48:51], v11, s[8:11], s35 offen
SA_X_F:
    v_mfma_f32_16x16x32_bf16 v[56:59], v[24:27], v[32:35], 0
    v_mfma_f32_16x16x32_bf16 v[56:59], v[28:31], v[36:39], v[56:59]
    s_branch SA_F_F
SA_3_F:
    s_barrier
    ds_read_b64_tr_b16 v[40:41], v7 offset:0
    ds_read_b64_tr_b16 v[42:43], v7 offset:512
    ds_read_b64_tr_b16 v[44:45], v7 offset:1024
    ds_read_b64_tr_b16 v[46:47], v7 offset:1536
    s_waitcnt lgkmcnt(0)
    v_mfma_f32_16x16x32_bf16 v[52:55], v[40:43], v[24:27], 0
    v_mfma_f32_16x16x32_bf16 v[56:59], v[40:43], v[32:35], 0
    v_mfma_f32_16x16x32_bf16 v[52:55], v[44:47], v[28:31], v[52:55]
    v_mfma_f32_16x16x32_bf16 v[56:59], v[44:47], v[36:39], v[56:59]
    s_nop 7
    v_permlane32_swap_b32 v52, v56
    v_permlane32_swap_b32 v53, v57
    v_permlane32_swap_b32 v54, v58
    v_permlane32_swap_b32 v55, v59
SA_F_F:
    s_nop 6
    buffer_store_dwordx4 v[56:59], v10, s[8:11], s36 offen
    s_waitcnt vmcnt(0)
    buffer_store_dword v9, v6, s[8:11], s33 offen
    s_cmp_eq_u32 s29, 63
    s_cbranch_scc1 SA_END_F
    s_cmp_eq_u32 s29, 62
    s_cbranch_scc1 SA_N_F
    s_mul_i32 s5, s14, 10240
    s_and_b32 s3, s29, 1
    s_mul_i32 s3, s3, 40960
    s_add_u32 s3, s3, s5
    s_mul_i32 s4, s29, 40960
    s_add_u32 s4, s4, s5
    s_add_u32 s4, s4, 10567680
    s_mov_b32 m0, s3
    s_nop 0
    buffer_load_dwordx4 v2, s[8:11], s4 offen offset:0 sc1 lds
    buffer_load_dwordx4 v2, s[8:11], s4 offen offset:1024 sc1 lds
    buffer_load_dwordx4 v2, s[8:11], s4 offen offset:2048 sc1 lds
    buffer_load_dwordx4 v2, s[8:11], s4 offen offset:3072 sc1 lds
    s_add_u32 s3, s3, 4096
    s_add_u32 s4, s4, 4096
    s_mov_b32 m0, s3
    s_nop 0
    buffer_load_dwordx4 v2, s[8:11], s4 offen offset:0 sc1 lds
    buffer_load_dwordx4 v2, s[8:11], s4 offen offset:1024 sc1 lds
    buffer_load_dwordx4 v2, s[8:11], s4 offen offset:2048 sc1 lds
    buffer_load_dwordx4 v2, s[8:11], s4 offen offset:3072 sc1 lds
    s_add_u32 s3, s3, 4096
    s_add_u32 s4, s4, 4096
    s_mov_b32 m0, s3
    s_nop 0
    buffer_load_dwordx4 v2, s[8:11], s4 offen offset:0 sc1 lds
    buffer_load_dwordx4 v2, s[8:11], s4 offen offset:1024 sc1 lds
SA_N_F:
    s_add_u32 s29, s29, 1
    s_branch SA_LOOP_F
SA_END_F:
    s_waitcnt vmcnt(0)
    s_waitcnt vmcnt(0)
    s_branch END
VA_F:
    s_sub_u32 s15, s28, 12
    s_mul_i32 s3, s15, 12288
    s_lshl_b32 s4, s14, 11
    s_add_u32 s4, s4, s3
    v_add_u32 v14, s4, v2
    s_add_u32 s4, s3, 1024
    v_add_u32 v15, s4, v2
    v_mov_b32 v9, 2147483392
    s_cmp_eq_u32 s14, 1
    s_cselect_b64 vcc, -1, 0
    v_cndmask_b32 v15, v9, v15, vcc
    s_lshl_b32 s4, s14, 9
    s_add_u32 s4, s4, s3
    s_add_u32 s4, s4, 2560
    v_add_u32 v7, s4, v2
    v_cmp_le_u32 vcc, 32, v0
    s_nop 1
    v_cndmask_b32 v7, v9, v7, vcc
    s_mul_i32 s3, s14, 5120
    s_lshl_b32 s4, s15, 10
    s_add_u32 s4, s4, s3
    v_add_u32 v10, s4, v2
    v_and_b32 v6, 15, v0
    v_lshlrev_b32 v11, 4, v6
    v_bfe_u32 v64, v0, 4, 1
    v_lshl_add_u32 v11, v64, 3, v11
    s_lshl_b32 s4, s15, 8
    s_add_u32 s4, s4, s3
    s_add_u32 s4, s4, 4096
    v_add_u32 v11, s4, v11
    v_cndmask_b32 v11, v9, v11, vcc
    v_mov_b32 v65, 0xf149f2ca
    v_mov_b32 v66, 0
    v_cndmask_b32 v108, v65, v66, vcc
    v_cndmask_b32 v109, v65, v66, vcc
    v_cndmask_b32 v110, v65, v66, vcc
    v_cndmask_b32 v111, v65, v66, vcc
    s_lshl_b32 s3, s14, 4
    v_add_u32 v6, s3, v6
    v_lshrrev_b32 v64, 4, v0
    v_lshlrev_b32 v64, 2, v64
    v_sub_u32 v6, v6, v64
    v_cmp_le_i32 vcc, 0, v6
    s_nop 1
    v_cndmask_b32 v100, v65, v66, vcc
    v_cmp_le_i32 vcc, 1, v6
    s_nop 1
    v_cndmask_b32 v101, v65, v66, vcc
    v_cmp_le_i32 vcc, 2, v6
    s_nop 1
    v_cndmask_b32 v102, v65, v66, vcc
    v_cmp_le_i32 vcc, 3, v6
    s_nop 1
    v_cndmask_b32 v103, v65, v66, vcc
    v_cmp_le_i32 vcc, 16, v6
    s_nop 1
    v_cndmask_b32 v104, v65, v66, vcc
    v_cmp_le_i32 vcc, 17, v6
    s_nop 1
    v_cndmask_b32 v105, v65, v66, vcc
    v_cmp_le_i32 vcc, 18, v6
    s_nop 1
    v_cndmask_b32 v106, v65, v66, vcc
    v_cmp_le_i32 vcc, 19, v6
    s_nop 1
    v_cndmask_b32 v107, v65, v66, vcc
    v_min_u32 v6, 11, v0
    v_lshlrev_b32 v6, 2, v6
    s_mul_i32 s3, s15, 48
    s_add_u32 s3, s3, 128
    v_add_u32 v6, s3, v6
    s_lshl_b32 s3, s14, 2
    s_add_u32 s3, s3, s15
    s_lshl_b32 s3, s3, 2
    s_add_u32 s3, s3, 384
    v_mov_b32 v112, 2147483392
    s_nop 0
    v_writelane_b32 v112, s3, 0
    s_mov_b32 s38, 0x3dd53b95
    v_mov_b32 v114, s38
    v_mov_b32 v115, s38
    s_cmp_lt_u32 s15, 4
    s_cselect_b32 s39, 1, 0
    s_cmp_lt_u32 s14, 2
    s_cselect_b32 s39, s39, 0
    s_mov_b32 s29, 0
    s_mov_b32 s42, 2
    s_cmp_lg_u32 s26, 7
    s_cbranch_scc1 VW_20
    v_mov_b32 v62, 1
    s_cmp_lg_u32 s31, 0
    s_cbranch_scc1 VK_22
    v_mov_b32 v62, 2
    s_cmp_ge_u32 s88, 32
    s_cbranch_scc1 VK_22x
    v_mov_b32 v63, 16
VG_21:
    global_load_dword v62, v63, s[84:85] offset:128 sc1
    s_waitcnt vmcnt(0)
    v_cmp_ne_u32 vcc, 0, v62
    s_cbranch_vccnz VK_22
    s_sleep 8
    s_sub_u32 s30, s30, 1
    s_cbranch_scc0 VG_21
    s_branch END
VK_22x:
    v_mov_b32 v63, 16
VG_21x:
    global_load_dword v61, v63, s[84:85] offset:128 sc1
    s_waitcnt vmcnt(0)
    v_cmp_ne_u32 vcc, 0, v61
    s_cbranch_vccnz VK_22
    s_sleep 8
    s_sub_u32 s30, s30, 1
    s_cbranch_scc0 VG_21x
    s_branch END
VK_22:
    v_mov_b32 v63, 163832
    ds_write_b32 v63, v62
    s_waitcnt lgkmcnt(0)
VW_20:
    s_barrier
    v_mov_b32 v63, 163832
    ds_read_b32 v62, v63
    s_waitcnt lgkmcnt(0)
    v_readfirstlane_b32 s3, v62
    s_cmp_lg_u32 s3, 1
    s_cbranch_scc1 REROLE
    s_branch VA_GOT_F
VA_LOOP_F:
    s_cmp_lg_u32 s39, 0
    s_cbranch_scc1 VA_P_F
    s_add_u32 s36, s29, 3
    s_and_b32 s36, s36, 3
    s_mul_i32 s36, s36, 327680
    s_add_u32 s36, s36, 8388608
    s_and_b32 s37, s29, 3
    s_mul_i32 s37, s37, 10240
    s_add_u32 s37, s37, s32
    s_add_u32 s35, s29, 3
    s_and_b32 s35, s35, 3
    s_mul_i32 s35, s35, 10240
    s_add_u32 s35, s35, s32
    s_sub_u32 s3, s29, 1
    s_lshr_b32 s25, s3, 2
    s_and_b32 s25, s25, 1
    s_add_u32 s25, s25, 1
    s_xor_b32 s3, s41, 16384
    s_add_u32 s16, s36, s41
    s_add_u32 s17, s16, 4096
    s_add_u32 s18, s36, s3
    s_add_u32 s19, s18, 4096
    s_lshl_b32 s43, s29, 1
    buffer_load_dword v144, v140, s[8:11], s33 offen sc1
    s_nop 15
    buffer_load_dword v145, v140, s[8:11], s33 offen sc1
    s_nop 15
H3F_25:
    buffer_load_dword v146, v140, s[8:11], s33 offen sc1
    s_waitcnt vmcnt(2)
    v_cmp_gt_u32 vcc, s43, v144
    s_cbranch_vccz H3G_26
    buffer_load_dword v144, v140, s[8:11], s33 offen sc1
    s_waitcnt vmcnt(2)
    v_cmp_gt_u32 vcc, s43, v145
    s_cbranch_vccz H3G_26
    buffer_load_dword v145, v140, s[8:11], s33 offen sc1
    s_waitcnt vmcnt(2)
    v_cmp_gt_u32 vcc, s43, v146
    s_cbranch_vccz H3G_26
    s_sub_u32 s30, s30, 1
    s_cbranch_scc0 H3F_25
    s_branch END
H3G_26:
    s_cmp_lt_i32 s40, 0
    s_cbranch_scc1 H3N_23
    s_cmp_lg_u32 s29, 1
    s_cbranch_scc1 H3G_26_c
    s_waitcnt vmcnt(0)
    v_max3_u32 v147, v144, v145, v146
    v_and_b32 v147, 1, v147
    v_lshl_add_u32 v141, v147, 13, v141
H3G_26_c:
    s_nop 15
    s_nop 15
    s_nop 15
    s_nop 15
    s_nop 3
H3P_27:
    s_sub_u32 s30, s30, 1
    s_cbranch_scc1 END
    buffer_load_dwordx4 v[148:151], v141, s[8:11], s16 offen sc1
    buffer_load_dwordx4 v[152:155], v141, s[8:11], s17 offen sc1
    buffer_load_dwordx4 v[156:159], v141, s[8:11], s18 offen sc1
    buffer_load_dwordx4 v[160:163], v141, s[8:11], s19 offen sc1
    s_waitcnt vmcnt(3)
    v_bitop3_b32 v52, s25, v148, v149 bitop3:0x80
    v_bitop3_b32 v52, v52, v150, v151 bitop3:0x80
    s_waitcnt vmcnt(2)
    v_pk_add_f32 v[164:165], v[148:149], v[152:153]
    v_pk_add_f32 v[166:167], v[150:151], v[154:155]
    v_bitop3_b32 v52, v52, v152, v153 bitop3:0x80
    v_bitop3_b32 v52, v52, v154, v155 bitop3:0x80
    s_waitcnt vmcnt(1)
    v_pk_add_f32 v[164:165], v[164:165], v[156:157]
    v_pk_add_f32 v[166:167], v[166:167], v[158:159]
    v_bitop3_b32 v52, v52, v156, v157 bitop3:0x80
    v_bitop3_b32 v52, v52, v158, v159 bitop3:0x80
    s_waitcnt vmcnt(0)
    v_pk_add_f32 v[164:165], v[164:165], v[160:161]
    v_pk_add_f32 v[166:167], v[166:167], v[162:163]
    v_bitop3_b32 v52, v52, v160, v161 bitop3:0x80
    v_bitop3_b32 v52, v52, v162, v163 bitop3:0x80
    v_permlane32_swap_b32 v164, v166
    v_permlane32_swap_b32 v165, v167
    v_cmp_eq_u32 vcc, 0, v52
    v_pk_add_f32 v[164:165], v[164:165], v[166:167]
    v_cvt_pk_bf16_f32 v166, v164, v165
    v_min_u32 v166, -2, v166
    s_cbranch_vccnz H3P_27
H3K_28:
    buffer_store_dword v166, v142, s[8:11], s37 offen
    buffer_store_dword v143, v142, s[8:11], s35 offen
    s_branch H3D_24
H3N_23:
    s_sleep 10
H3D_24:
VA_P_F:
    s_and_b32 s34, s29, 3
    s_mul_i32 s34, s34, 10240
    s_add_u32 s34, s34, s32
    s_add_u32 s35, s34, 4096
    s_add_u32 s36, s34, 8192
H1P_29:
    buffer_load_dwordx4 v[116:119], v4, s[8:11], s34 offen sc1
    buffer_load_dwordx4 v[120:123], v4, s[8:11], s35 offen sc1
    buffer_load_dwordx4 v[124:127], v8, s[8:11], s36 offen sc1
    s_waitcnt vmcnt(2)
    ds_write_b128 v12, v[116:119]
    v_max3_u32 v52, v116, v117, v118
    s_waitcnt vmcnt(1)
    ds_write_b128 v12, v[120:123] offset:4096
    v_max3_u32 v52, v119, v120, v52
    v_max3_u32 v52, v121, v122, v52
    s_waitcnt vmcnt(0)
    ds_write_b128 v13, v[124:127]
    v_max3_u32 v52, v123, v124, v52
    v_max3_u32 v52, v125, v126, v52
    v_max_u32 v52, v127, v52
    v_cmp_eq_u32 vcc, -1, v52
    s_cbranch_vccz VA_GOT_F
    s_waitcnt lgkmcnt(0)
    s_sub_u32 s30, s30, 1
    s_cbranch_scc0 H1P_29
    s_branch END
VA_GOT_F:
    s_waitcnt lgkmcnt(0)
    s_barrier
    s_barrier
    s_cmp_ge_u32 s29, 2
    s_cbranch_scc1 VA_R_F
    s_mul_i32 s5, s14, 10240
    s_and_b32 s3, s42, 1
    s_mul_i32 s3, s3, 40960
    s_add_u32 s3, s3, s5
    s_mul_i32 s4, s42, 40960
    s_add_u32 s4, s4, s5
    s_add_u32 s4, s4, 10485760
    s_add_u32 s42, s42, 1
    s_mov_b32 m0, s3
    s_nop 0
    buffer_load_dwordx4 v2, s[8:11], s4 offen offset:0 sc1 lds
    buffer_load_dwordx4 v2, s[8:11], s4 offen offset:1024 sc1 lds
    buffer_load_dwordx4 v2, s[8:11], s4 offen offset:2048 sc1 lds
    buffer_load_dwordx4 v2, s[8:11], s4 offen offset:3072 sc1 lds
    s_add_u32 s3, s3, 4096
    s_add_u32 s4, s4, 4096
    s_mov_b32 m0, s3
    s_nop 0
    buffer_load_dwordx4 v2, s[8:11], s4 offen offset:0 sc1 lds
    buffer_load_dwordx4 v2, s[8:11], s4 offen offset:1024 sc1 lds
    buffer_load_dwordx4 v2, s[8:11], s4 offen offset:2048 sc1 lds
    buffer_load_dwordx4 v2, s[8:11], s4 offen offset:3072 sc1 lds
    s_add_u32 s3, s3, 4096
    s_add_u32 s4, s4, 4096
    s_mov_b32 m0, s3
    s_nop 0
    buffer_load_dwordx4 v2, s[8:11], s4 offen offset:0 sc1 lds
    buffer_load_dwordx4 v2, s[8:11], s4 offen offset:1024 sc1 lds
    s_waitcnt vmcnt(0)
    s_barrier
VA_R_F:
    s_cmp_ge_u32 s29, 60
    s_cbranch_scc1 VA_S_F
    s_mul_i32 s5, s14, 10240
    s_and_b32 s3, s42, 1
    s_mul_i32 s3, s3, 40960
    s_add_u32 s3, s3, s5
    s_mul_i32 s4, s42, 40960
    s_add_u32 s4, s4, s5
    s_add_u32 s4, s4, 10485760
    s_add_u32 s42, s42, 1
    s_mov_b32 m0, s3
    s_nop 0
    buffer_load_dwordx4 v2, s[8:11], s4 offen offset:0 sc1 lds
    buffer_load_dwordx4 v2, s[8:11], s4 offen offset:1024 sc1 lds
    buffer_load_dwordx4 v2, s[8:11], s4 offen offset:2048 sc1 lds
    buffer_load_dwordx4 v2, s[8:11], s4 offen offset:3072 sc1 lds
    s_add_u32 s3, s3, 4096
    s_add_u32 s4, s4, 4096
    s_mov_b32 m0, s3
    s_nop 0
    buffer_load_dwordx4 v2, s[8:11], s4 offen offset:0 sc1 lds
    buffer_load_dwordx4 v2, s[8:11], s4 offen offset:1024 sc1 lds
    buffer_load_dwordx4 v2, s[8:11], s4 offen offset:2048 sc1 lds
    buffer_load_dwordx4 v2, s[8:11], s4 offen offset:3072 sc1 lds
    s_add_u32 s3, s3, 4096
    s_add_u32 s4, s4, 4096
    s_mov_b32 m0, s3
    s_nop 0
    buffer_load_dwordx4 v2, s[8:11], s4 offen offset:0 sc1 lds
    buffer_load_dwordx4 v2, s[8:11], s4 offen offset:1024 sc1 lds
VA_S_F:
    s_cmp_eq_u32 s39, 0
    s_cbranch_scc1 VA_N_F
    s_and_b32 s34, s29, 3
    s_mul_i32 s34, s34, 49152
    s_add_u32 s34, s34, 360448
    s_add_u32 s34, s34, s32
    s_and_b32 s37, s29, 3
    s_mul_i32 s37, s37, 10240
    s_add_u32 s37, s37, 557056
    s_add_u32 s37, s37, s32
    s_add_u32 s35, s34, 4096
    s_add_u32 s36, s34, 8192
    s_add_u32 s3, s29, 1
    v_mov_b32 v113, s3
FW_30:
    buffer_load_dword v64, v6, s[8:11], s33 offen sc1
    s_waitcnt vmcnt(0)
    v_cmp_gt_u32 vcc, s3, v64
    s_cbranch_vccz FO_31
    s_sub_u32 s30, s30, 1
    s_cbranch_scc0 FW_30
    s_branch END
FO_31:
    buffer_load_dwordx4 v[64:67], v14, s[8:11], s34 offen sc1
    buffer_load_dwordx4 v[68:71], v15, s[8:11], s34 offen sc1
    buffer_load_dwordx4 v[72:75], v7, s[8:11], s34 offen sc1
    buffer_load_dwordx4 v[76:79], v14, s[8:11], s35 offen sc1
    buffer_load_dwordx4 v[80:83], v15, s[8:11], s35 offen sc1
    buffer_load_dwordx4 v[84:87], v7, s[8:11], s35 offen sc1
    buffer_load_dwordx4 v[88:91], v14, s[8:11], s36 offen sc1
    buffer_load_dwordx4 v[92:95], v15, s[8:11], s36 offen sc1
    buffer_load_dwordx4 v[96:99], v7, s[8:11], s36 offen sc1
    s_waitcnt vmcnt(3)
    v_pk_add_f32 v[64:65], v[64:65], v[76:77]
    v_pk_add_f32 v[66:67], v[66:67], v[78:79]
    v_pk_add_f32 v[68:69], v[68:69], v[80:81]
    v_pk_add_f32 v[70:71], v[70:71], v[82:83]
    v_pk_add_f32 v[72:73], v[72:73], v[84:85]
    v_pk_add_f32 v[74:75], v[74:75], v[86:87]
    v_pk_add_f32 v[64:65], v[64:65], v[100:101]
    v_pk_add_f32 v[66:67], v[66:67], v[102:103]
    v_pk_add_f32 v[68:69], v[68:69], v[104:105]
    v_pk_add_f32 v[70:71], v[70:71], v[106:107]
    v_pk_add_f32 v[72:73], v[72:73], v[108:109]
    v_pk_add_f32 v[74:75], v[74:75], v[110:111]
    s_waitcnt vmcnt(0)
    v_pk_add_f32 v[64:65], v[64:65], v[88:89]
    v_pk_add_f32 v[66:67], v[66:67], v[90:91]
    v_pk_add_f32 v[68:69], v[68:69], v[92:93]
    v_pk_add_f32 v[70:71], v[70:71], v[94:95]
    v_pk_add_f32 v[72:73], v[72:73], v[96:97]
    v_pk_add_f32 v[74:75], v[74:75], v[98:99]
    v_max3_f32 v76, v64, v65, v66
    v_max3_f32 v76, v76, v67, v68
    v_max3_f32 v76, v76, v69, v70
    v_max3_f32 v76, v76, v71, v72
    v_max3_f32 v76, v76, v73, v74
    v_max_f32 v76, v76, v75
    v_mov_b32 v77, v76
    s_nop 1
    v_permlane16_swap_b32 v76, v77
    v_max_f32 v76, v76, v77
    v_mov_b32 v77, v76
    s_nop 1
    v_permlane32_swap_b32 v76, v77
    v_max_f32 v76, v76, v77
    v_mul_f32 v78, s38, v76
    v_pk_fma_f32 v[64:65], v[64:65], v[114:115], v[78:79] op_sel_hi:[1,1,0] neg_lo:[0,0,1] neg_hi:[0,0,1]
    v_pk_fma_f32 v[66:67], v[66:67], v[114:115], v[78:79] op_sel_hi:[1,1,0] neg_lo:[0,0,1] neg_hi:[0,0,1]
    v_pk_fma_f32 v[68:69], v[68:69], v[114:115], v[78:79] op_sel_hi:[1,1,0] neg_lo:[0,0,1] neg_hi:[0,0,1]
    v_pk_fma_f32 v[70:71], v[70:71], v[114:115], v[78:79] op_sel_hi:[1,1,0] neg_lo:[0,0,1] neg_hi:[0,0,1]
    v_pk_fma_f32 v[72:73], v[72:73], v[114:115], v[78:79] op_sel_hi:[1,1,0] neg_lo:[0,0,1] neg_hi:[0,0,1]
    v_pk_fma_f32 v[74:75], v[74:75], v[114:115], v[78:79] op_sel_hi:[1,1,0] neg_lo:[0,0,1] neg_hi:[0,0,1]
    v_exp_f32 v64, v64
    v_exp_f32 v65, v65
    v_exp_f32 v66, v66
    v_exp_f32 v67, v67
    v_exp_f32 v68, v68
    v_exp_f32 v69, v69
    v_exp_f32 v70, v70
    v_exp_f32 v71, v71
    v_exp_f32 v72, v72
    v_exp_f32 v73, v73
    v_exp_f32 v74, v74
    v_exp_f32 v75, v75
    v_pk_add_f32 v[76:77], v[64:65], v[66:67]
    v_pk_add_f32 v[76:77], v[76:77], v[68:69]
    v_pk_add_f32 v[76:77], v[76:77], v[70:71]
    v_pk_add_f32 v[76:77], v[76:77], v[72:73]
    v_pk_add_f32 v[76:77], v[76:77], v[74:75]
    v_add_f32 v76, v76, v77
    v_mov_b32 v77, v76
    s_nop 1
    v_permlane16_swap_b32 v76, v77
    v_add_f32 v76, v76, v77
    v_mov_b32 v77, v76
    s_nop 1
    v_permlane32_swap_b32 v76, v77
    v_add_f32 v76, v76, v77
    v_rcp_f32 v78, v76
    s_nop 0
    v_pk_mul_f32 v[64:65], v[64:65], v[78:79] op_sel_hi:[1,0]
    v_pk_mul_f32 v[66:67], v[66:67], v[78:79] op_sel_hi:[1,0]
    v_pk_mul_f32 v[68:69], v[68:69], v[78:79] op_sel_hi:[1,0]
    v_pk_mul_f32 v[70:71], v[70:71], v[78:79] op_sel_hi:[1,0]
    v_pk_mul_f32 v[72:73], v[72:73], v[78:79] op_sel_hi:[1,0]
    v_pk_mul_f32 v[74:75], v[74:75], v[78:79] op_sel_hi:[1,0]
    v_cvt_pk_bf16_f32 v80, v64, v65
    v_cvt_pk_bf16_f32 v81, v66, v67
    v_cvt_pk_bf16_f32 v82, v68, v69
    v_cvt_pk_bf16_f32 v83, v70, v71
    v_cvt_pk_bf16_f32 v84, v72, v73
    v_cvt_pk_bf16_f32 v85, v74, v75
    buffer_store_dwordx4 v[80:83], v10, s[8:11], s37 offen
    buffer_store_dwordx2 v[84:85], v11, s[8:11], s37 offen
    s_waitcnt vmcnt(0)
    buffer_store_dword v113, v112, s[8:11], s33 offen
VA_N_F:
    s_add_u32 s29, s29, 1
    s_cmp_lt_u32 s29, 64
    s_cbranch_scc1 VA_LOOP_F
    s_waitcnt vmcnt(0)
    s_waitcnt vmcnt(0)
    s_branch END
COMB_F:
    s_sub_u32 s15, s28, 18
    s_cmp_ge_u32 s26, 4
    s_cbranch_scc1 CAUX_F
    v_and_b32 v4, 15, v0
    v_cmp_gt_u32 vcc, 8, v4
    v_mov_b32 v5, 0xeeee
    v_mov_b32 v6, 0x4444
    v_cndmask_b32 v5, v5, v6, vcc
    s_mul_i32 s3, s26, 3072
    v_add_u32 v4, s3, v2
    v_and_b32 v6, 15, v0
    v_lshlrev_b32 v6, 4, v6
    v_bfe_u32 v7, v0, 4, 1
    v_lshl_add_u32 v6, v7, 3, v6
    v_lshrrev_b32 v7, 5, v0
    v_lshl_add_u32 v6, v7, 10, v6
    s_lshl_b32 s3, s26, 8
    s_add_u32 s3, s3, 65536
    v_add_u32 v6, s3, v6
    s_lshl_b32 s3, s26, 12
    v_add_u32 v8, s3, v2
    s_mul_i32 s3, s26, 12288
    v_add_u32 v14, s3, v2
    s_lshr_b32 s4, s26, 1
    s_lshl_b32 s3, s4, 11
    v_add_u32 v11, s3, v2
    s_and_b32 s5, s26, 1
    s_mul_i32 s3, s5, 5120
    v_add_u32 v12, s3, v2
    v_and_b32 v13, 7, v0
    v_lshlrev_b32 v13, 7, v13
    v_lshrrev_b32 v7, 4, v0
    v_lshl_add_u32 v13, v7, 4, v13
    v_bfe_u32 v7, v0, 3, 1
    v_lshl_add_u32 v13, v7, 6, v13
    s_mul_i32 s3, s27, 81920
    s_lshl_b32 s6, s15, 13
    s_add_u32 s3, s3, s6
    s_lshl_b32 s6, s26, 11
    s_add_u32 s3, s3, s6
    v_add_u32 v13, s3, v13
    v_min_u32 v15, 5, v0
    v_lshlrev_b32 v15, 2, v15
    s_mul_i32 s3, s26, 24
    v_add_u32 v15, s3, v15
    v_and_b32 v60, 3, v0
    v_lshlrev_b32 v60, 2, v60
    s_lshl_b32 s3, s5, 4
    s_add_u32 s3, s3, 384
    v_add_u32 v60, s3, v60
    s_add_u32 s3, s15, s26
    s_cmp_eq_u32 s3, 0
    s_mov_b32 s4, 2147483392
    s_cselect_b32 s3, 1024, s4
    v_mov_b32 v61, 2147483392
    s_nop 0
    v_writelane_b32 v61, s3, 0
    s_mov_b32 s43, 13369344
    s_lshl_b32 s3, s15, 15
    s_lshl_b32 s4, s26, 9
    s_add_u32 s3, s3, s4
    s_lshr_b32 s5, s27, 2
    s_lshl_b32 s5, s5, 14
    s_add_u32 s3, s3, s5
    s_and_b32 s4, s27, 3
    s_lshl_b32 s4, s4, 11
    s_add_u32 s3, s3, s4
    v_and_b32 v62, 7, v0
    v_lshrrev_b32 v3, 5, v0
    v_lshlrev_b32 v3, 8, v3
    v_lshl_add_u32 v3, v62, 5, v3
    v_bfe_u32 v7, v0, 4, 1
    v_lshl_add_u32 v3, v7, 4, v3
    v_bfe_u32 v7, v0, 3, 1
    v_lshl_add_u32 v3, v7, 13, v3
    v_add_u32 v3, s3, v3
    v_lshrrev_b32 v7, 4, v0
    v_lshl_add_u32 v1, v7, 3, v62
    v_lshlrev_b32 v1, 4, v1
    v_add_u32 v1, 81920, v1
    s_lshl_b32 s38, s26, 10
    s_mov_b32 s29, 0
    s_mov_b32 s4, 1
FW_32:
    buffer_load_dword v62, v15, s[8:11], s33 offen sc1
    s_waitcnt vmcnt(0)
    v_cmp_gt_u32 vcc, s4, v62
    s_cbranch_vccz FO_33
    s_sub_u32 s30, s30, 1
    s_cbranch_scc0 FW_32
    s_branch END
FO_33:
    s_and_b32 s35, s29, 3
    s_mul_i32 s35, s35, 49152
    s_add_u32 s35, s35, 163840
    s_add_u32 s35, s35, s32
    s_add_u32 s36, s35, 4096
    s_add_u32 s37, s35, 8192
    buffer_load_dwordx4 v[160:163], v14, s[8:11], s35 offen offset:0 sc1
    buffer_load_dwordx4 v[164:167], v14, s[8:11], s35 offen offset:1024 sc1
    buffer_load_dwordx4 v[168:171], v14, s[8:11], s35 offen offset:2048 sc1
    buffer_load_dwordx4 v[172:175], v14, s[8:11], s35 offen offset:3072 sc1
    buffer_load_dwordx4 v[176:179], v14, s[8:11], s36 offen offset:0 sc1
    buffer_load_dwordx4 v[180:183], v14, s[8:11], s36 offen offset:1024 sc1
    buffer_load_dwordx4 v[184:187], v14, s[8:11], s36 offen offset:2048 sc1
    buffer_load_dwordx4 v[188:191], v14, s[8:11], s36 offen offset:3072 sc1
    buffer_load_dwordx4 v[192:195], v14, s[8:11], s37 offen offset:0 sc1
    buffer_load_dwordx4 v[196:199], v14, s[8:11], s37 offen offset:1024 sc1
    buffer_load_dwordx4 v[200:203], v14, s[8:11], s37 offen offset:2048 sc1
    buffer_load_dwordx4 v[204:207], v14, s[8:11], s37 offen offset:3072 sc1
    s_waitcnt vmcnt(0)
    s_add_u32 s3, s29, 0
    s_and_b32 s3, s3, 3
    s_lshl_b32 s3, s3, 14
    v_add_u32 v7, s3, v8
    v_mfma_f32_16x16x32_bf16 v[16:19], v[160:163], v[64:67], 0
    v_mfma_f32_16x16x32_bf16 v[20:23], v[164:167], v[64:67], 0
    v_mfma_f32_16x16x32_bf16 v[24:27], v[160:163], v[72:75], 0
    v_mfma_f32_16x16x32_bf16 v[28:31], v[164:167], v[72:75], 0
    v_mfma_f32_16x16x32_bf16 v[32:35], v[160:163], v[80:83], 0
    v_mfma_f32_16x16x32_bf16 v[36:39], v[164:167], v[80:83], 0
    v_mfma_f32_16x16x32_bf16 v[40:43], v[160:163], v[88:91], 0
    v_mfma_f32_16x16x32_bf16 v[44:47], v[164:167], v[88:91], 0
    v_mfma_f32_16x16x32_bf16 v[16:19], v[168:171], v[68:71], v[16:19]
    v_mfma_f32_16x16x32_bf16 v[20:23], v[172:175], v[68:71], v[20:23]
    v_mfma_f32_16x16x32_bf16 v[24:27], v[168:171], v[76:79], v[24:27]
    v_mfma_f32_16x16x32_bf16 v[28:31], v[172:175], v[76:79], v[28:31]
    v_mfma_f32_16x16x32_bf16 v[32:35], v[168:171], v[84:87], v[32:35]
    v_mfma_f32_16x16x32_bf16 v[36:39], v[172:175], v[84:87], v[36:39]
    v_mfma_f32_16x16x32_bf16 v[40:43], v[168:171], v[92:95], v[40:43]
    v_mfma_f32_16x16x32_bf16 v[44:47], v[172:175], v[92:95], v[44:47]
    v_mfma_f32_16x16x32_bf16 v[16:19], v[176:179], v[96:99], v[16:19]
    v_mfma_f32_16x16x32_bf16 v[20:23], v[180:183], v[96:99], v[20:23]
    v_mfma_f32_16x16x32_bf16 v[24:27], v[176:179], v[104:107], v[24:27]
    v_mfma_f32_16x16x32_bf16 v[28:31], v[180:183], v[104:107], v[28:31]
    v_mfma_f32_16x16x32_bf16 v[32:35], v[176:179], v[112:115], v[32:35]
    v_mfma_f32_16x16x32_bf16 v[36:39], v[180:183], v[112:115], v[36:39]
    v_mfma_f32_16x16x32_bf16 v[40:43], v[176:179], v[120:123], v[40:43]
    v_mfma_f32_16x16x32_bf16 v[44:47], v[180:183], v[120:123], v[44:47]
    v_mfma_f32_16x16x32_bf16 v[16:19], v[184:187], v[100:103], v[16:19]
    v_mfma_f32_16x16x32_bf16 v[20:23], v[188:191], v[100:103], v[20:23]
    v_mfma_f32_16x16x32_bf16 v[24:27], v[184:187], v[108:111], v[24:27]
    v_mfma_f32_16x16x32_bf16 v[28:31], v[188:191], v[108:111], v[28:31]
    v_mfma_f32_16x16x32_bf16 v[32:35], v[184:187], v[116:119], v[32:35]
    v_mfma_f32_16x16x32_bf16 v[36:39], v[188:191], v[116:119], v[36:39]
    v_mfma_f32_16x16x32_bf16 v[40:43], v[184:187], v[124:127], v[40:43]
    v_mfma_f32_16x16x32_bf16 v[44:47], v[188:191], v[124:127], v[44:47]
    v_mfma_f32_16x16x32_bf16 v[16:19], v[192:195], v[128:131], v[16:19]
    v_mfma_f32_16x16x32_bf16 v[20:23], v[196:199], v[128:131], v[20:23]
    v_mfma_f32_16x16x32_bf16 v[24:27], v[192:195], v[136:139], v[24:27]
    v_mfma_f32_16x16x32_bf16 v[28:31], v[196:199], v[136:139], v[28:31]
    v_mfma_f32_16x16x32_bf16 v[32:35], v[192:195], v[144:147], v[32:35]
    v_mfma_f32_16x16x32_bf16 v[36:39], v[196:199], v[144:147], v[36:39]
    v_mfma_f32_16x16x32_bf16 v[40:43], v[192:195], v[152:155], v[40:43]
    v_mfma_f32_16x16x32_bf16 v[44:47], v[196:199], v[152:155], v[44:47]
    v_mfma_f32_16x16x32_bf16 v[16:19], v[200:203], v[132:135], v[16:19]
    v_mfma_f32_16x16x32_bf16 v[20:23], v[204:207], v[132:135], v[20:23]
    v_mfma_f32_16x16x32_bf16 v[24:27], v[200:203], v[140:143], v[24:27]
    v_mfma_f32_16x16x32_bf16 v[28:31], v[204:207], v[140:143], v[28:31]
    v_mfma_f32_16x16x32_bf16 v[32:35], v[200:203], v[148:151], v[32:35]
    v_mfma_f32_16x16x32_bf16 v[36:39], v[204:207], v[148:151], v[36:39]
    v_mfma_f32_16x16x32_bf16 v[40:43], v[200:203], v[156:159], v[40:43]
    v_mfma_f32_16x16x32_bf16 v[44:47], v[204:207], v[156:159], v[44:47]
    s_nop 0
    v_cvt_pk_bf16_f32 v16, v16, v17
    v_cvt_pk_bf16_f32 v17, v18, v19
    v_cvt_pk_bf16_f32 v18, v20, v21
    v_cvt_pk_bf16_f32 v19, v22, v23
    ds_write_b128 v7, v[16:19] offset:0
    v_cvt_pk_bf16_f32 v24, v24, v25
    v_cvt_pk_bf16_f32 v25, v26, v27
    v_cvt_pk_bf16_f32 v26, v28, v29
    v_cvt_pk_bf16_f32 v27, v30, v31
    ds_write_b128 v7, v[24:27] offset:1024
    v_cvt_pk_bf16_f32 v32, v32, v33
    v_cvt_pk_bf16_f32 v33, v34, v35
    v_cvt_pk_bf16_f32 v34, v36, v37
    v_cvt_pk_bf16_f32 v35, v38, v39
    ds_write_b128 v7, v[32:35] offset:2048
    v_cvt_pk_bf16_f32 v40, v40, v41
    v_cvt_pk_bf16_f32 v41, v42, v43
    v_cvt_pk_bf16_f32 v42, v44, v45
    v_cvt_pk_bf16_f32 v43, v46, v47
    ds_write_b128 v7, v[40:43] offset:3072
    s_waitcnt lgkmcnt(0)
    s_barrier
    s_and_b32 s34, s29, 3
    s_mul_i32 s34, s34, 12288
    s_add_u32 s34, s34, 40960
    s_add_u32 s34, s34, s32
    v_mov_b32 v32, 0
    v_mov_b32 v33, 0
    v_mov_b32 v34, 0
    v_mov_b32 v35, 0
    v_mov_b32 v36, 0
    v_mov_b32 v37, 0
    v_mov_b32 v38, 0
    v_mov_b32 v39, 0
    v_mov_b32 v40, 0
    v_mov_b32 v41, 0
    v_mov_b32 v42, 0
    v_mov_b32 v43, 0
    v_mov_b32 v44, 0
    v_mov_b32 v45, 0
    v_mov_b32 v46, 0
    v_mov_b32 v47, 0
    s_and_b32 s3, s29, 3
    s_lshl_b32 s4, s3, 14
    s_add_u32 s4, s4, s38
    v_add_u32 v9, s4, v2
    s_lshl_b32 s3, s3, 12
    v_add_u32 v7, s3, v6
    s_add_u32 s3, s3, s38
    s_add_u32 s3, s3, 65536
    v_add_u32 v10, s3, v2
    ds_read_b128 v[228:231], v9 offset:0
    ds_read_b128 v[232:235], v9 offset:4096
    ds_read_b128 v[236:239], v9 offset:8192
    ds_read_b128 v[240:243], v9 offset:12288
    s_and_b32 s39, s29, 3
    s_mul_i32 s39, s39, 327680
    s_add_u32 s39, s39, 8388608
    s_lshr_b32 s25, s29, 2
    s_and_b32 s25, s25, 1
    s_add_u32 s25, s25, 1
    s_branch CG_P_F
    .p2align 6
CG_LOOP_F:
    s_and_b32 s34, s29, 3
    s_mul_i32 s34, s34, 12288
    s_add_u32 s34, s34, 40960
    s_add_u32 s34, s34, s32
    v_mov_b32 v32, 0
    v_mov_b32 v33, 0
    v_mov_b32 v34, 0
    v_mov_b32 v35, 0
    v_mov_b32 v36, 0
    v_mov_b32 v37, 0
    v_mov_b32 v38, 0
    v_mov_b32 v39, 0
    v_mov_b32 v40, 0
    v_mov_b32 v41, 0
    v_mov_b32 v42, 0
    v_mov_b32 v43, 0
    v_mov_b32 v44, 0
    v_mov_b32 v45, 0
    v_mov_b32 v46, 0
    v_mov_b32 v47, 0
    s_and_b32 s3, s29, 3
    s_lshl_b32 s4, s3, 14
    s_add_u32 s4, s4, s38
    v_add_u32 v9, s4, v2
    s_lshl_b32 s3, s3, 12
    v_add_u32 v7, s3, v6
    s_add_u32 s3, s3, s38
    s_add_u32 s3, s3, 65536
    v_add_u32 v10, s3, v2
    ds_read_b128 v[228:231], v9 offset:0
    ds_read_b128 v[232:235], v9 offset:4096
    ds_read_b128 v[236:239], v9 offset:8192
    ds_read_b128 v[240:243], v9 offset:12288
    s_and_b32 s39, s29, 3
    s_mul_i32 s39, s39, 327680
    s_add_u32 s39, s39, 8388608
    s_lshr_b32 s25, s29, 2
    s_and_b32 s25, s25, 1
    s_add_u32 s25, s25, 1
    s_sleep 10
CG_P_F:
    s_sub_u32 s30, s30, 1
    s_cbranch_scc1 END
    buffer_load_dwordx4 v[48:51], v4, s[8:11], s34 offen offset:0 sc1
    buffer_load_dwordx4 v[52:55], v4, s[8:11], s34 offen offset:1024 sc1
    buffer_load_dwordx4 v[56:59], v4, s[8:11], s34 offen offset:2048 sc1
    s_waitcnt vmcnt(2)
    v_max3_u32 v62, v48, v49, v50
    s_waitcnt vmcnt(1)
    v_max3_u32 v62, v62, v51, v52
    v_max3_u32 v62, v62, v53, v54
    s_waitcnt vmcnt(0)
    v_max3_u32 v62, v62, v55, v56
    v_max3_u32 v62, v62, v57, v58
    v_max_u32 v62, v62, v59
    v_cmp_eq_u32 vcc, -1, v62
    s_cbranch_vccnz CG_P_F
    v_smfmac_f32_16x16x64_bf16 v[32:35], v[48:51], v[64:71], v5
    v_smfmac_f32_16x16x64_bf16 v[36:39], v[48:51], v[72:79], v5
    v_smfmac_f32_16x16x64_bf16 v[40:43], v[48:51], v[80:87], v5
    v_smfmac_f32_16x16x64_bf16 v[44:47], v[48:51], v[88:95], v5
    v_smfmac_f32_16x16x64_bf16 v[32:35], v[52:55], v[96:103], v5
    v_smfmac_f32_16x16x64_bf16 v[36:39], v[52:55], v[104:111], v5
    v_smfmac_f32_16x16x64_bf16 v[40:43], v[52:55], v[112:119], v5
    v_smfmac_f32_16x16x64_bf16 v[44:47], v[52:55], v[120:127], v5
    v_smfmac_f32_16x16x64_bf16 v[32:35], v[56:59], v[128:135], v5
    v_smfmac_f32_16x16x64_bf16 v[36:39], v[56:59], v[136:143], v5
    v_smfmac_f32_16x16x64_bf16 v[40:43], v[56:59], v[144:151], v5
    v_smfmac_f32_16x16x64_bf16 v[44:47], v[56:59], v[152:159], v5
    s_nop 5
    v_permlane32_swap_b32 v32, v36
    v_permlane32_swap_b32 v33, v37
    v_permlane32_swap_b32 v34, v38
    v_permlane32_swap_b32 v35, v39
    v_pk_add_f32 v[32:33], v[32:33], v[36:37]
    v_pk_add_f32 v[34:35], v[34:35], v[38:39]
    v_cvt_pk_bf16_f32 v32, v32, v33
    v_cvt_pk_bf16_f32 v33, v34, v35
    ds_write_b64 v7, v[32:33] offset:0
    v_permlane32_swap_b32 v40, v44
    v_permlane32_swap_b32 v41, v45
    v_permlane32_swap_b32 v42, v46
    v_permlane32_swap_b32 v43, v47
    v_pk_add_f32 v[40:41], v[40:41], v[44:45]
    v_pk_add_f32 v[42:43], v[42:43], v[46:47]
    v_cvt_pk_bf16_f32 v40, v40, v41
    v_cvt_pk_bf16_f32 v41, v42, v43
    ds_write_b64 v7, v[40:41] offset:2048
    s_waitcnt lgkmcnt(0)
    s_barrier
    s_cmp_eq_u32 s29, 63
    s_cbranch_scc1 CG_0_F
    ds_read_b128 v[16:19], v1 offset:0
    ds_read_b128 v[20:23], v1 offset:512
    ds_read_b128 v[24:27], v1 offset:1024
    ds_read_b128 v[28:31], v1 offset:1536
    ds_read_b128 v[32:35], v1 offset:2048
    ds_read_b128 v[36:39], v10
    s_waitcnt lgkmcnt(5)
    v_mfma_f32_16x16x32_bf16 v[40:43], v[228:231], v[16:19], 0
    s_waitcnt lgkmcnt(4)
    v_mfma_f32_16x16x32_bf16 v[40:43], v[232:235], v[20:23], v[40:43]
    s_waitcnt lgkmcnt(3)
    v_mfma_f32_16x16x32_bf16 v[40:43], v[236:239], v[24:27], v[40:43]
    s_waitcnt lgkmcnt(2)
    v_mfma_f32_16x16x32_bf16 v[40:43], v[240:243], v[28:31], v[40:43]
    s_waitcnt lgkmcnt(0)
    v_mfma_f32_16x16x32_bf16 v[40:43], v[36:39], v[32:35], v[40:43]
    s_nop 7
    v_and_or_b32 v40, v40, -4, s25
    v_and_or_b32 v41, v41, -4, s25
    v_and_or_b32 v42, v42, -4, s25
    v_and_or_b32 v43, v43, -4, s25
    buffer_store_dwordx4 v[40:43], v3, s[8:11], s39 offen sc1
CG_0_F:
    s_add_u32 s3, s29, 2
    s_and_b32 s3, s3, 3
    s_lshl_b32 s4, s3, 14
    v_add_u32 v9, s4, v11
    s_lshl_b32 s3, s3, 12
    s_add_u32 s3, s3, 65536
    v_add_u32 v10, s3, v11
    ds_read_b128 v[228:231], v9 offset:0
    ds_read_b128 v[232:235], v9 offset:4096
    ds_read_b128 v[236:239], v9 offset:8192
    ds_read_b128 v[240:243], v9 offset:12288
    ds_read_b128 v[244:247], v10 offset:0
    ds_read_b128 v[248:251], v9 offset:1024
    ds_read_b128 v[252:255], v9 offset:5120
    ds_read_b128 v[48:51], v9 offset:9216
    ds_read_b128 v[52:55], v9 offset:13312
    ds_read_b128 v[56:59], v10 offset:1024
    s_cmp_eq_u32 s29, 63
    s_cbranch_scc1 CG_1_F
    s_cmp_lt_u32 s29, 2
    s_cbranch_scc1 CG_E0_F
CG_Z_F:
    s_add_u32 s35, s29, 2
    s_and_b32 s35, s35, 3
    s_mul_i32 s35, s35, 49152
    s_add_u32 s35, s35, 163840
    s_add_u32 s35, s35, s32
    s_cmp_ge_u32 s29, 62
    s_cselect_b32 s35, 2147417856, s35
    s_add_u32 s36, s35, 4096
    s_add_u32 s37, s35, 8192
    s_add_u32 s3, s29, 1
    s_and_b32 s3, s3, 3
    s_lshl_b32 s3, s3, 14
    v_add_u32 v7, s3, v8
    v_mfma_f32_16x16x32_bf16 v[16:19], v[160:163], v[64:67], 0
    v_mfma_f32_16x16x32_bf16 v[20:23], v[164:167], v[64:67], 0
    v_mfma_f32_16x16x32_bf16 v[24:27], v[160:163], v[72:75], 0
    v_mfma_f32_16x16x32_bf16 v[28:31], v[164:167], v[72:75], 0
    v_mfma_f32_16x16x32_bf16 v[32:35], v[160:163], v[80:83], 0
    v_mfma_f32_16x16x32_bf16 v[36:39], v[164:167], v[80:83], 0
    v_mfma_f32_16x16x32_bf16 v[40:43], v[160:163], v[88:91], 0
    v_mfma_f32_16x16x32_bf16 v[44:47], v[164:167], v[88:91], 0
    v_mfma_f32_16x16x32_bf16 v[16:19], v[168:171], v[68:71], v[16:19]
    v_mfma_f32_16x16x32_bf16 v[20:23], v[172:175], v[68:71], v[20:23]
    v_mfma_f32_16x16x32_bf16 v[24:27], v[168:171], v[76:79], v[24:27]
    v_mfma_f32_16x16x32_bf16 v[28:31], v[172:175], v[76:79], v[28:31]
    v_mfma_f32_16x16x32_bf16 v[32:35], v[168:171], v[84:87], v[32:35]
    v_mfma_f32_16x16x32_bf16 v[36:39], v[172:175], v[84:87], v[36:39]
    v_mfma_f32_16x16x32_bf16 v[40:43], v[168:171], v[92:95], v[40:43]
    v_mfma_f32_16x16x32_bf16 v[44:47], v[172:175], v[92:95], v[44:47]
    buffer_load_dwordx4 v[160:163], v14, s[8:11], s35 offen offset:0 sc1
    buffer_load_dwordx4 v[164:167], v14, s[8:11], s35 offen offset:1024 sc1
    v_mfma_f32_16x16x32_bf16 v[16:19], v[176:179], v[96:99], v[16:19]
    v_mfma_f32_16x16x32_bf16 v[20:23], v[180:183], v[96:99], v[20:23]
    v_mfma_f32_16x16x32_bf16 v[24:27], v[176:179], v[104:107], v[24:27]
    v_mfma_f32_16x16x32_bf16 v[28:31], v[180:183], v[104:107], v[28:31]
    v_mfma_f32_16x16x32_bf16 v[32:35], v[176:179], v[112:115], v[32:35]
    v_mfma_f32_16x16x32_bf16 v[36:39], v[180:183], v[112:115], v[36:39]
    v_mfma_f32_16x16x32_bf16 v[40:43], v[176:179], v[120:123], v[40:43]
    v_mfma_f32_16x16x32_bf16 v[44:47], v[180:183], v[120:123], v[44:47]
    buffer_load_dwordx4 v[168:171], v14, s[8:11], s35 offen offset:2048 sc1
    buffer_load_dwordx4 v[172:175], v14, s[8:11], s35 offen offset:3072 sc1
    v_mfma_f32_16x16x32_bf16 v[16:19], v[184:187], v[100:103], v[16:19]
    v_mfma_f32_16x16x32_bf16 v[20:23], v[188:191], v[100:103], v[20:23]
    v_mfma_f32_16x16x32_bf16 v[24:27], v[184:187], v[108:111], v[24:27]
    v_mfma_f32_16x16x32_bf16 v[28:31], v[188:191], v[108:111], v[28:31]
    v_mfma_f32_16x16x32_bf16 v[32:35], v[184:187], v[116:119], v[32:35]
    v_mfma_f32_16x16x32_bf16 v[36:39], v[188:191], v[116:119], v[36:39]
    v_mfma_f32_16x16x32_bf16 v[40:43], v[184:187], v[124:127], v[40:43]
    v_mfma_f32_16x16x32_bf16 v[44:47], v[188:191], v[124:127], v[44:47]
    buffer_load_dwordx4 v[176:179], v14, s[8:11], s36 offen offset:0 sc1
    buffer_load_dwordx4 v[180:183], v14, s[8:11], s36 offen offset:1024 sc1
    v_mfma_f32_16x16x32_bf16 v[16:19], v[192:195], v[128:131], v[16:19]
    v_mfma_f32_16x16x32_bf16 v[20:23], v[196:199], v[128:131], v[20:23]
    v_mfma_f32_16x16x32_bf16 v[24:27], v[192:195], v[136:139], v[24:27]
    v_mfma_f32_16x16x32_bf16 v[28:31], v[196:199], v[136:139], v[28:31]
    v_mfma_f32_16x16x32_bf16 v[32:35], v[192:195], v[144:147], v[32:35]
    v_mfma_f32_16x16x32_bf16 v[36:39], v[196:199], v[144:147], v[36:39]
    v_mfma_f32_16x16x32_bf16 v[40:43], v[192:195], v[152:155], v[40:43]
    v_mfma_f32_16x16x32_bf16 v[44:47], v[196:199], v[152:155], v[44:47]
    buffer_load_dwordx4 v[184:187], v14, s[8:11], s36 offen offset:2048 sc1
    buffer_load_dwordx4 v[188:191], v14, s[8:11], s36 offen offset:3072 sc1
    v_mfma_f32_16x16x32_bf16 v[16:19], v[200:203], v[132:135], v[16:19]
    v_mfma_f32_16x16x32_bf16 v[20:23], v[204:207], v[132:135], v[20:23]
    v_mfma_f32_16x16x32_bf16 v[24:27], v[200:203], v[140:143], v[24:27]
    v_mfma_f32_16x16x32_bf16 v[28:31], v[204:207], v[140:143], v[28:31]
    v_mfma_f32_16x16x32_bf16 v[32:35], v[200:203], v[148:151], v[32:35]
    v_mfma_f32_16x16x32_bf16 v[36:39], v[204:207], v[148:151], v[36:39]
    v_mfma_f32_16x16x32_bf16 v[40:43], v[200:203], v[156:159], v[40:43]
    v_mfma_f32_16x16x32_bf16 v[44:47], v[204:207], v[156:159], v[44:47]
    buffer_load_dwordx4 v[192:195], v14, s[8:11], s37 offen offset:0 sc1
    buffer_load_dwordx4 v[196:199], v14, s[8:11], s37 offen offset:1024 sc1
    buffer_load_dwordx4 v[200:203], v14, s[8:11], s37 offen offset:2048 sc1
    buffer_load_dwordx4 v[204:207], v14, s[8:11], s37 offen offset:3072 sc1
    v_cvt_pk_bf16_f32 v16, v16, v17
    v_cvt_pk_bf16_f32 v17, v18, v19
    v_cvt_pk_bf16_f32 v18, v20, v21
    v_cvt_pk_bf16_f32 v19, v22, v23
    ds_write_b128 v7, v[16:19] offset:0
    v_cvt_pk_bf16_f32 v24, v24, v25
    v_cvt_pk_bf16_f32 v25, v26, v27
    v_cvt_pk_bf16_f32 v26, v28, v29
    v_cvt_pk_bf16_f32 v27, v30, v31
    ds_write_b128 v7, v[24:27] offset:1024
    v_cvt_pk_bf16_f32 v32, v32, v33
    v_cvt_pk_bf16_f32 v33, v34, v35
    v_cvt_pk_bf16_f32 v34, v36, v37
    v_cvt_pk_bf16_f32 v35, v38, v39
    ds_write_b128 v7, v[32:35] offset:2048
    v_cvt_pk_bf16_f32 v40, v40, v41
    v_cvt_pk_bf16_f32 v41, v42, v43
    v_cvt_pk_bf16_f32 v42, v44, v45
    v_cvt_pk_bf16_f32 v43, v46, v47
    ds_write_b128 v7, v[40:43] offset:3072
CG_1_F:
    s_waitcnt lgkmcnt(0)
    v_mfma_f32_16x16x32_bf16 v[20:23], v[228:231], v[208:211], 0
    v_mfma_f32_16x16x32_bf16 v[28:31], v[248:251], v[208:211], 0
    v_mfma_f32_16x16x32_bf16 v[20:23], v[232:235], v[212:215], v[20:23]
    v_mfma_f32_16x16x32_bf16 v[28:31], v[252:255], v[212:215], v[28:31]
    v_mfma_f32_16x16x32_bf16 v[20:23], v[236:239], v[216:219], v[20:23]
    v_mfma_f32_16x16x32_bf16 v[28:31], v[48:51], v[216:219], v[28:31]
    v_mfma_f32_16x16x32_bf16 v[20:23], v[240:243], v[220:223], v[20:23]
    v_mfma_f32_16x16x32_bf16 v[28:31], v[52:55], v[220:223], v[28:31]
    v_mfma_f32_16x16x32_bf16 v[20:23], v[244:247], v[224:227], v[20:23]
    v_mfma_f32_16x16x32_bf16 v[28:31], v[56:59], v[224:227], v[28:31]
    s_nop 6
    v_and_or_b32 v24, v20, -4, 1
    v_and_or_b32 v28, v28, -4, 1
    v_and_or_b32 v25, v21, -4, 1
    v_and_or_b32 v29, v29, -4, 1
    v_and_or_b32 v26, v22, -4, 1
    v_and_or_b32 v30, v30, -4, 1
    v_and_or_b32 v27, v23, -4, 1
    v_and_or_b32 v31, v31, -4, 1
    v_mov_b32 v20, v24
    v_mov_b32 v21, v25
    v_mov_b32 v22, v26
    v_mov_b32 v23, v27
    v_mov_b32_dpp v20, v28 row_ror:8 row_mask:0xf bank_mask:0xc
    v_mov_b32_dpp v21, v29 row_ror:8 row_mask:0xf bank_mask:0xc
    v_mov_b32_dpp v22, v30 row_ror:8 row_mask:0xf bank_mask:0xc
    v_mov_b32_dpp v23, v31 row_ror:8 row_mask:0xf bank_mask:0xc
    v_mov_b32_dpp v28, v24 row_ror:8 row_mask:0xf bank_mask:0x3
    v_mov_b32_dpp v29, v25 row_ror:8 row_mask:0xf bank_mask:0x3
    v_mov_b32_dpp v30, v26 row_ror:8 row_mask:0xf bank_mask:0x3
    v_mov_b32_dpp v31, v27 row_ror:8 row_mask:0xf bank_mask:0x3
    s_sub_u32 s3, s29, 3
    s_max_i32 s3, s3, 0
    v_mov_b32 v63, s3
    s_cmp_lt_u32 s29, 2
    s_cbranch_scc1 CG_3_F
    buffer_store_dwordx4 v[20:23], v13, s[8:11], s43 offen sc1
    buffer_store_dwordx4 v[28:31], v13, s[8:11], s43 offen offset:1024 sc1
    s_sub_u32 s3, s29, 8
    s_cmp_ge_u32 s3, 4
    s_cbranch_scc1 CG_3_F
    s_add_u32 s3, s43, 35389440
    v_mov_b32 v20, 0
    v_mov_b32 v21, 0
    v_mov_b32 v22, 0
    v_mov_b32 v23, 0
    buffer_store_dwordx4 v[20:23], v13, s[8:11], s3 offen sc1
    buffer_store_dwordx4 v[20:23], v13, s[8:11], s3 offen offset:1024 sc1
CG_3_F:
    s_add_u32 s3, s29, 2
    s_and_b32 s3, s3, 3
    s_mul_i32 s3, s3, 327680
    s_add_u32 s3, s3, 8388608
    v_mov_b32 v44, 0
    v_mov_b32 v45, 0
    v_mov_b32 v46, 0
    v_mov_b32 v47, 0
    buffer_store_dwordx4 v[44:47], v3, s[8:11], s3 offen sc1
    buffer_store_dword v63, v61, s[8:11], s33 offen
    s_add_u32 s35, s29, 3
    s_and_b32 s35, s35, 3
    s_mul_i32 s35, s35, 10240
    s_add_u32 s35, s35, 557056
    s_add_u32 s35, s35, s32
    s_add_u32 s36, s35, 4096
    buffer_load_dwordx4 v[208:211], v12, s[8:11], s35 offen offset:0 sc1
    buffer_load_dwordx4 v[212:215], v12, s[8:11], s35 offen offset:1024 sc1
    buffer_load_dwordx4 v[216:219], v12, s[8:11], s35 offen offset:2048 sc1
    buffer_load_dwordx4 v[220:223], v12, s[8:11], s35 offen offset:3072 sc1
    buffer_load_dwordx4 v[224:227], v12, s[8:11], s36 offen sc1
    s_waitcnt lgkmcnt(0)
    s_barrier
    s_add_u32 s43, s43, 655360
    s_add_u32 s29, s29, 1
    s_cmp_lt_u32 s29, 64
    s_cbranch_scc1 CG_LOOP_F
    s_add_u32 s3, s29, 2
    s_and_b32 s3, s3, 3
    s_lshl_b32 s4, s3, 14
    v_add_u32 v9, s4, v11
    s_lshl_b32 s3, s3, 12
    s_add_u32 s3, s3, 65536
    v_add_u32 v10, s3, v11
    ds_read_b128 v[228:231], v9 offset:0
    ds_read_b128 v[232:235], v9 offset:4096
    ds_read_b128 v[236:239], v9 offset:8192
    ds_read_b128 v[240:243], v9 offset:12288
    ds_read_b128 v[244:247], v10 offset:0
    ds_read_b128 v[248:251], v9 offset:1024
    ds_read_b128 v[252:255], v9 offset:5120
    ds_read_b128 v[48:51], v9 offset:9216
    ds_read_b128 v[52:55], v9 offset:13312
    ds_read_b128 v[56:59], v10 offset:1024
    s_waitcnt vmcnt(0) lgkmcnt(0)
    v_mfma_f32_16x16x32_bf16 v[20:23], v[228:231], v[208:211], 0
    v_mfma_f32_16x16x32_bf16 v[28:31], v[248:251], v[208:211], 0
    v_mfma_f32_16x16x32_bf16 v[20:23], v[232:235], v[212:215], v[20:23]
    v_mfma_f32_16x16x32_bf16 v[28:31], v[252:255], v[212:215], v[28:31]
    v_mfma_f32_16x16x32_bf16 v[20:23], v[236:239], v[216:219], v[20:23]
    v_mfma_f32_16x16x32_bf16 v[28:31], v[48:51], v[216:219], v[28:31]
    v_mfma_f32_16x16x32_bf16 v[20:23], v[240:243], v[220:223], v[20:23]
    v_mfma_f32_16x16x32_bf16 v[28:31], v[52:55], v[220:223], v[28:31]
    v_mfma_f32_16x16x32_bf16 v[20:23], v[244:247], v[224:227], v[20:23]
    v_mfma_f32_16x16x32_bf16 v[28:31], v[56:59], v[224:227], v[28:31]
    s_nop 6
    v_and_or_b32 v24, v20, -4, 1
    v_and_or_b32 v28, v28, -4, 1
    v_and_or_b32 v25, v21, -4, 1
    v_and_or_b32 v29, v29, -4, 1
    v_and_or_b32 v26, v22, -4, 1
    v_and_or_b32 v30, v30, -4, 1
    v_and_or_b32 v27, v23, -4, 1
    v_and_or_b32 v31, v31, -4, 1
    v_mov_b32 v20, v24
    v_mov_b32 v21, v25
    v_mov_b32 v22, v26
    v_mov_b32 v23, v27
    v_mov_b32_dpp v20, v28 row_ror:8 row_mask:0xf bank_mask:0xc
    v_mov_b32_dpp v21, v29 row_ror:8 row_mask:0xf bank_mask:0xc
    v_mov_b32_dpp v22, v30 row_ror:8 row_mask:0xf bank_mask:0xc
    v_mov_b32_dpp v23, v31 row_ror:8 row_mask:0xf bank_mask:0xc
    v_mov_b32_dpp v28, v24 row_ror:8 row_mask:0xf bank_mask:0x3
    v_mov_b32_dpp v29, v25 row_ror:8 row_mask:0xf bank_mask:0x3
    v_mov_b32_dpp v30, v26 row_ror:8 row_mask:0xf bank_mask:0x3
    v_mov_b32_dpp v31, v27 row_ror:8 row_mask:0xf bank_mask:0x3
    buffer_store_dwordx4 v[20:23], v13, s[8:11], s43 offen sc1
    buffer_store_dwordx4 v[28:31], v13, s[8:11], s43 offen offset:1024 sc1
    s_mov_b32 s4, 64
FW_34:
    buffer_load_dword v62, v60, s[8:11], s33 offen sc1
    s_waitcnt vmcnt(0)
    v_cmp_gt_u32 vcc, s4, v62
    s_cbranch_vccz FO_35
    s_sub_u32 s30, s30, 1
    s_cbranch_scc0 FW_34
    s_branch END
FO_35:
    s_add_u32 s35, s29, 3
    s_and_b32 s35, s35, 3
    s_mul_i32 s35, s35, 10240
    s_add_u32 s35, s35, 557056
    s_add_u32 s35, s35, s32
    s_add_u32 s36, s35, 4096
    buffer_load_dwordx4 v[208:211], v12, s[8:11], s35 offen offset:0 sc1
    buffer_load_dwordx4 v[212:215], v12, s[8:11], s35 offen offset:1024 sc1
    buffer_load_dwordx4 v[216:219], v12, s[8:11], s35 offen offset:2048 sc1
    buffer_load_dwordx4 v[220:223], v12, s[8:11], s35 offen offset:3072 sc1
    buffer_load_dwordx4 v[224:227], v12, s[8:11], s36 offen sc1
    s_add_u32 s43, s43, 655360
    s_add_u32 s29, s29, 1
    s_add_u32 s3, s29, 2
    s_and_b32 s3, s3, 3
    s_lshl_b32 s4, s3, 14
    v_add_u32 v9, s4, v11
    s_lshl_b32 s3, s3, 12
    s_add_u32 s3, s3, 65536
    v_add_u32 v10, s3, v11
    ds_read_b128 v[228:231], v9 offset:0
    ds_read_b128 v[232:235], v9 offset:4096
    ds_read_b128 v[236:239], v9 offset:8192
    ds_read_b128 v[240:243], v9 offset:12288
    ds_read_b128 v[244:247], v10 offset:0
    ds_read_b128 v[248:251], v9 offset:1024
    ds_read_b128 v[252:255], v9 offset:5120
    ds_read_b128 v[48:51], v9 offset:9216
    ds_read_b128 v[52:55], v9 offset:13312
    ds_read_b128 v[56:59], v10 offset:1024
    s_waitcnt vmcnt(0) lgkmcnt(0)
    v_mfma_f32_16x16x32_bf16 v[20:23], v[228:231], v[208:211], 0
    v_mfma_f32_16x16x32_bf16 v[28:31], v[248:251], v[208:211], 0
    v_mfma_f32_16x16x32_bf16 v[20:23], v[232:235], v[212:215], v[20:23]
    v_mfma_f32_16x16x32_bf16 v[28:31], v[252:255], v[212:215], v[28:31]
    v_mfma_f32_16x16x32_bf16 v[20:23], v[236:239], v[216:219], v[20:23]
    v_mfma_f32_16x16x32_bf16 v[28:31], v[48:51], v[216:219], v[28:31]
    v_mfma_f32_16x16x32_bf16 v[20:23], v[240:243], v[220:223], v[20:23]
    v_mfma_f32_16x16x32_bf16 v[28:31], v[52:55], v[220:223], v[28:31]
    v_mfma_f32_16x16x32_bf16 v[20:23], v[244:247], v[224:227], v[20:23]
    v_mfma_f32_16x16x32_bf16 v[28:31], v[56:59], v[224:227], v[28:31]
    s_nop 6
    v_and_or_b32 v24, v20, -4, 1
    v_and_or_b32 v28, v28, -4, 1
    v_and_or_b32 v25, v21, -4, 1
    v_and_or_b32 v29, v29, -4, 1
    v_and_or_b32 v26, v22, -4, 1
    v_and_or_b32 v30, v30, -4, 1
    v_and_or_b32 v27, v23, -4, 1
    v_and_or_b32 v31, v31, -4, 1
    v_mov_b32 v20, v24
    v_mov_b32 v21, v25
    v_mov_b32 v22, v26
    v_mov_b32 v23, v27
    v_mov_b32_dpp v20, v28 row_ror:8 row_mask:0xf bank_mask:0xc
    v_mov_b32_dpp v21, v29 row_ror:8 row_mask:0xf bank_mask:0xc
    v_mov_b32_dpp v22, v30 row_ror:8 row_mask:0xf bank_mask:0xc
    v_mov_b32_dpp v23, v31 row_ror:8 row_mask:0xf bank_mask:0xc
    v_mov_b32_dpp v28, v24 row_ror:8 row_mask:0xf bank_mask:0x3
    v_mov_b32_dpp v29, v25 row_ror:8 row_mask:0xf bank_mask:0x3
    v_mov_b32_dpp v30, v26 row_ror:8 row_mask:0xf bank_mask:0x3
    v_mov_b32_dpp v31, v27 row_ror:8 row_mask:0xf bank_mask:0x3
    buffer_store_dwordx4 v[20:23], v13, s[8:11], s43 offen sc1
    buffer_store_dwordx4 v[28:31], v13, s[8:11], s43 offen offset:1024 sc1
    s_waitcnt vmcnt(0)
    s_waitcnt vmcnt(0)
    s_branch END
CG_E0_F:
    s_cmp_eq_u32 s29, 1
    s_cbranch_scc1 CG_Y_F
    s_mov_b32 s4, 2
FW_36:
    buffer_load_dword v62, v15, s[8:11], s33 offen sc1
    s_waitcnt vmcnt(0)
    v_cmp_gt_u32 vcc, s4, v62
    s_cbranch_vccz FO_37
    s_sub_u32 s30, s30, 1
    s_cbranch_scc0 FW_36
    s_branch END
FO_37:
    s_add_u32 s35, s29, 1
    s_and_b32 s35, s35, 3
    s_mul_i32 s35, s35, 49152
    s_add_u32 s35, s35, 163840
    s_add_u32 s35, s35, s32
    s_add_u32 s36, s35, 4096
    s_add_u32 s37, s35, 8192
    buffer_load_dwordx4 v[160:163], v14, s[8:11], s35 offen offset:0 sc1
    buffer_load_dwordx4 v[164:167], v14, s[8:11], s35 offen offset:1024 sc1
    buffer_load_dwordx4 v[168:171], v14, s[8:11], s35 offen offset:2048 sc1
    buffer_load_dwordx4 v[172:175], v14, s[8:11], s35 offen offset:3072 sc1
    buffer_load_dwordx4 v[176:179], v14, s[8:11], s36 offen offset:0 sc1
    buffer_load_dwordx4 v[180:183], v14, s[8:11], s36 offen offset:1024 sc1
    buffer_load_dwordx4 v[184:187], v14, s[8:11], s36 offen offset:2048 sc1
    buffer_load_dwordx4 v[188:191], v14, s[8:11], s36 offen offset:3072 sc1
    buffer_load_dwordx4 v[192:195], v14, s[8:11], s37 offen offset:0 sc1
    buffer_load_dwordx4 v[196:199], v14, s[8:11], s37 offen offset:1024 sc1
    buffer_load_dwordx4 v[200:203], v14, s[8:11], s37 offen offset:2048 sc1
    buffer_load_dwordx4 v[204:207], v14, s[8:11], s37 offen offset:3072 sc1
CG_Y_F:
    s_add_u32 s4, s29, 3
FW_38:
    buffer_load_dword v62, v15, s[8:11], s33 offen sc1
    s_waitcnt vmcnt(0)
    v_cmp_gt_u32 vcc, s4, v62
    s_cbranch_vccz FO_39
    s_sub_u32 s30, s30, 1
    s_cbranch_scc0 FW_38
    s_branch END
FO_39:
    s_branch CG_Z_F
CAUX_F:
    s_setprio 2
    s_sub_u32 s14, s26, 4
    s_mul_i32 s3, s14, 3840
    v_add_u32 v4, s3, v2
    s_add_u32 s3, s3, 1024
    v_lshlrev_b32 v5, 2, v0
    v_add_u32 v5, s3, v5
    v_and_b32 v6, 3, v0
    v_bfe_u32 v7, v0, 2, 3
    v_lshl_add_u32 v12, v6, 3, v7
    v_lshlrev_b32 v12, 4, v12
    v_lshrrev_b32 v8, 5, v0
    v_lshl_add_u32 v12, v8, 3, v12
    s_lshl_b32 s3, s14, 9
    s_add_u32 s3, s3, 81920
    v_add_u32 v12, s3, v12
    v_lshlrev_b32 v13, 4, v7
    v_lshl_add_u32 v13, v8, 3, v13
    v_lshl_add_u32 v13, v6, 1, v13
    s_lshl_b32 s3, s14, 7
    s_add_u32 s3, s3, 83968
    v_add_u32 v13, s3, v13
    s_lshl_b32 s3, s15, 7
    s_add_u32 s3, s3, 2048
    s_cmp_eq_u32 s14, 0
    s_cselect_b32 s3, s3, 2147483392
    v_mov_b32 v10, 2147483392
    s_nop 0
    v_writelane_b32 v10, s3, 0
    s_mov_b32 s24, 0x3dd53b95
    v_mov_b32 v20, s24
    v_mov_b32 v21, s24
    s_mov_b32 s40, 0
    s_cmp_lg_u32 s14, 0
    s_cbranch_scc1 CA_C_F
    v_and_b32 v24, 31, v0
    v_lshlrev_b32 v24, 4, v24
    v_lshrrev_b32 v25, 5, v0
    v_lshl_add_u32 v24, v25, 11, v24
    s_lshl_b32 s3, s15, 15
    v_add_u32 v24, s3, v24
    s_mov_b32 s6, -1
    s_mov_b32 s7, -1
    s_mov_b32 s4, 9043968
    buffer_load_dwordx2 v[26:27], v24, s[8:11], s4 offen sc1
    s_waitcnt vmcnt(0)
    s_mov_b32 s4, 9371648
    s_memtime s[60:61]
    s_waitcnt lgkmcnt(0)
    buffer_load_dwordx2 v[26:27], v24, s[8:11], s4 offen sc1
    s_waitcnt vmcnt(0)
    s_memtime s[62:63]
    s_waitcnt lgkmcnt(0)
    s_sub_u32 s3, s62, s60
    s_min_u32 s6, s6, s3
    s_mov_b32 s4, 9379840
    s_memtime s[60:61]
    s_waitcnt lgkmcnt(0)
    buffer_load_dwordx2 v[26:27], v24, s[8:11], s4 offen sc1
    s_waitcnt vmcnt(0)
    s_memtime s[62:63]
    s_waitcnt lgkmcnt(0)
    s_sub_u32 s3, s62, s60
    s_min_u32 s7, s7, s3
    s_mov_b32 s4, 9375744
    s_memtime s[60:61]
    s_waitcnt lgkmcnt(0)
    buffer_load_dwordx2 v[26:27], v24, s[8:11], s4 offen sc1
    s_waitcnt vmcnt(0)
    s_memtime s[62:63]
    s_waitcnt lgkmcnt(0)
    s_sub_u32 s3, s62, s60
    s_min_u32 s6, s6, s3
    s_mov_b32 s4, 9383936
    s_memtime s[60:61]
    s_waitcnt lgkmcnt(0)
    buffer_load_dwordx2 v[26:27], v24, s[8:11], s4 offen sc1
    s_waitcnt vmcnt(0)
    s_memtime s[62:63]
    s_waitcnt lgkmcnt(0)
    s_sub_u32 s3, s62, s60
    s_min_u32 s7, s7, s3
    s_min_u32 s3, s6, s7
    s_cmp_lt_u32 s3, 520
    s_cbranch_scc1 CA_K_F
    s_mov_b32 s4, 9388032
    s_memtime s[60:61]
    s_waitcnt lgkmcnt(0)
    buffer_load_dwordx2 v[26:27], v24, s[8:11], s4 offen sc1
    s_waitcnt vmcnt(0)
    s_memtime s[62:63]
    s_waitcnt lgkmcnt(0)
    s_sub_u32 s3, s62, s60
    s_min_u32 s6, s6, s3
    s_mov_b32 s4, 9396224
    s_memtime s[60:61]
    s_waitcnt lgkmcnt(0)
    buffer_load_dwordx2 v[26:27], v24, s[8:11], s4 offen sc1
    s_waitcnt vmcnt(0)
    s_memtime s[62:63]
    s_waitcnt lgkmcnt(0)
    s_sub_u32 s3, s62, s60
    s_min_u32 s7, s7, s3
    s_min_u32 s3, s6, s7
    s_cmp_lt_u32 s3, 520
    s_cbranch_scc1 CA_K_F
    s_mov_b32 s4, 9392128
    s_memtime s[60:61]
    s_waitcnt lgkmcnt(0)
    buffer_load_dwordx2 v[26:27], v24, s[8:11], s4 offen sc1
    s_waitcnt vmcnt(0)
    s_memtime s[62:63]
    s_waitcnt lgkmcnt(0)
    s_sub_u32 s3, s62, s60
    s_min_u32 s6, s6, s3
    s_mov_b32 s4, 9400320
    s_memtime s[60:61]
    s_waitcnt lgkmcnt(0)
    buffer_load_dwordx2 v[26:27], v24, s[8:11], s4 offen sc1
    s_waitcnt vmcnt(0)
    s_memtime s[62:63]
    s_waitcnt lgkmcnt(0)
    s_sub_u32 s3, s62, s60
    s_min_u32 s7, s7, s3
    s_min_u32 s3, s6, s7
    s_cmp_lt_u32 s3, 520
    s_cbranch_scc1 CA_K_F
    s_mov_b32 s4, 9372160
    s_memtime s[60:61]
    s_waitcnt lgkmcnt(0)
    buffer_load_dwordx2 v[26:27], v24, s[8:11], s4 offen sc1
    s_waitcnt vmcnt(0)
    s_memtime s[62:63]
    s_waitcnt lgkmcnt(0)
    s_sub_u32 s3, s62, s60
    s_min_u32 s6, s6, s3
    s_mov_b32 s4, 9380352
    s_memtime s[60:61]
    s_waitcnt lgkmcnt(0)
    buffer_load_dwordx2 v[26:27], v24, s[8:11], s4 offen sc1
    s_waitcnt vmcnt(0)
    s_memtime s[62:63]
    s_waitcnt lgkmcnt(0)
    s_sub_u32 s3, s62, s60
    s_min_u32 s7, s7, s3
    s_min_u32 s3, s6, s7
    s_cmp_lt_u32 s3, 520
    s_cbranch_scc1 CA_K_F
    s_mov_b32 s4, 9376256
    s_memtime s[60:61]
    s_waitcnt lgkmcnt(0)
    buffer_load_dwordx2 v[26:27], v24, s[8:11], s4 offen sc1
    s_waitcnt vmcnt(0)
    s_memtime s[62:63]
    s_waitcnt lgkmcnt(0)
    s_sub_u32 s3, s62, s60
    s_min_u32 s6, s6, s3
    s_mov_b32 s4, 9384448
    s_memtime s[60:61]
    s_waitcnt lgkmcnt(0)
    buffer_load_dwordx2 v[26:27], v24, s[8:11], s4 offen sc1
    s_waitcnt vmcnt(0)
    s_memtime s[62:63]
    s_waitcnt lgkmcnt(0)
    s_sub_u32 s3, s62, s60
    s_min_u32 s7, s7, s3
    s_min_u32 s3, s6, s7
    s_cmp_lt_u32 s3, 520
    s_cbranch_scc1 CA_K_F
    s_mov_b32 s4, 9388544
    s_memtime s[60:61]
    s_waitcnt lgkmcnt(0)
    buffer_load_dwordx2 v[26:27], v24, s[8:11], s4 offen sc1
    s_waitcnt vmcnt(0)
    s_memtime s[62:63]
    s_waitcnt lgkmcnt(0)
    s_sub_u32 s3, s62, s60
    s_min_u32 s6, s6, s3
    s_mov_b32 s4, 9396736
    s_memtime s[60:61]
    s_waitcnt lgkmcnt(0)
    buffer_load_dwordx2 v[26:27], v24, s[8:11], s4 offen sc1
    s_waitcnt vmcnt(0)
    s_memtime s[62:63]
    s_waitcnt lgkmcnt(0)
    s_sub_u32 s3, s62, s60
    s_min_u32 s7, s7, s3
    s_min_u32 s3, s6, s7
    s_cmp_lt_u32 s3, 520
    s_cbranch_scc1 CA_K_F
    s_mov_b32 s4, 9392640
    s_memtime s[60:61]
    s_waitcnt lgkmcnt(0)
    buffer_load_dwordx2 v[26:27], v24, s[8:11], s4 offen sc1
    s_waitcnt vmcnt(0)
    s_memtime s[62:63]
    s_waitcnt lgkmcnt(0)
    s_sub_u32 s3, s62, s60
    s_min_u32 s6, s6, s3
    s_mov_b32 s4, 9400832
    s_memtime s[60:61]
    s_waitcnt lgkmcnt(0)
    buffer_load_dwordx2 v[26:27], v24, s[8:11], s4 offen sc1
    s_waitcnt vmcnt(0)
    s_memtime s[62:63]
    s_waitcnt lgkmcnt(0)
    s_sub_u32 s3, s62, s60
    s_min_u32 s7, s7, s3
CA_K_F:
    s_cmp_lt_u32 s7, s6
    s_cselect_b32 s40, 1, 0
CA_C_F:
    s_mov_b32 s29, 0
    s_barrier
    s_and_b32 s34, s29, 3
    s_mul_i32 s34, s34, 15360
    s_add_u32 s34, s34, 90112
    s_add_u32 s34, s34, s32
    s_lshr_b32 s25, s29, 2
    s_and_b32 s25, s25, 1
    s_add_u32 s25, s25, 1
    s_lshl_b32 s3, s29, 1
    s_add_u32 s3, s3, s40
    s_add_u32 s3, s3, 2
    v_mov_b32 v11, s3
    s_branch CA_P2_F
    .p2align 6
CA_LOOP_F:
    s_and_b32 s34, s29, 3
    s_mul_i32 s34, s34, 15360
    s_add_u32 s34, s34, 90112
    s_add_u32 s34, s34, s32
    s_lshr_b32 s25, s29, 2
    s_and_b32 s25, s25, 1
    s_add_u32 s25, s25, 1
    s_lshl_b32 s3, s29, 1
    s_add_u32 s3, s3, s40
    s_add_u32 s3, s3, 2
    v_mov_b32 v11, s3
    s_sleep 16
CA_P2_F:
    s_sub_u32 s30, s30, 1
    s_cbranch_scc1 END
    buffer_load_dwordx4 v[24:27], v4, s[8:11], s34 offen offset:0 sc1
    buffer_load_dwordx4 v[28:31], v4, s[8:11], s34 offen offset:1280 sc1
    buffer_load_dwordx4 v[32:35], v4, s[8:11], s34 offen offset:2560 sc1
    buffer_load_dword v36, v5, s[8:11], s34 offen offset:0 sc1
    buffer_load_dword v37, v5, s[8:11], s34 offen offset:1280 sc1
    buffer_load_dword v38, v5, s[8:11], s34 offen offset:2560 sc1
    s_waitcnt vmcnt(5)
    v_bitop3_b32 v40, s25, v24, v25 bitop3:0x80
    v_bitop3_b32 v40, v40, v26, v27 bitop3:0x80
    s_waitcnt vmcnt(4)
    v_pk_add_f32 v[72:73], v[24:25], v[28:29]
    v_pk_add_f32 v[74:75], v[26:27], v[30:31]
    v_bitop3_b32 v40, v40, v28, v29 bitop3:0x80
    v_bitop3_b32 v40, v40, v30, v31 bitop3:0x80
    s_waitcnt vmcnt(3)
    v_pk_add_f32 v[72:73], v[72:73], v[32:33]
    v_pk_add_f32 v[74:75], v[74:75], v[34:35]
    v_bitop3_b32 v40, v40, v32, v33 bitop3:0x80
    v_bitop3_b32 v40, v40, v34, v35 bitop3:0x80
    v_max3_f32 v77, v72, v73, v74
    s_waitcnt vmcnt(0)
    v_bitop3_b32 v40, v40, v36, v37 bitop3:0x80
    v_add_f32 v76, v36, v37
    v_and_b32 v40, v40, v38
    v_add_f32 v76, v76, v38
    v_cmp_eq_u32 vcc, 0, v40
    v_max3_f32 v77, v77, v75, v76
    s_cbranch_vccnz CA_P2_F
    s_nop 0
    v_max_f32_dpp v77, v77, v77 quad_perm:[1,0,3,2] row_mask:0xf bank_mask:0xf
    s_nop 1
    v_max_f32_dpp v77, v77, v77 quad_perm:[2,3,0,1] row_mask:0xf bank_mask:0xf
    v_mov_b32 v78, v77
    s_nop 1
    v_permlane32_swap_b32 v77, v78
    v_max_f32 v77, v77, v78
    v_mul_f32 v78, s24, v77
    v_pk_fma_f32 v[72:73], v[72:73], v[20:21], v[78:79] op_sel_hi:[1,1,0] neg_lo:[0,0,1] neg_hi:[0,0,1]
    v_pk_fma_f32 v[74:75], v[74:75], v[20:21], v[78:79] op_sel_hi:[1,1,0] neg_lo:[0,0,1] neg_hi:[0,0,1]
    v_fma_f32 v76, v76, v20, -v78
    v_exp_f32 v72, v72
    v_exp_f32 v73, v73
    v_exp_f32 v74, v74
    v_exp_f32 v75, v75
    v_exp_f32 v76, v76
    v_pk_add_f32 v[78:79], v[72:73], v[74:75]
    v_add_f32 v77, v78, v76
    v_add_f32 v77, v77, v79
    s_nop 1
    v_add_f32_dpp v77, v77, v77 quad_perm:[1,0,3,2] row_mask:0xf bank_mask:0xf
    s_nop 1
    v_add_f32_dpp v77, v77, v77 quad_perm:[2,3,0,1] row_mask:0xf bank_mask:0xf
    v_mov_b32 v78, v77
    s_nop 1
    v_permlane32_swap_b32 v77, v78
    v_add_f32 v77, v77, v78
    v_rcp_f32 v78, v77
    s_nop 0
    v_pk_mul_f32 v[72:73], v[72:73], v[78:79] op_sel_hi:[1,0]
    v_pk_mul_f32 v[74:75], v[74:75], v[78:79] op_sel_hi:[1,0]
    v_mul_f32 v76, v76, v78
    v_cvt_pk_bf16_f32 v72, v72, v73
    v_cvt_pk_bf16_f32 v73, v74, v75
    v_cvt_pk_bf16_f32 v76, v76, v76
    ds_write_b64 v12, v[72:73]
    ds_write_b16 v13, v76
    s_waitcnt lgkmcnt(0)
    s_barrier
    buffer_store_dword v11, v10, s[8:11], s33 offen
    s_barrier
    s_add_u32 s29, s29, 1
    s_cmp_lt_u32 s29, 63
    s_cbranch_scc1 CA_LOOP_F
    s_waitcnt lgkmcnt(0)
    s_barrier
    s_barrier
    s_waitcnt vmcnt(0)
    s_waitcnt vmcnt(0)
    s_branch END
CHAIN_S:
    s_lshl_b32 s33, s27, 12
    s_add_u32 s33, s33, 13631488
    s_cmp_ge_u32 s28, 18
    s_cbranch_scc1 COMB_S
    s_cmp_ge_u32 s26, 4
    s_cbranch_scc1 PAUX_S
    v_and_b32 v4, 15, v0
    v_cmp_gt_u32 vcc, 8, v4
    v_mov_b32 v5, 0xeeee
    v_mov_b32 v6, 0x4444
    v_cndmask_b32 v5, v5, v6, vcc
    v_add_u32 v11, 81920, v2
    s_cmp_ge_u32 s28, 12
    s_cbranch_scc1 VG_S
    v_and_b32 v4, 15, v0
    v_lshlrev_b32 v6, 5, v4
    v_lshrrev_b32 v7, 4, v0
    v_lshl_add_u32 v6, v7, 3, v6
    s_lshl_b32 s3, s26, 9
    s_add_u32 s3, s3, 92160
    v_add_u32 v6, s3, v6
    s_lshr_b32 s3, s26, 1
    s_lshl_b32 s3, s3, 10
    s_and_b32 s4, s26, 1
    s_lshl_b32 s4, s4, 3
    s_add_u32 s3, s3, s4
    s_add_u32 s3, s3, 94208
    v_add_u32 v7, s3, v2
    s_mov_b32 s29, -1
    s_branch SG_TOK_S
SG_LOOP_S:
    v_mov_b32 v56, 0
    v_mov_b32 v57, 0
    v_mov_b32 v58, 0
    v_mov_b32 v59, 0
    v_mov_b32 v60, 0
    v_mov_b32 v61, 0
    v_mov_b32 v62, 0
    v_mov_b32 v63, 0
    s_waitcnt lgkmcnt(0)
    s_barrier
    ds_read_b128 v[16:19], v11 offset:0
    ds_read_b128 v[20:23], v11 offset:1024
    ds_read_b128 v[24:27], v11 offset:2048
    ds_read_b128 v[28:31], v11 offset:3072
    ds_read_b128 v[32:35], v11 offset:4096
    ds_read_b128 v[36:39], v11 offset:5120
    ds_read_b128 v[40:43], v11 offset:6144
    ds_read_b128 v[44:47], v11 offset:7168
    ds_read_b128 v[48:51], v11 offset:8192
    ds_read_b128 v[52:55], v11 offset:9216
    s_waitcnt lgkmcnt(9)
    v_smfmac_f32_16x16x64_bf16 v[56:59], v[16:19], v[64:71], v5
    v_smfmac_f32_16x16x64_bf16 v[60:63], v[16:19], v[72:79], v5
    s_waitcnt lgkmcnt(8)
    v_smfmac_f32_16x16x64_bf16 v[56:59], v[20:23], v[80:87], v5
    v_smfmac_f32_16x16x64_bf16 v[60:63], v[20:23], v[88:95], v5
    s_waitcnt lgkmcnt(7)
    v_smfmac_f32_16x16x64_bf16 v[56:59], v[24:27], v[96:103], v5
    v_smfmac_f32_16x16x64_bf16 v[60:63], v[24:27], v[104:111], v5
    s_waitcnt lgkmcnt(6)
    v_smfmac_f32_16x16x64_bf16 v[56:59], v[28:31], v[112:119], v5
    v_smfmac_f32_16x16x64_bf16 v[60:63], v[28:31], v[120:127], v5
    s_waitcnt lgkmcnt(5)
    v_smfmac_f32_16x16x64_bf16 v[56:59], v[32:35], v[128:135], v5
    v_smfmac_f32_16x16x64_bf16 v[60:63], v[32:35], v[136:143], v5
    s_waitcnt lgkmcnt(4)
    v_smfmac_f32_16x16x64_bf16 v[56:59], v[36:39], v[144:151], v5
    v_smfmac_f32_16x16x64_bf16 v[60:63], v[36:39], v[152:159], v5
    s_waitcnt lgkmcnt(3)
    v_smfmac_f32_16x16x64_bf16 v[56:59], v[40:43], v[160:167], v5
    v_smfmac_f32_16x16x64_bf16 v[60:63], v[40:43], v[168:175], v5
    s_waitcnt lgkmcnt(2)
    v_smfmac_f32_16x16x64_bf16 v[56:59], v[44:47], v[176:183], v5
    v_smfmac_f32_16x16x64_bf16 v[60:63], v[44:47], v[184:191], v5
    s_waitcnt lgkmcnt(1)
    v_smfmac_f32_16x16x64_bf16 v[56:59], v[48:51], v[192:199], v5
    v_smfmac_f32_16x16x64_bf16 v[60:63], v[48:51], v[200:207], v5
    s_waitcnt lgkmcnt(0)
    v_smfmac_f32_16x16x64_bf16 v[56:59], v[52:55], v[208:215], v5
    v_smfmac_f32_16x16x64_bf16 v[60:63], v[52:55], v[216:223], v5
    s_nop 7
    v_permlane32_swap_b32 v56, v60
    v_permlane32_swap_b32 v57, v61
    v_permlane32_swap_b32 v58, v62
    v_permlane32_swap_b32 v59, v63
    v_pk_add_f32 v[56:57], v[56:57], v[60:61]
    v_pk_add_f32 v[58:59], v[58:59], v[62:63]
    v_cvt_pk_bf16_f32 v56, v56, v57
    v_cvt_pk_bf16_f32 v57, v58, v59
    ds_write_b64 v6, v[56:57]
    s_waitcnt lgkmcnt(0)
    s_barrier
    s_cmp_eq_u32 s29, 63
    s_cbranch_scc1 SG_END_S
SG_TOK_S:
    s_add_u32 s29, s29, 1
    s_and_b32 s3, s29, 1
    s_mul_i32 s3, s3, 40960
    v_add_u32 v9, s3, v2
    ds_read_b128 v[16:19], v9 offset:0
    ds_read_b128 v[20:23], v9 offset:20480
    ds_read_b128 v[24:27], v9 offset:1024
    ds_read_b128 v[28:31], v9 offset:21504
    ds_read_b128 v[32:35], v9 offset:2048
    s_waitcnt lgkmcnt(4)
    v_mfma_f32_16x16x32_bf16 v[224:227], v[64:67], v[16:19], 0
    v_mfma_f32_16x16x32_bf16 v[232:235], v[72:75], v[16:19], 0
    ds_read_b128 v[16:19], v9 offset:22528
    s_waitcnt lgkmcnt(4)
    v_mfma_f32_16x16x32_bf16 v[228:231], v[64:67], v[20:23], 0
    v_mfma_f32_16x16x32_bf16 v[236:239], v[72:75], v[20:23], 0
    ds_read_b128 v[20:23], v9 offset:3072
    s_waitcnt lgkmcnt(4)
    v_mfma_f32_16x16x32_bf16 v[224:227], v[68:71], v[24:27], v[224:227]
    v_mfma_f32_16x16x32_bf16 v[232:235], v[76:79], v[24:27], v[232:235]
    ds_read_b128 v[24:27], v9 offset:23552
    s_waitcnt lgkmcnt(4)
    v_mfma_f32_16x16x32_bf16 v[228:231], v[68:71], v[28:31], v[228:231]
    v_mfma_f32_16x16x32_bf16 v[236:239], v[76:79], v[28:31], v[236:239]
    ds_read_b128 v[28:31], v9 offset:4096
    s_waitcnt lgkmcnt(4)
    v_mfma_f32_16x16x32_bf16 v[224:227], v[80:83], v[32:35], v[224:227]
    v_mfma_f32_16x16x32_bf16 v[232:235], v[88:91], v[32:35], v[232:235]
    ds_read_b128 v[32:35], v9 offset:24576
    s_waitcnt lgkmcnt(4)
    v_mfma_f32_16x16x32_bf16 v[228:231], v[80:83], v[16:19], v[228:231]
    v_mfma_f32_16x16x32_bf16 v[236:239], v[88:91], v[16:19], v[236:239]
    ds_read_b128 v[16:19], v9 offset:5120
    s_waitcnt lgkmcnt(4)
    v_mfma_f32_16x16x32_bf16 v[224:227], v[84:87], v[20:23], v[224:227]
    v_mfma_f32_16x16x32_bf16 v[232:235], v[92:95], v[20:23], v[232:235]
    ds_read_b128 v[20:23], v9 offset:25600
    s_waitcnt lgkmcnt(4)
    v_mfma_f32_16x16x32_bf16 v[228:231], v[84:87], v[24:27], v[228:231]
    v_mfma_f32_16x16x32_bf16 v[236:239], v[92:95], v[24:27], v[236:239]
    ds_read_b128 v[24:27], v9 offset:6144
    s_waitcnt lgkmcnt(4)
    v_mfma_f32_16x16x32_bf16 v[224:227], v[96:99], v[28:31], v[224:227]
    v_mfma_f32_16x16x32_bf16 v[232:235], v[104:107], v[28:31], v[232:235]
    ds_read_b128 v[28:31], v9 offset:26624
    s_waitcnt lgkmcnt(4)
    v_mfma_f32_16x16x32_bf16 v[228:231], v[96:99], v[32:35], v[228:231]
    v_mfma_f32_16x16x32_bf16 v[236:239], v[104:107], v[32:35], v[236:239]
    ds_read_b128 v[32:35], v9 offset:7168
    s_waitcnt lgkmcnt(4)
    v_mfma_f32_16x16x32_bf16 v[224:227], v[100:103], v[16:19], v[224:227]
    v_mfma_f32_16x16x32_bf16 v[232:235], v[108:111], v[16:19], v[232:235]
    ds_read_b128 v[16:19], v9 offset:27648
    s_waitcnt lgkmcnt(4)
    v_mfma_f32_16x16x32_bf16 v[228:231], v[100:103], v[20:23], v[228:231]
    v_mfma_f32_16x16x32_bf16 v[236:239], v[108:111], v[20:23], v[236:239]
    ds_read_b128 v[20:23], v9 offset:8192
    s_waitcnt lgkmcnt(4)
    v_mfma_f32_16x16x32_bf16 v[224:227], v[112:115], v[24:27], v[224:227]
    v_mfma_f32_16x16x32_bf16 v[232:235], v[120:123], v[24:27], v[232:235]
    ds_read_b128 v[24:27], v9 offset:28672
    s_waitcnt lgkmcnt(4)
    v_mfma_f32_16x16x32_bf16 v[228:231], v[112:115], v[28:31], v[228:231]
    v_mfma_f32_16x16x32_bf16 v[236:239], v[120:123], v[28:31], v[236:239]
    ds_read_b128 v[28:31], v9 offset:9216
    s_waitcnt lgkmcnt(4)
    v_mfma_f32_16x16x32_bf16 v[224:227], v[116:119], v[32:35], v[224:227]
    v_mfma_f32_16x16x32_bf16 v[232:235], v[124:127], v[32:35], v[232:235]
    ds_read_b128 v[32:35], v9 offset:29696
    s_waitcnt lgkmcnt(4)
    v_mfma_f32_16x16x32_bf16 v[228:231], v[116:119], v[16:19], v[228:231]
    v_mfma_f32_16x16x32_bf16 v[236:239], v[124:127], v[16:19], v[236:239]
    ds_read_b128 v[16:19], v9 offset:10240
    s_waitcnt lgkmcnt(4)
    v_mfma_f32_16x16x32_bf16 v[224:227], v[128:131], v[20:23], v[224:227]
    v_mfma_f32_16x16x32_bf16 v[232:235], v[136:139], v[20:23], v[232:235]
    ds_read_b128 v[20:23], v9 offset:30720
    s_waitcnt lgkmcnt(4)
    v_mfma_f32_16x16x32_bf16 v[228:231], v[128:131], v[24:27], v[228:231]
    v_mfma_f32_16x16x32_bf16 v[236:239], v[136:139], v[24:27], v[236:239]
    ds_read_b128 v[24:27], v9 offset:11264
    s_waitcnt lgkmcnt(4)
    v_mfma_f32_16x16x32_bf16 v[224:227], v[132:135], v[28:31], v[224:227]
    v_mfma_f32_16x16x32_bf16 v[232:235], v[140:143], v[28:31], v[232:235]
    ds_read_b128 v[28:31], v9 offset:31744
    s_waitcnt lgkmcnt(4)
    v_mfma_f32_16x16x32_bf16 v[228:231], v[132:135], v[32:35], v[228:231]
    v_mfma_f32_16x16x32_bf16 v[236:239], v[140:143], v[32:35], v[236:239]
    ds_read_b128 v[32:35], v9 offset:12288
    s_waitcnt lgkmcnt(4)
    v_mfma_f32_16x16x32_bf16 v[224:227], v[144:147], v[16:19], v[224:227]
    v_mfma_f32_16x16x32_bf16 v[232:235], v[152:155], v[16:19], v[232:235]
    ds_read_b128 v[16:19], v9 offset:32768
    s_waitcnt lgkmcnt(4)
    v_mfma_f32_16x16x32_bf16 v[228:231], v[144:147], v[20:23], v[228:231]
    v_mfma_f32_16x16x32_bf16 v[236:239], v[152:155], v[20:23], v[236:239]
    ds_read_b128 v[20:23], v9 offset:13312
    s_waitcnt lgkmcnt(4)
    v_mfma_f32_16x16x32_bf16 v[224:227], v[148:151], v[24:27], v[224:227]
    v_mfma_f32_16x16x32_bf16 v[232:235], v[156:159], v[24:27], v[232:235]
    ds_read_b128 v[24:27], v9 offset:33792
    s_waitcnt lgkmcnt(4)
    v_mfma_f32_16x16x32_bf16 v[228:231], v[148:151], v[28:31], v[228:231]
    v_mfma_f32_16x16x32_bf16 v[236:239], v[156:159], v[28:31], v[236:239]
    ds_read_b128 v[28:31], v9 offset:14336
    s_waitcnt lgkmcnt(4)
    v_mfma_f32_16x16x32_bf16 v[224:227], v[160:163], v[32:35], v[224:227]
    v_mfma_f32_16x16x32_bf16 v[232:235], v[168:171], v[32:35], v[232:235]
    ds_read_b128 v[32:35], v9 offset:34816
    s_waitcnt lgkmcnt(4)
    v_mfma_f32_16x16x32_bf16 v[228:231], v[160:163], v[16:19], v[228:231]
    v_mfma_f32_16x16x32_bf16 v[236:239], v[168:171], v[16:19], v[236:239]
    ds_read_b128 v[16:19], v9 offset:15360
    s_waitcnt lgkmcnt(4)
    v_mfma_f32_16x16x32_bf16 v[224:227], v[164:167], v[20:23], v[224:227]
    v_mfma_f32_16x16x32_bf16 v[232:235], v[172:175], v[20:23], v[232:235]
    ds_read_b128 v[20:23], v9 offset:35840
    s_waitcnt lgkmcnt(4)
    v_mfma_f32_16x16x32_bf16 v[228:231], v[164:167], v[24:27], v[228:231]
    v_mfma_f32_16x16x32_bf16 v[236:239], v[172:175], v[24:27], v[236:239]
    ds_read_b128 v[24:27], v9 offset:16384
    s_waitcnt lgkmcnt(4)
    v_mfma_f32_16x16x32_bf16 v[224:227], v[176:179], v[28:31], v[224:227]
    v_mfma_f32_16x16x32_bf16 v[232:235], v[184:187], v[28:31], v[232:235]
    ds_read_b128 v[28:31], v9 offset:36864
    s_waitcnt lgkmcnt(4)
    v_mfma_f32_16x16x32_bf16 v[228:231], v[176:179], v[32:35], v[228:231]
    v_mfma_f32_16x16x32_bf16 v[236:239], v[184:187], v[32:35], v[236:239]
    ds_read_b128 v[32:35], v9 offset:17408
    s_waitcnt lgkmcnt(4)
    v_mfma_f32_16x16x32_bf16 v[224:227], v[180:183], v[16:19], v[224:227]
    v_mfma_f32_16x16x32_bf16 v[232:235], v[188:191], v[16:19], v[232:235]
    ds_read_b128 v[16:19], v9 offset:37888
    s_waitcnt lgkmcnt(4)
    v_mfma_f32_16x16x32_bf16 v[228:231], v[180:183], v[20:23], v[228:231]
    v_mfma_f32_16x16x32_bf16 v[236:239], v[188:191], v[20:23], v[236:239]
    ds_read_b128 v[20:23], v9 offset:18432
    s_waitcnt lgkmcnt(4)
    v_mfma_f32_16x16x32_bf16 v[224:227], v[192:195], v[24:27], v[224:227]
    v_mfma_f32_16x16x32_bf16 v[232:235], v[200:203], v[24:27], v[232:235]
    ds_read_b128 v[24:27], v9 offset:38912
    s_waitcnt lgkmcnt(4)
    v_mfma_f32_16x16x32_bf16 v[228:231], v[192:195], v[28:31], v[228:231]
    v_mfma_f32_16x16x32_bf16 v[236:239], v[200:203], v[28:31], v[236:239]
    ds_read_b128 v[28:31], v9 offset:19456
    s_waitcnt lgkmcnt(4)
    v_mfma_f32_16x16x32_bf16 v[224:227], v[196:199], v[32:35], v[224:227]
    v_mfma_f32_16x16x32_bf16 v[232:235], v[204:207], v[32:35], v[232:235]
    ds_read_b128 v[32:35], v9 offset:39936
    s_waitcnt lgkmcnt(4)
    v_mfma_f32_16x16x32_bf16 v[228:231], v[196:199], v[16:19], v[228:231]
    v_mfma_f32_16x16x32_bf16 v[236:239], v[204:207], v[16:19], v[236:239]
    s_waitcnt lgkmcnt(3)
    v_mfma_f32_16x16x32_bf16 v[224:227], v[208:211], v[20:23], v[224:227]
    v_mfma_f32_16x16x32_bf16 v[232:235], v[216:219], v[20:23], v[232:235]
    s_waitcnt lgkmcnt(2)
    v_mfma_f32_16x16x32_bf16 v[228:231], v[208:211], v[24:27], v[228:231]
    v_mfma_f32_16x16x32_bf16 v[236:239], v[216:219], v[24:27], v[236:239]
    s_waitcnt lgkmcnt(1)
    v_mfma_f32_16x16x32_bf16 v[224:227], v[212:215], v[28:31], v[224:227]
    v_mfma_f32_16x16x32_bf16 v[232:235], v[220:223], v[28:31], v[232:235]
    s_waitcnt lgkmcnt(0)
    v_mfma_f32_16x16x32_bf16 v[228:231], v[212:215], v[32:35], v[228:231]
    v_mfma_f32_16x16x32_bf16 v[236:239], v[220:223], v[32:35], v[236:239]
    s_nop 3
    v_cvt_pk_bf16_f32 v224, v224, v225
    v_cvt_pk_bf16_f32 v225, v226, v227
    ds_write_b64 v7, v[224:225] offset:0
    v_cvt_pk_bf16_f32 v228, v228, v229
    v_cvt_pk_bf16_f32 v229, v230, v231
    ds_write_b64 v7, v[228:229] offset:2048
    v_cvt_pk_bf16_f32 v232, v232, v233
    v_cvt_pk_bf16_f32 v233, v234, v235
    ds_write_b64 v7, v[232:233] offset:4096
    v_cvt_pk_bf16_f32 v236, v236, v237
    v_cvt_pk_bf16_f32 v237, v238, v239
    ds_write_b64 v7, v[236:237] offset:6144
    s_cmp_lg_u32 s29, 0
    s_cbranch_scc1 SG_LOOP_S
    s_barrier
    v_mov_b32 v63, 163832
    ds_read_b32 v62, v63
    s_waitcnt lgkmcnt(0)
    v_readfirstlane_b32 s3, v62
    s_cmp_lg_u32 s3, 1
    s_cbranch_scc1 REROLE
    s_branch SG_LOOP_S
SG_END_S:
    s_waitcnt vmcnt(0)
    s_waitcnt vmcnt(0)
    s_branch END
VG_S:
    v_bfe_u32 v6, v0, 3, 1
    v_lshlrev_b32 v6, 8, v6
    v_bfe_u32 v7, v0, 2, 1
    v_lshl_add_u32 v6, v7, 7, v6
    v_lshrrev_b32 v7, 5, v0
    v_lshl_add_u32 v6, v7, 6, v6
    v_and_b32 v7, 1, v0
    v_lshl_add_u32 v6, v7, 5, v6
    v_bfe_u32 v7, v0, 1, 1
    v_lshl_add_u32 v6, v7, 4, v6
    v_bfe_u32 v7, v0, 4, 1
    v_lshl_add_u32 v6, v7, 3, v6
    s_lshl_b32 s3, s26, 9
    s_add_u32 s3, s3, 92160
    v_add_u32 v6, s3, v6
    v_bfe_u32 v7, v0, 4, 1
    v_lshlrev_b32 v7, 8, v7
    v_and_b32 v8, 15, v0
    v_lshl_add_u32 v7, v8, 3, v7
    v_add_u32 v7, s3, v7
    s_sub_u32 s4, s28, 12
    s_lshl_b32 s4, s4, 2
    s_add_u32 s4, s4, s26
    s_lshl_b32 s3, s4, 9
    v_add_u32 v10, s3, v2
    v_mov_b32 v8, 2147483392
    v_cmp_gt_u32 vcc, 32, v0
    s_nop 1
    v_cndmask_b32 v10, v8, v10, vcc
    s_lshl_b32 s3, s4, 11
    v_add_u32 v8, s3, v2
    s_lshl_b32 s3, s4, 2
    v_mov_b32 v15, 2147483392
    s_nop 0
    v_writelane_b32 v15, s3, 0
    v_mov_b32 v240, -1
    v_mov_b32 v241, -1
    v_mov_b32 v242, -1
    v_mov_b32 v243, -1
    s_mov_b32 s29, -1
    s_mov_b32 s37, 0
    s_branch VG_TOK_S
VG_LOOP_S:
    v_mov_b32 v56, 0
    v_mov_b32 v57, 0
    v_mov_b32 v58, 0
    v_mov_b32 v59, 0
    v_mov_b32 v60, 0
    v_mov_b32 v61, 0
    v_mov_b32 v62, 0
    v_mov_b32 v63, 0
    s_and_b32 s34, s29, 3
    s_mul_i32 s34, s34, 12288
    s_add_u32 s34, s34, 40960
    s_add_u32 s34, s34, s32
    s_add_u32 s35, s29, 3
    s_and_b32 s35, s35, 3
    s_mul_i32 s35, s35, 12288
    s_add_u32 s35, s35, 40960
    s_add_u32 s35, s35, s32
    s_barrier
    ds_read_b128 v[16:19], v11 offset:0
    ds_read_b128 v[20:23], v11 offset:1024
    ds_read_b128 v[24:27], v11 offset:2048
    ds_read_b128 v[28:31], v11 offset:3072
    ds_read_b128 v[32:35], v11 offset:4096
    ds_read_b128 v[36:39], v11 offset:5120
    ds_read_b128 v[40:43], v11 offset:6144
    ds_read_b128 v[44:47], v11 offset:7168
    ds_read_b128 v[48:51], v11 offset:8192
    ds_read_b128 v[52:55], v11 offset:9216
    s_waitcnt lgkmcnt(9)
    v_smfmac_f32_16x16x64_bf16 v[56:59], v[16:19], v[64:71], v5
    v_smfmac_f32_16x16x64_bf16 v[60:63], v[16:19], v[72:79], v5
    s_waitcnt lgkmcnt(8)
    v_smfmac_f32_16x16x64_bf16 v[56:59], v[20:23], v[80:87], v5
    v_smfmac_f32_16x16x64_bf16 v[60:63], v[20:23], v[88:95], v5
    s_waitcnt lgkmcnt(7)
    v_smfmac_f32_16x16x64_bf16 v[56:59], v[24:27], v[96:103], v5
    v_smfmac_f32_16x16x64_bf16 v[60:63], v[24:27], v[104:111], v5
    s_waitcnt lgkmcnt(6)
    v_smfmac_f32_16x16x64_bf16 v[56:59], v[28:31], v[112:119], v5
    v_smfmac_f32_16x16x64_bf16 v[60:63], v[28:31], v[120:127], v5
    s_waitcnt lgkmcnt(5)
    v_smfmac_f32_16x16x64_bf16 v[56:59], v[32:35], v[128:135], v5
    v_smfmac_f32_16x16x64_bf16 v[60:63], v[32:35], v[136:143], v5
    s_waitcnt lgkmcnt(4)
    v_smfmac_f32_16x16x64_bf16 v[56:59], v[36:39], v[144:151], v5
    v_smfmac_f32_16x16x64_bf16 v[60:63], v[36:39], v[152:159], v5
    s_waitcnt lgkmcnt(3)
    v_smfmac_f32_16x16x64_bf16 v[56:59], v[40:43], v[160:167], v5
    v_smfmac_f32_16x16x64_bf16 v[60:63], v[40:43], v[168:175], v5
    s_waitcnt lgkmcnt(2)
    v_smfmac_f32_16x16x64_bf16 v[56:59], v[44:47], v[176:183], v5
    v_smfmac_f32_16x16x64_bf16 v[60:63], v[44:47], v[184:191], v5
    s_waitcnt lgkmcnt(1)
    v_smfmac_f32_16x16x64_bf16 v[56:59], v[48:51], v[192:199], v5
    v_smfmac_f32_16x16x64_bf16 v[60:63], v[48:51], v[200:207], v5
    s_waitcnt lgkmcnt(0)
    v_smfmac_f32_16x16x64_bf16 v[56:59], v[52:55], v[208:215], v5
    v_smfmac_f32_16x16x64_bf16 v[60:63], v[52:55], v[216:223], v5
    s_nop 7
    v_permlane32_swap_b32 v56, v60
    v_permlane32_swap_b32 v57, v61
    v_permlane32_swap_b32 v58, v62
    v_permlane32_swap_b32 v59, v63
    v_pk_add_f32 v[56:57], v[56:57], v[60:61]
    v_pk_add_f32 v[58:59], v[58:59], v[62:63]
    v_cvt_pk_bf16_f32 v56, v56, v57
    v_cvt_pk_bf16_f32 v57, v58, v59
    ds_write_b64 v6, v[56:57]
    ds_read_b64_tr_b16 v[56:57], v7
    ds_read_b64_tr_b16 v[58:59], v7 offset:128
    s_waitcnt lgkmcnt(1)
    v_min_u32 v56, -2, v56
    v_min_u32 v57, -2, v57
    s_waitcnt lgkmcnt(0)
    v_min_u32 v58, -2, v58
    v_min_u32 v59, -2, v59
    buffer_store_dwordx4 v[56:59], v10, s[8:11], s34 offen sc1
    buffer_store_dwordx4 v[240:243], v10, s[8:11], s35 offen sc1
    s_barrier
    s_cmp_lt_u32 s29, 61
    s_cbranch_scc1 VG_TOK_S
    s_cmp_eq_u32 s29, 63
    s_cbranch_scc1 VG_END_S
    s_add_u32 s29, s29, 1
    s_waitcnt vmcnt(0)
    s_branch VG_LOOP_S
VG_TOK_S:
    s_and_b32 s3, s37, 1
    s_mul_i32 s3, s3, 40960
    v_add_u32 v9, s3, v2
    s_and_b32 s36, s37, 3
    s_mul_i32 s36, s36, 49152
    s_add_u32 s36, s36, 163840
    s_add_u32 s36, s36, s32
    s_add_u32 s37, s37, 1
    v_mov_b32 v14, s37
    ds_read_b128 v[16:19], v9 offset:0
    ds_read_b128 v[20:23], v9 offset:20480
    ds_read_b128 v[24:27], v9 offset:1024
    ds_read_b128 v[28:31], v9 offset:21504
    ds_read_b128 v[32:35], v9 offset:2048
    s_waitcnt lgkmcnt(4)
    v_mfma_f32_16x16x32_bf16 v[224:227], v[64:67], v[16:19], 0
    v_mfma_f32_16x16x32_bf16 v[232:235], v[72:75], v[16:19], 0
    ds_read_b128 v[16:19], v9 offset:22528
    s_waitcnt lgkmcnt(4)
    v_mfma_f32_16x16x32_bf16 v[228:231], v[64:67], v[20:23], 0
    v_mfma_f32_16x16x32_bf16 v[236:239], v[72:75], v[20:23], 0
    ds_read_b128 v[20:23], v9 offset:3072
    s_waitcnt lgkmcnt(4)
    v_mfma_f32_16x16x32_bf16 v[224:227], v[68:71], v[24:27], v[224:227]
    v_mfma_f32_16x16x32_bf16 v[232:235], v[76:79], v[24:27], v[232:235]
    ds_read_b128 v[24:27], v9 offset:23552
    s_waitcnt lgkmcnt(4)
    v_mfma_f32_16x16x32_bf16 v[228:231], v[68:71], v[28:31], v[228:231]
    v_mfma_f32_16x16x32_bf16 v[236:239], v[76:79], v[28:31], v[236:239]
    ds_read_b128 v[28:31], v9 offset:4096
    s_waitcnt lgkmcnt(4)
    v_mfma_f32_16x16x32_bf16 v[224:227], v[80:83], v[32:35], v[224:227]
    v_mfma_f32_16x16x32_bf16 v[232:235], v[88:91], v[32:35], v[232:235]
    ds_read_b128 v[32:35], v9 offset:24576
    s_waitcnt lgkmcnt(4)
    v_mfma_f32_16x16x32_bf16 v[228:231], v[80:83], v[16:19], v[228:231]
    v_mfma_f32_16x16x32_bf16 v[236:239], v[88:91], v[16:19], v[236:239]
    ds_read_b128 v[16:19], v9 offset:5120
    s_waitcnt lgkmcnt(4)
    v_mfma_f32_16x16x32_bf16 v[224:227], v[84:87], v[20:23], v[224:227]
    v_mfma_f32_16x16x32_bf16 v[232:235], v[92:95], v[20:23], v[232:235]
    ds_read_b128 v[20:23], v9 offset:25600
    s_waitcnt lgkmcnt(4)
    v_mfma_f32_16x16x32_bf16 v[228:231], v[84:87], v[24:27], v[228:231]
    v_mfma_f32_16x16x32_bf16 v[236:239], v[92:95], v[24:27], v[236:239]
    ds_read_b128 v[24:27], v9 offset:6144
    s_waitcnt lgkmcnt(4)
    v_mfma_f32_16x16x32_bf16 v[224:227], v[96:99], v[28:31], v[224:227]
    v_mfma_f32_16x16x32_bf16 v[232:235], v[104:107], v[28:31], v[232:235]
    ds_read_b128 v[28:31], v9 offset:26624
    s_waitcnt lgkmcnt(4)
    v_mfma_f32_16x16x32_bf16 v[228:231], v[96:99], v[32:35], v[228:231]
    v_mfma_f32_16x16x32_bf16 v[236:239], v[104:107], v[32:35], v[236:239]
    ds_read_b128 v[32:35], v9 offset:7168
    s_waitcnt lgkmcnt(4)
    v_mfma_f32_16x16x32_bf16 v[224:227], v[100:103], v[16:19], v[224:227]
    v_mfma_f32_16x16x32_bf16 v[232:235], v[108:111], v[16:19], v[232:235]
    ds_read_b128 v[16:19], v9 offset:27648
    s_waitcnt lgkmcnt(4)
    v_mfma_f32_16x16x32_bf16 v[228:231], v[100:103], v[20:23], v[228:231]
    v_mfma_f32_16x16x32_bf16 v[236:239], v[108:111], v[20:23], v[236:239]
    ds_read_b128 v[20:23], v9 offset:8192
    s_waitcnt lgkmcnt(4)
    v_mfma_f32_16x16x32_bf16 v[224:227], v[112:115], v[24:27], v[224:227]
    v_mfma_f32_16x16x32_bf16 v[232:235], v[120:123], v[24:27], v[232:235]
    ds_read_b128 v[24:27], v9 offset:28672
    s_waitcnt lgkmcnt(4)
    v_mfma_f32_16x16x32_bf16 v[228:231], v[112:115], v[28:31], v[228:231]
    v_mfma_f32_16x16x32_bf16 v[236:239], v[120:123], v[28:31], v[236:239]
    ds_read_b128 v[28:31], v9 offset:9216
    s_waitcnt lgkmcnt(4)
    v_mfma_f32_16x16x32_bf16 v[224:227], v[116:119], v[32:35], v[224:227]
    v_mfma_f32_16x16x32_bf16 v[232:235], v[124:127], v[32:35], v[232:235]
    ds_read_b128 v[32:35], v9 offset:29696
    s_waitcnt lgkmcnt(4)
    v_mfma_f32_16x16x32_bf16 v[228:231], v[116:119], v[16:19], v[228:231]
    v_mfma_f32_16x16x32_bf16 v[236:239], v[124:127], v[16:19], v[236:239]
    ds_read_b128 v[16:19], v9 offset:10240
    s_waitcnt lgkmcnt(4)
    v_mfma_f32_16x16x32_bf16 v[224:227], v[128:131], v[20:23], v[224:227]
    v_mfma_f32_16x16x32_bf16 v[232:235], v[136:139], v[20:23], v[232:235]
    ds_read_b128 v[20:23], v9 offset:30720
    s_waitcnt lgkmcnt(4)
    v_mfma_f32_16x16x32_bf16 v[228:231], v[128:131], v[24:27], v[228:231]
    v_mfma_f32_16x16x32_bf16 v[236:239], v[136:139], v[24:27], v[236:239]
    ds_read_b128 v[24:27], v9 offset:11264
    s_waitcnt lgkmcnt(4)
    v_mfma_f32_16x16x32_bf16 v[224:227], v[132:135], v[28:31], v[224:227]
    v_mfma_f32_16x16x32_bf16 v[232:235], v[140:143], v[28:31], v[232:235]
    ds_read_b128 v[28:31], v9 offset:31744
    s_waitcnt lgkmcnt(4)
    v_mfma_f32_16x16x32_bf16 v[228:231], v[132:135], v[32:35], v[228:231]
    v_mfma_f32_16x16x32_bf16 v[236:239], v[140:143], v[32:35], v[236:239]
    ds_read_b128 v[32:35], v9 offset:12288
    s_waitcnt lgkmcnt(4)
    v_mfma_f32_16x16x32_bf16 v[224:227], v[144:147], v[16:19], v[224:227]
    v_mfma_f32_16x16x32_bf16 v[232:235], v[152:155], v[16:19], v[232:235]
    ds_read_b128 v[16:19], v9 offset:32768
    s_waitcnt lgkmcnt(4)
    v_mfma_f32_16x16x32_bf16 v[228:231], v[144:147], v[20:23], v[228:231]
    v_mfma_f32_16x16x32_bf16 v[236:239], v[152:155], v[20:23], v[236:239]
    ds_read_b128 v[20:23], v9 offset:13312
    s_waitcnt lgkmcnt(4)
    v_mfma_f32_16x16x32_bf16 v[224:227], v[148:151], v[24:27], v[224:227]
    v_mfma_f32_16x16x32_bf16 v[232:235], v[156:159], v[24:27], v[232:235]
    ds_read_b128 v[24:27], v9 offset:33792
    s_waitcnt lgkmcnt(4)
    v_mfma_f32_16x16x32_bf16 v[228:231], v[148:151], v[28:31], v[228:231]
    v_mfma_f32_16x16x32_bf16 v[236:239], v[156:159], v[28:31], v[236:239]
    ds_read_b128 v[28:31], v9 offset:14336
    s_waitcnt lgkmcnt(4)
    v_mfma_f32_16x16x32_bf16 v[224:227], v[160:163], v[32:35], v[224:227]
    v_mfma_f32_16x16x32_bf16 v[232:235], v[168:171], v[32:35], v[232:235]
    ds_read_b128 v[32:35], v9 offset:34816
    s_waitcnt lgkmcnt(4)
    v_mfma_f32_16x16x32_bf16 v[228:231], v[160:163], v[16:19], v[228:231]
    v_mfma_f32_16x16x32_bf16 v[236:239], v[168:171], v[16:19], v[236:239]
    ds_read_b128 v[16:19], v9 offset:15360
    s_waitcnt lgkmcnt(4)
    v_mfma_f32_16x16x32_bf16 v[224:227], v[164:167], v[20:23], v[224:227]
    v_mfma_f32_16x16x32_bf16 v[232:235], v[172:175], v[20:23], v[232:235]
    ds_read_b128 v[20:23], v9 offset:35840
    s_waitcnt lgkmcnt(4)
    v_mfma_f32_16x16x32_bf16 v[228:231], v[164:167], v[24:27], v[228:231]
    v_mfma_f32_16x16x32_bf16 v[236:239], v[172:175], v[24:27], v[236:239]
    ds_read_b128 v[24:27], v9 offset:16384
    s_waitcnt lgkmcnt(4)
    v_mfma_f32_16x16x32_bf16 v[224:227], v[176:179], v[28:31], v[224:227]
    v_mfma_f32_16x16x32_bf16 v[232:235], v[184:187], v[28:31], v[232:235]
    ds_read_b128 v[28:31], v9 offset:36864
    s_waitcnt lgkmcnt(4)
    v_mfma_f32_16x16x32_bf16 v[228:231], v[176:179], v[32:35], v[228:231]
    v_mfma_f32_16x16x32_bf16 v[236:239], v[184:187], v[32:35], v[236:239]
    ds_read_b128 v[32:35], v9 offset:17408
    s_waitcnt lgkmcnt(4)
    v_mfma_f32_16x16x32_bf16 v[224:227], v[180:183], v[16:19], v[224:227]
    v_mfma_f32_16x16x32_bf16 v[232:235], v[188:191], v[16:19], v[232:235]
    ds_read_b128 v[16:19], v9 offset:37888
    s_waitcnt lgkmcnt(4)
    v_mfma_f32_16x16x32_bf16 v[228:231], v[180:183], v[20:23], v[228:231]
    v_mfma_f32_16x16x32_bf16 v[236:239], v[188:191], v[20:23], v[236:239]
    ds_read_b128 v[20:23], v9 offset:18432
    s_waitcnt lgkmcnt(4)
    v_mfma_f32_16x16x32_bf16 v[224:227], v[192:195], v[24:27], v[224:227]
    v_mfma_f32_16x16x32_bf16 v[232:235], v[200:203], v[24:27], v[232:235]
    ds_read_b128 v[24:27], v9 offset:38912
    s_waitcnt lgkmcnt(4)
    v_mfma_f32_16x16x32_bf16 v[228:231], v[192:195], v[28:31], v[228:231]
    v_mfma_f32_16x16x32_bf16 v[236:239], v[200:203], v[28:31], v[236:239]
    ds_read_b128 v[28:31], v9 offset:19456
    s_waitcnt lgkmcnt(4)
    v_mfma_f32_16x16x32_bf16 v[224:227], v[196:199], v[32:35], v[224:227]
    v_mfma_f32_16x16x32_bf16 v[232:235], v[204:207], v[32:35], v[232:235]
    ds_read_b128 v[32:35], v9 offset:39936
    s_waitcnt lgkmcnt(4)
    v_mfma_f32_16x16x32_bf16 v[228:231], v[196:199], v[16:19], v[228:231]
    v_mfma_f32_16x16x32_bf16 v[236:239], v[204:207], v[16:19], v[236:239]
    s_waitcnt lgkmcnt(3)
    v_mfma_f32_16x16x32_bf16 v[224:227], v[208:211], v[20:23], v[224:227]
    v_mfma_f32_16x16x32_bf16 v[232:235], v[216:219], v[20:23], v[232:235]
    s_waitcnt lgkmcnt(2)
    v_mfma_f32_16x16x32_bf16 v[228:231], v[208:211], v[24:27], v[228:231]
    v_mfma_f32_16x16x32_bf16 v[236:239], v[216:219], v[24:27], v[236:239]
    s_waitcnt lgkmcnt(1)
    v_mfma_f32_16x16x32_bf16 v[224:227], v[212:215], v[28:31], v[224:227]
    v_mfma_f32_16x16x32_bf16 v[232:235], v[220:223], v[28:31], v[232:235]
    s_waitcnt lgkmcnt(0)
    v_mfma_f32_16x16x32_bf16 v[228:231], v[212:215], v[32:35], v[228:231]
    v_mfma_f32_16x16x32_bf16 v[236:239], v[220:223], v[32:35], v[236:239]
    s_cmp_lg_u32 s37, 1
    s_cbranch_scc1 VG_ST_S
    s_barrier
    v_mov_b32 v63, 163832
    ds_read_b32 v62, v63
    s_waitcnt lgkmcnt(0)
    v_readfirstlane_b32 s3, v62
    s_cmp_lg_u32 s3, 1
    s_cbranch_scc1 REROLE
VG_ST_S:
    s_nop 1
    v_cvt_pk_bf16_f32 v16, v224, v225
    v_cvt_pk_bf16_f32 v17, v226, v227
    v_cvt_pk_bf16_f32 v18, v232, v233
    v_cvt_pk_bf16_f32 v19, v234, v235
    buffer_store_dwordx4 v[16:19], v8, s[8:11], s36 offen offset:0 sc1
    v_cvt_pk_bf16_f32 v20, v228, v229
    v_cvt_pk_bf16_f32 v21, v230, v231
    v_cvt_pk_bf16_f32 v22, v236, v237
    v_cvt_pk_bf16_f32 v23, v238, v239
    buffer_store_dwordx4 v[20:23], v8, s[8:11], s36 offen offset:1024 sc1
    s_waitcnt vmcnt(0)
    buffer_store_dword v14, v15, s[8:11], s33 offen sc1
    s_lshl_b32 s3, s29, 1
    s_add_u32 s3, s3, 2
    s_add_u32 s4, s29, 3
    s_min_i32 s3, s3, s4
    s_cmp_le_i32 s37, s3
    s_cbranch_scc1 VG_2_S
    s_add_u32 s29, s29, 1
    s_branch VG_LOOP_S
VG_2_S:
    s_barrier
    s_branch VG_TOK_S
VG_END_S:
    s_waitcnt vmcnt(0)
    s_waitcnt vmcnt(0)
    s_branch END
PAUX_S:
    s_setprio 2
    s_sub_u32 s14, s26, 4
    s_lshl_b32 s3, s14, 10
    v_add_u32 v4, s3, v2
    v_add_u32 v12, 81920, v4
    s_cmp_lt_u32 s14, 2
    s_cselect_b64 vcc, -1, 0
    v_mov_b32 v8, 2147483392
    v_cndmask_b32 v8, v8, v4, vcc
    v_add_u32 v13, 102400, v2
    v_add_u32 v5, 8192, v12
    v_cndmask_b32 v13, v13, v5, vcc
    ds_write_b128 v12, v[200:203]
    ds_write_b128 v12, v[204:207] offset:4096
    ds_write_b128 v13, v[208:211]
    s_lshl_b32 s40, s28, 2
    s_add_u32 s40, s40, s14
    s_cmp_lt_u32 s28, 10
    s_cselect_b32 s40, s40, -1
    s_lshr_b32 s3, s28, 1
    s_lshr_b32 s4, s40, 2
    s_cmp_lt_i32 s40, 0
    s_cselect_b32 s3, s3, s4
    s_lshl_b32 s3, s3, 7
    s_add_u32 s3, s3, 2048
    v_mov_b32 v140, s3
    s_max_i32 s5, s40, 0
    s_lshr_b32 s3, s5, 2
    s_lshl_b32 s3, s3, 15
    s_and_b32 s4, s5, 3
    s_lshl_b32 s4, s4, 9
    s_add_u32 s3, s3, s4
    v_and_b32 v142, 31, v0
    v_lshlrev_b32 v141, 4, v142
    v_lshrrev_b32 v143, 5, v0
    v_lshl_add_u32 v141, v143, 11, v141
    v_add_u32 v141, s3, v141
    s_lshl_b32 s3, s5, 8
    v_lshlrev_b32 v142, 3, v142
    v_lshl_add_u32 v142, v143, 2, v142
    v_add_u32 v142, s3, v142
    v_mov_b32 v143, -1
    s_lshr_b32 s41, s27, 2
    s_lshl_b32 s41, s41, 14
    s_cmp_ge_u32 s28, 12
    s_cbranch_scc1 VA_S
    s_cmp_eq_u32 s14, 3
    s_cselect_b32 s3, 0, 4096
    s_cmp_eq_u32 s14, 1
    s_cselect_b32 s4, 2048, 0
    s_add_u32 s3, s3, s4
    s_add_u32 s3, s3, 94208
    v_add_u32 v14, s3, v2
    s_cmp_eq_u32 s14, 0
    s_cselect_b32 s3, 0, 2048
    s_add_u32 s3, s3, 94208
    v_add_u32 v15, s3, v2
    v_add_u32 v7, 92160, v3
    v_and_b32 v6, 7, v0
    v_lshrrev_b32 v9, 4, v0
    v_lshl_add_u32 v11, v6, 2, v9
    v_lshlrev_b32 v11, 4, v11
    s_lshl_b32 s3, s14, 9
    v_add_u32 v11, s3, v11
    v_lshl_add_u32 v9, v9, 3, v6
    v_lshlrev_b32 v9, 4, v9
    v_add_u32 v9, 768, v9
    s_cmp_eq_u32 s14, 2
    s_cselect_b64 vcc, -1, 0
    v_cndmask_b32 v11, v11, v9, vcc
    s_mul_i32 s3, s28, 1280
    v_add_u32 v11, s3, v11
    s_mov_b32 s5, 0x00ff00ff
    s_cselect_b32 s4, 0, s5
    s_mov_b64 vcc, s[4:5]
    v_mov_b32 v9, 2147483392
    v_cndmask_b32 v11, v9, v11, vcc
    s_lshl_b32 s3, s28, 2
    s_add_u32 s3, s3, s14
    s_lshl_b32 s4, s3, 10
    v_add_u32 v10, s4, v2
    s_lshl_b32 s3, s3, 2
    s_add_u32 s3, s3, 128
    v_mov_b32 v6, 2147483392
    s_nop 0
    v_writelane_b32 v6, s3, 0
    s_mov_b32 s29, 0
    s_cmp_lg_u32 s26, 7
    s_cbranch_scc1 VW_40
    v_mov_b32 v62, 1
    s_cmp_lg_u32 s31, 0
    s_cbranch_scc1 VK_42
    v_mov_b32 v62, 2
    s_cmp_ge_u32 s88, 32
    s_cbranch_scc1 VK_42x
    v_mov_b32 v63, 16
VG_41:
    global_load_dword v62, v63, s[84:85] offset:128 sc1
    s_waitcnt vmcnt(0)
    v_cmp_ne_u32 vcc, 0, v62
    s_cbranch_vccnz VK_42
    s_sleep 8
    s_sub_u32 s30, s30, 1
    s_cbranch_scc0 VG_41
    s_branch END
VK_42x:
    v_mov_b32 v63, 16
VG_41x:
    global_load_dword v61, v63, s[84:85] offset:128 sc1
    s_waitcnt vmcnt(0)
    v_cmp_ne_u32 vcc, 0, v61
    s_cbranch_vccnz VK_42
    s_sleep 8
    s_sub_u32 s30, s30, 1
    s_cbranch_scc0 VG_41x
    s_branch END
VK_42:
    v_mov_b32 v63, 163832
    ds_write_b32 v63, v62
    s_waitcnt lgkmcnt(0)
VW_40:
    s_barrier
    v_mov_b32 v63, 163832
    ds_read_b32 v62, v63
    s_waitcnt lgkmcnt(0)
    v_readfirstlane_b32 s3, v62
    s_cmp_lg_u32 s3, 1
    s_cbranch_scc1 REROLE
    s_branch SA_GOT_S
SA_LOOP_S:
    s_add_u32 s36, s29, 3
    s_and_b32 s36, s36, 3
    s_mul_i32 s36, s36, 327680
    s_add_u32 s36, s36, 8388608
    s_and_b32 s37, s29, 3
    s_mul_i32 s37, s37, 10240
    s_add_u32 s37, s37, s32
    s_add_u32 s35, s29, 3
    s_and_b32 s35, s35, 3
    s_mul_i32 s35, s35, 10240
    s_add_u32 s35, s35, s32
    s_sub_u32 s3, s29, 1
    s_lshr_b32 s25, s3, 2
    s_and_b32 s25, s25, 1
    s_add_u32 s25, s25, 1
    s_xor_b32 s3, s41, 16384
    s_add_u32 s16, s36, s41
    s_add_u32 s17, s16, 4096
    s_add_u32 s18, s36, s3
    s_add_u32 s19, s18, 4096
    s_lshl_b32 s43, s29, 1
    buffer_load_dword v144, v140, s[8:11], s33 offen sc1
    s_nop 15
    buffer_load_dword v145, v140, s[8:11], s33 offen sc1
    s_nop 15
H3F_45:
    buffer_load_dword v146, v140, s[8:11], s33 offen sc1
    s_waitcnt vmcnt(2)
    v_cmp_gt_u32 vcc, s43, v144
    s_cbranch_vccz H3G_46
    buffer_load_dword v144, v140, s[8:11], s33 offen sc1
    s_waitcnt vmcnt(2)
    v_cmp_gt_u32 vcc, s43, v145
    s_cbranch_vccz H3G_46
    buffer_load_dword v145, v140, s[8:11], s33 offen sc1
    s_waitcnt vmcnt(2)
    v_cmp_gt_u32 vcc, s43, v146
    s_cbranch_vccz H3G_46
    s_sub_u32 s30, s30, 1
    s_cbranch_scc0 H3F_45
    s_branch END
H3G_46:
    s_cmp_lt_i32 s40, 0
    s_cbranch_scc1 H3N_43
    s_cmp_lg_u32 s29, 1
    s_cbranch_scc1 H3G_46_c
    s_waitcnt vmcnt(0)
    v_max3_u32 v147, v144, v145, v146
    v_and_b32 v147, 1, v147
    v_lshl_add_u32 v141, v147, 13, v141
H3G_46_c:
    s_nop 15
    s_nop 15
    s_nop 15
    s_nop 15
    s_nop 3
H3P_47:
    s_sub_u32 s30, s30, 1
    s_cbranch_scc1 END
    buffer_load_dwordx4 v[148:151], v141, s[8:11], s16 offen sc1
    buffer_load_dwordx4 v[152:155], v141, s[8:11], s17 offen sc1
    buffer_load_dwordx4 v[156:159], v141, s[8:11], s18 offen sc1
    buffer_load_dwordx4 v[160:163], v141, s[8:11], s19 offen sc1
    s_waitcnt vmcnt(3)
    v_bitop3_b32 v52, s25, v148, v149 bitop3:0x80
    v_bitop3_b32 v52, v52, v150, v151 bitop3:0x80
    s_waitcnt vmcnt(2)
    v_pk_add_f32 v[164:165], v[148:149], v[152:153]
    v_pk_add_f32 v[166:167], v[150:151], v[154:155]
    v_bitop3_b32 v52, v52, v152, v153 bitop3:0x80
    v_bitop3_b32 v52, v52, v154, v155 bitop3:0x80
    s_waitcnt vmcnt(1)
    v_pk_add_f32 v[164:165], v[164:165], v[156:157]
    v_pk_add_f32 v[166:167], v[166:167], v[158:159]
    v_bitop3_b32 v52, v52, v156, v157 bitop3:0x80
    v_bitop3_b32 v52, v52, v158, v159 bitop3:0x80
    s_waitcnt vmcnt(0)
    v_pk_add_f32 v[164:165], v[164:165], v[160:161]
    v_pk_add_f32 v[166:167], v[166:167], v[162:163]
    v_bitop3_b32 v52, v52, v160, v161 bitop3:0x80
    v_bitop3_b32 v52, v52, v162, v163 bitop3:0x80
    v_permlane32_swap_b32 v164, v166
    v_permlane32_swap_b32 v165, v167
    v_cmp_eq_u32 vcc, 0, v52
    v_pk_add_f32 v[164:165], v[164:165], v[166:167]
    v_cvt_pk_bf16_f32 v166, v164, v165
    v_min_u32 v166, -2, v166
    s_cbranch_vccnz H3P_47
H3K_48:
    buffer_store_dword v166, v142, s[8:11], s37 offen sc1
    buffer_store_dword v143, v142, s[8:11], s35 offen sc1
    s_branch H3D_44
H3N_43:
    s_sleep 10
H3D_44:
    s_and_b32 s34, s29, 3
    s_mul_i32 s34, s34, 10240
    s_add_u32 s34, s34, s32
    s_add_u32 s35, s34, 4096
    s_add_u32 s36, s34, 8192
H1P_49:
    buffer_load_dwordx4 v[116:119], v4, s[8:11], s34 offen sc1
    buffer_load_dwordx4 v[120:123], v4, s[8:11], s35 offen sc1
    buffer_load_dwordx4 v[124:127], v8, s[8:11], s36 offen sc1
    s_waitcnt vmcnt(2)
    ds_write_b128 v12, v[116:119]
    v_max3_u32 v52, v116, v117, v118
    s_waitcnt vmcnt(1)
    ds_write_b128 v12, v[120:123] offset:4096
    v_max3_u32 v52, v119, v120, v52
    v_max3_u32 v52, v121, v122, v52
    s_waitcnt vmcnt(0)
    ds_write_b128 v13, v[124:127]
    v_max3_u32 v52, v123, v124, v52
    v_max3_u32 v52, v125, v126, v52
    v_max_u32 v52, v127, v52
    v_cmp_eq_u32 vcc, -1, v52
    s_cbranch_vccz SA_GOT_S
    s_waitcnt lgkmcnt(0)
    s_sub_u32 s30, s30, 1
    s_cbranch_scc0 H1P_49
    s_branch END
SA_GOT_S:
    s_waitcnt lgkmcnt(0)
    s_barrier
    ds_read_b128 v[24:27], v14
    ds_read_b128 v[28:31], v14 offset:1024
    ds_read_b128 v[32:35], v15
    ds_read_b128 v[36:39], v15 offset:1024
    s_and_b32 s35, s29, 3
    s_mul_i32 s35, s35, 15360
    s_add_u32 s35, s35, 90112
    s_add_u32 s35, s35, s32
    s_and_b32 s36, s29, 3
    s_mul_i32 s36, s36, 49152
    s_add_u32 s36, s36, 360448
    s_add_u32 s36, s36, s32
    s_lshr_b32 s37, s29, 2
    s_and_b32 s37, s37, 1
    s_add_u32 s37, s37, 1
    s_add_u32 s3, s29, 1
    v_mov_b32 v9, s3
    s_waitcnt lgkmcnt(0)
    s_cmp_eq_u32 s14, 2
    s_cbranch_scc1 SA_2_S
    s_cmp_eq_u32 s14, 3
    s_cbranch_scc1 SA_3_S
    s_barrier
    ds_read_b64_tr_b16 v[40:41], v7 offset:0
    ds_read_b64_tr_b16 v[42:43], v7 offset:512
    ds_read_b64_tr_b16 v[44:45], v7 offset:1024
    ds_read_b64_tr_b16 v[46:47], v7 offset:1536
    s_waitcnt lgkmcnt(2)
    v_mfma_f32_16x16x32_bf16 v[48:51], v[24:27], v[40:43], 0
    s_waitcnt lgkmcnt(0)
    v_mfma_f32_16x16x32_bf16 v[48:51], v[28:31], v[44:47], v[48:51]
    s_nop 7
    v_and_or_b32 v48, v48, -4, s37
    v_and_or_b32 v49, v49, -4, s37
    v_and_or_b32 v50, v50, -4, s37
    v_and_or_b32 v51, v51, -4, s37
    buffer_store_dwordx4 v[48:51], v11, s[8:11], s35 offen sc1
    s_branch SA_X_S
SA_2_S:
    s_barrier
    ds_read_b64_tr_b16 v[40:41], v7 offset:0
    ds_read_b64_tr_b16 v[42:43], v7 offset:512
    ds_read_b64_tr_b16 v[44:45], v7 offset:1024
    ds_read_b64_tr_b16 v[46:47], v7 offset:1536
    s_waitcnt lgkmcnt(2)
    v_mfma_f32_16x16x32_bf16 v[48:51], v[40:43], v[40:43], 0
    s_waitcnt lgkmcnt(0)
    v_mfma_f32_16x16x32_bf16 v[48:51], v[44:47], v[44:47], v[48:51]
    s_nop 7
    v_and_or_b32 v48, v48, -4, s37
    v_and_or_b32 v49, v49, -4, s37
    v_and_or_b32 v50, v50, -4, s37
    v_and_or_b32 v51, v51, -4, s37
    buffer_store_dwordx4 v[48:51], v11, s[8:11], s35 offen sc1
SA_X_S:
    v_mfma_f32_16x16x32_bf16 v[56:59], v[24:27], v[32:35], 0
    v_mfma_f32_16x16x32_bf16 v[56:59], v[28:31], v[36:39], v[56:59]
    s_branch SA_F_S
SA_3_S:
    s_barrier
    ds_read_b64_tr_b16 v[40:41], v7 offset:0
    ds_read_b64_tr_b16 v[42:43], v7 offset:512
    ds_read_b64_tr_b16 v[44:45], v7 offset:1024
    ds_read_b64_tr_b16 v[46:47], v7 offset:1536
    s_waitcnt lgkmcnt(0)
    v_mfma_f32_16x16x32_bf16 v[52:55], v[40:43], v[24:27], 0
    v_mfma_f32_16x16x32_bf16 v[56:59], v[40:43], v[32:35], 0
    v_mfma_f32_16x16x32_bf16 v[52:55], v[44:47], v[28:31], v[52:55]
    v_mfma_f32_16x16x32_bf16 v[56:59], v[44:47], v[36:39], v[56:59]
    s_nop 7
    v_permlane32_swap_b32 v52, v56
    v_permlane32_swap_b32 v53, v57
    v_permlane32_swap_b32 v54, v58
    v_permlane32_swap_b32 v55, v59
SA_F_S:
    s_nop 6
    buffer_store_dwordx4 v[56:59], v10, s[8:11], s36 offen sc1
    s_waitcnt vmcnt(0)
    buffer_store_dword v9, v6, s[8:11], s33 offen sc1
    s_cmp_eq_u32 s29, 63
    s_cbranch_scc1 SA_END_S
    s_cmp_eq_u32 s29, 62
    s_cbranch_scc1 SA_N_S
    s_mul_i32 s5, s14, 10240
    s_and_b32 s3, s29, 1
    s_mul_i32 s3, s3, 40960
    s_add_u32 s3, s3, s5
    s_mul_i32 s4, s29, 40960
    s_add_u32 s4, s4, s5
    s_add_u32 s4, s4, 10567680
    s_mov_b32 m0, s3
    s_nop 0
    buffer_load_dwordx4 v2, s[8:11], s4 offen offset:0 sc1 lds
    buffer_load_dwordx4 v2, s[8:11], s4 offen offset:1024 sc1 lds
    buffer_load_dwordx4 v2, s[8:11], s4 offen offset:2048 sc1 lds
    buffer_load_dwordx4 v2, s[8:11], s4 offen offset:3072 sc1 lds
    s_add_u32 s3, s3, 4096
    s_add_u32 s4, s4, 4096
    s_mov_b32 m0, s3
    s_nop 0
    buffer_load_dwordx4 v2, s[8:11], s4 offen offset:0 sc1 lds
    buffer_load_dwordx4 v2, s[8:11], s4 offen offset:1024 sc1 lds
    buffer_load_dwordx4 v2, s[8:11], s4 offen offset:2048 sc1 lds
    buffer_load_dwordx4 v2, s[8:11], s4 offen offset:3072 sc1 lds
    s_add_u32 s3, s3, 4096
    s_add_u32 s4, s4, 4096
    s_mov_b32 m0, s3
    s_nop 0
    buffer_load_dwordx4 v2, s[8:11], s4 offen offset:0 sc1 lds
    buffer_load_dwordx4 v2, s[8:11], s4 offen offset:1024 sc1 lds
SA_N_S:
    s_add_u32 s29, s29, 1
    s_branch SA_LOOP_S
SA_END_S:
    s_waitcnt vmcnt(0)
    s_waitcnt vmcnt(0)
    s_branch END
VA_S:
    s_sub_u32 s15, s28, 12
    s_mul_i32 s3, s15, 12288
    s_lshl_b32 s4, s14, 11
    s_add_u32 s4, s4, s3
    v_add_u32 v14, s4, v2
    s_add_u32 s4, s3, 1024
    v_add_u32 v15, s4, v2
    v_mov_b32 v9, 2147483392
    s_cmp_eq_u32 s14, 1
    s_cselect_b64 vcc, -1, 0
    v_cndmask_b32 v15, v9, v15, vcc
    s_lshl_b32 s4, s14, 9
    s_add_u32 s4, s4, s3
    s_add_u32 s4, s4, 2560
    v_add_u32 v7, s4, v2
    v_cmp_le_u32 vcc, 32, v0
    s_nop 1
    v_cndmask_b32 v7, v9, v7, vcc
    s_mul_i32 s3, s14, 5120
    s_lshl_b32 s4, s15, 10
    s_add_u32 s4, s4, s3
    v_add_u32 v10, s4, v2
    v_and_b32 v6, 15, v0
    v_lshlrev_b32 v11, 4, v6
    v_bfe_u32 v64, v0, 4, 1
    v_lshl_add_u32 v11, v64, 3, v11
    s_lshl_b32 s4, s15, 8
    s_add_u32 s4, s4, s3
    s_add_u32 s4, s4, 4096
    v_add_u32 v11, s4, v11
    v_cndmask_b32 v11, v9, v11, vcc
    v_mov_b32 v65, 0xf149f2ca
    v_mov_b32 v66, 0
    v_cndmask_b32 v108, v65, v66, vcc
    v_cndmask_b32 v109, v65, v66, vcc
    v_cndmask_b32 v110, v65, v66, vcc
    v_cndmask_b32 v111, v65, v66, vcc
    s_lshl_b32 s3, s14, 4
    v_add_u32 v6, s3, v6
    v_lshrrev_b32 v64, 4, v0
    v_lshlrev_b32 v64, 2, v64
    v_sub_u32 v6, v6, v64
    v_cmp_le_i32 vcc, 0, v6
    s_nop 1
    v_cndmask_b32 v100, v65, v66, vcc
    v_cmp_le_i32 vcc, 1, v6
    s_nop 1
    v_cndmask_b32 v101, v65, v66, vcc
    v_cmp_le_i32 vcc, 2, v6
    s_nop 1
    v_cndmask_b32 v102, v65, v66, vcc
    v_cmp_le_i32 vcc, 3, v6
    s_nop 1
    v_cndmask_b32 v103, v65, v66, vcc
    v_cmp_le_i32 vcc, 16, v6
    s_nop 1
    v_cndmask_b32 v104, v65, v66, vcc
    v_cmp_le_i32 vcc, 17, v6
    s_nop 1
    v_cndmask_b32 v105, v65, v66, vcc
    v_cmp_le_i32 vcc, 18, v6
    s_nop 1
    v_cndmask_b32 v106, v65, v66, vcc
    v_cmp_le_i32 vcc, 19, v6
    s_nop 1
    v_cndmask_b32 v107, v65, v66, vcc
    v_min_u32 v6, 11, v0
    v_lshlrev_b32 v6, 2, v6
    s_mul_i32 s3, s15, 48
    s_add_u32 s3, s3, 128
    v_add_u32 v6, s3, v6
    s_lshl_b32 s3, s14, 2
    s_add_u32 s3, s3, s15
    s_lshl_b32 s3, s3, 2
    s_add_u32 s3, s3, 384
    v_mov_b32 v112, 2147483392
    s_nop 0
    v_writelane_b32 v112, s3, 0
    s_mov_b32 s38, 0x3dd53b95
    v_mov_b32 v114, s38
    v_mov_b32 v115, s38
    s_cmp_lt_u32 s15, 4
    s_cselect_b32 s39, 1, 0
    s_cmp_lt_u32 s14, 2
    s_cselect_b32 s39, s39, 0
    s_mov_b32 s29, 0
    s_mov_b32 s42, 2
    s_cmp_lg_u32 s26, 7
    s_cbranch_scc1 VW_50
    v_mov_b32 v62, 1
    s_cmp_lg_u32 s31, 0
    s_cbranch_scc1 VK_52
    v_mov_b32 v62, 2
    s_cmp_ge_u32 s88, 32
    s_cbranch_scc1 VK_52x
    v_mov_b32 v63, 16
VG_51:
    global_load_dword v62, v63, s[84:85] offset:128 sc1
    s_waitcnt vmcnt(0)
    v_cmp_ne_u32 vcc, 0, v62
    s_cbranch_vccnz VK_52
    s_sleep 8
    s_sub_u32 s30, s30, 1
    s_cbranch_scc0 VG_51
    s_branch END
VK_52x:
    v_mov_b32 v63, 16
VG_51x:
    global_load_dword v61, v63, s[84:85] offset:128 sc1
    s_waitcnt vmcnt(0)
    v_cmp_ne_u32 vcc, 0, v61
    s_cbranch_vccnz VK_52
    s_sleep 8
    s_sub_u32 s30, s30, 1
    s_cbranch_scc0 VG_51x
    s_branch END
VK_52:
    v_mov_b32 v63, 163832
    ds_write_b32 v63, v62
    s_waitcnt lgkmcnt(0)
VW_50:
    s_barrier
    v_mov_b32 v63, 163832
    ds_read_b32 v62, v63
    s_waitcnt lgkmcnt(0)
    v_readfirstlane_b32 s3, v62
    s_cmp_lg_u32 s3, 1
    s_cbranch_scc1 REROLE
    s_branch VA_GOT_S
VA_LOOP_S:
    s_cmp_lg_u32 s39, 0
    s_cbranch_scc1 VA_P_S
    s_add_u32 s36, s29, 3
    s_and_b32 s36, s36, 3
    s_mul_i32 s36, s36, 327680
    s_add_u32 s36, s36, 8388608
    s_and_b32 s37, s29, 3
    s_mul_i32 s37, s37, 10240
    s_add_u32 s37, s37, s32
    s_add_u32 s35, s29, 3
    s_and_b32 s35, s35, 3
    s_mul_i32 s35, s35, 10240
    s_add_u32 s35, s35, s32
    s_sub_u32 s3, s29, 1
    s_lshr_b32 s25, s3, 2
    s_and_b32 s25, s25, 1
    s_add_u32 s25, s25, 1
    s_xor_b32 s3, s41, 16384
    s_add_u32 s16, s36, s41
    s_add_u32 s17, s16, 4096
    s_add_u32 s18, s36, s3
    s_add_u32 s19, s18, 4096
    s_lshl_b32 s43, s29, 1
    buffer_load_dword v144, v140, s[8:11], s33 offen sc1
    s_nop 15
    buffer_load_dword v145, v140, s[8:11], s33 offen sc1
    s_nop 15
H3F_55:
    buffer_load_dword v146, v140, s[8:11], s33 offen sc1
    s_waitcnt vmcnt(2)
    v_cmp_gt_u32 vcc, s43, v144
    s_cbranch_vccz H3G_56
    buffer_load_dword v144, v140, s[8:11], s33 offen sc1
    s_waitcnt vmcnt(2)
    v_cmp_gt_u32 vcc, s43, v145
    s_cbranch_vccz H3G_56
    buffer_load_dword v145, v140, s[8:11], s33 offen sc1
    s_waitcnt vmcnt(2)
    v_cmp_gt_u32 vcc, s43, v146
    s_cbranch_vccz H3G_56
    s_sub_u32 s30, s30, 1
    s_cbranch_scc0 H3F_55
    s_branch END
H3G_56:
    s_cmp_lt_i32 s40, 0
    s_cbranch_scc1 H3N_53
    s_cmp_lg_u32 s29, 1
    s_cbranch_scc1 H3G_56_c
    s_waitcnt vmcnt(0)
    v_max3_u32 v147, v144, v145, v146
    v_and_b32 v147, 1, v147
    v_lshl_add_u32 v141, v147, 13, v141
H3G_56_c:
    s_nop 15
    s_nop 15
    s_nop 15
    s_nop 15
    s_nop 3
H3P_57:
    s_sub_u32 s30, s30, 1
    s_cbranch_scc1 END
    buffer_load_dwordx4 v[148:151], v141, s[8:11], s16 offen sc1
    buffer_load_dwordx4 v[152:155], v141, s[8:11], s17 offen sc1
    buffer_load_dwordx4 v[156:159], v141, s[8:11], s18 offen sc1
    buffer_load_dwordx4 v[160:163], v141, s[8:11], s19 offen sc1
    s_waitcnt vmcnt(3)
    v_bitop3_b32 v52, s25, v148, v149 bitop3:0x80
    v_bitop3_b32 v52, v52, v150, v151 bitop3:0x80
    s_waitcnt vmcnt(2)
    v_pk_add_f32 v[164:165], v[148:149], v[152:153]
    v_pk_add_f32 v[166:167], v[150:151], v[154:155]
    v_bitop3_b32 v52, v52, v152, v153 bitop3:0x80
    v_bitop3_b32 v52, v52, v154, v155 bitop3:0x80
    s_waitcnt vmcnt(1)
    v_pk_add_f32 v[164:165], v[164:165], v[156:157]
    v_pk_add_f32 v[166:167], v[166:167], v[158:159]
    v_bitop3_b32 v52, v52, v156, v157 bitop3:0x80
    v_bitop3_b32 v52, v52, v158, v159 bitop3:0x80
    s_waitcnt vmcnt(0)
    v_pk_add_f32 v[164:165], v[164:165], v[160:161]
    v_pk_add_f32 v[166:167], v[166:167], v[162:163]
    v_bitop3_b32 v52, v52, v160, v161 bitop3:0x80
    v_bitop3_b32 v52, v52, v162, v163 bitop3:0x80
    v_permlane32_swap_b32 v164, v166
    v_permlane32_swap_b32 v165, v167
    v_cmp_eq_u32 vcc, 0, v52
    v_pk_add_f32 v[164:165], v[164:165], v[166:167]
    v_cvt_pk_bf16_f32 v166, v164, v165
    v_min_u32 v166, -2, v166
    s_cbranch_vccnz H3P_57
H3K_58:
    buffer_store_dword v166, v142, s[8:11], s37 offen sc1
    buffer_store_dword v143, v142, s[8:11], s35 offen sc1
    s_branch H3D_54
H3N_53:
    s_sleep 10
H3D_54:
VA_P_S:
    s_and_b32 s34, s29, 3
    s_mul_i32 s34, s34, 10240
    s_add_u32 s34, s34, s32
    s_add_u32 s35, s34, 4096
    s_add_u32 s36, s34, 8192
H1P_59:
    buffer_load_dwordx4 v[116:119], v4, s[8:11], s34 offen sc1
    buffer_load_dwordx4 v[120:123], v4, s[8:11], s35 offen sc1
    buffer_load_dwordx4 v[124:127], v8, s[8:11], s36 offen sc1
    s_waitcnt vmcnt(2)
    ds_write_b128 v12, v[116:119]
    v_max3_u32 v52, v116, v117, v118
    s_waitcnt vmcnt(1)
    ds_write_b128 v12, v[120:123] offset:4096
    v_max3_u32 v52, v119, v120, v52
    v_max3_u32 v52, v121, v122, v52
    s_waitcnt vmcnt(0)
    ds_write_b128 v13, v[124:127]
    v_max3_u32 v52, v123, v124, v52
    v_max3_u32 v52, v125, v126, v52
    v_max_u32 v52, v127, v52
    v_cmp_eq_u32 vcc, -1, v52
    s_cbranch_vccz VA_GOT_S
    s_waitcnt lgkmcnt(0)
    s_sub_u32 s30, s30, 1
    s_cbranch_scc0 H1P_59
    s_branch END
VA_GOT_S:
    s_waitcnt lgkmcnt(0)
    s_barrier
    s_barrier
    s_cmp_ge_u32 s29, 2
    s_cbranch_scc1 VA_R_S
    s_mul_i32 s5, s14, 10240
    s_and_b32 s3, s42, 1
    s_mul_i32 s3, s3, 40960
    s_add_u32 s3, s3, s5
    s_mul_i32 s4, s42, 40960
    s_add_u32 s4, s4, s5
    s_add_u32 s4, s4, 10485760
    s_add_u32 s42, s42, 1
    s_mov_b32 m0, s3
    s_nop 0
    buffer_load_dwordx4 v2, s[8:11], s4 offen offset:0 sc1 lds
    buffer_load_dwordx4 v2, s[8:11], s4 offen offset:1024 sc1 lds
    buffer_load_dwordx4 v2, s[8:11], s4 offen offset:2048 sc1 lds
    buffer_load_dwordx4 v2, s[8:11], s4 offen offset:3072 sc1 lds
    s_add_u32 s3, s3, 4096
    s_add_u32 s4, s4, 4096
    s_mov_b32 m0, s3
    s_nop 0
    buffer_load_dwordx4 v2, s[8:11], s4 offen offset:0 sc1 lds
    buffer_load_dwordx4 v2, s[8:11], s4 offen offset:1024 sc1 lds
    buffer_load_dwordx4 v2, s[8:11], s4 offen offset:2048 sc1 lds
    buffer_load_dwordx4 v2, s[8:11], s4 offen offset:3072 sc1 lds
    s_add_u32 s3, s3, 4096
    s_add_u32 s4, s4, 4096
    s_mov_b32 m0, s3
    s_nop 0
    buffer_load_dwordx4 v2, s[8:11], s4 offen offset:0 sc1 lds
    buffer_load_dwordx4 v2, s[8:11], s4 offen offset:1024 sc1 lds
    s_waitcnt vmcnt(0)
    s_barrier
VA_R_S:
    s_cmp_ge_u32 s29, 60
    s_cbranch_scc1 VA_S_S
    s_mul_i32 s5, s14, 10240
    s_and_b32 s3, s42, 1
    s_mul_i32 s3, s3, 40960
    s_add_u32 s3, s3, s5
    s_mul_i32 s4, s42, 40960
    s_add_u32 s4, s4, s5
    s_add_u32 s4, s4, 10485760
    s_add_u32 s42, s42, 1
    s_mov_b32 m0, s3
    s_nop 0
    buffer_load_dwordx4 v2, s[8:11], s4 offen offset:0 sc1 lds
    buffer_load_dwordx4 v2, s[8:11], s4 offen offset:1024 sc1 lds
    buffer_load_dwordx4 v2, s[8:11], s4 offen offset:2048 sc1 lds
    buffer_load_dwordx4 v2, s[8:11], s4 offen offset:3072 sc1 lds
    s_add_u32 s3, s3, 4096
    s_add_u32 s4, s4, 4096
    s_mov_b32 m0, s3
    s_nop 0
    buffer_load_dwordx4 v2, s[8:11], s4 offen offset:0 sc1 lds
    buffer_load_dwordx4 v2, s[8:11], s4 offen offset:1024 sc1 lds
    buffer_load_dwordx4 v2, s[8:11], s4 offen offset:2048 sc1 lds
    buffer_load_dwordx4 v2, s[8:11], s4 offen offset:3072 sc1 lds
    s_add_u32 s3, s3, 4096
    s_add_u32 s4, s4, 4096
    s_mov_b32 m0, s3
    s_nop 0
    buffer_load_dwordx4 v2, s[8:11], s4 offen offset:0 sc1 lds
    buffer_load_dwordx4 v2, s[8:11], s4 offen offset:1024 sc1 lds
VA_S_S:
    s_cmp_eq_u32 s39, 0
    s_cbranch_scc1 VA_N_S
    s_and_b32 s34, s29, 3
    s_mul_i32 s34, s34, 49152
    s_add_u32 s34, s34, 360448
    s_add_u32 s34, s34, s32
    s_and_b32 s37, s29, 3
    s_mul_i32 s37, s37, 10240
    s_add_u32 s37, s37, 557056
    s_add_u32 s37, s37, s32
    s_add_u32 s35, s34, 4096
    s_add_u32 s36, s34, 8192
    s_add_u32 s3, s29, 1
    v_mov_b32 v113, s3
FW_60:
    buffer_load_dword v64, v6, s[8:11], s33 offen sc1
    s_waitcnt vmcnt(0)
    v_cmp_gt_u32 vcc, s3, v64
    s_cbranch_vccz FO_61
    s_sub_u32 s30, s30, 1
    s_cbranch_scc0 FW_60
    s_branch END
FO_61:
    buffer_load_dwordx4 v[64:67], v14, s[8:11], s34 offen sc1
    buffer_load_dwordx4 v[68:71], v15, s[8:11], s34 offen sc1
    buffer_load_dwordx4 v[72:75], v7, s[8:11], s34 offen sc1
    buffer_load_dwordx4 v[76:79], v14, s[8:11], s35 offen sc1
    buffer_load_dwordx4 v[80:83], v15, s[8:11], s35 offen sc1
    buffer_load_dwordx4 v[84:87], v7, s[8:11], s35 offen sc1
    buffer_load_dwordx4 v[88:91], v14, s[8:11], s36 offen sc1
    buffer_load_dwordx4 v[92:95], v15, s[8:11], s36 offen sc1
    buffer_load_dwordx4 v[96:99], v7, s[8:11], s36 offen sc1
    s_waitcnt vmcnt(3)
    v_pk_add_f32 v[64:65], v[64:65], v[76:77]
    v_pk_add_f32 v[66:67], v[66:67], v[78:79]
    v_pk_add_f32 v[68:69], v[68:69], v[80:81]
    v_pk_add_f32 v[70:71], v[70:71], v[82:83]
    v_pk_add_f32 v[72:73], v[72:73], v[84:85]
    v_pk_add_f32 v[74:75], v[74:75], v[86:87]
    v_pk_add_f32 v[64:65], v[64:65], v[100:101]
    v_pk_add_f32 v[66:67], v[66:67], v[102:103]
    v_pk_add_f32 v[68:69], v[68:69], v[104:105]
    v_pk_add_f32 v[70:71], v[70:71], v[106:107]
    v_pk_add_f32 v[72:73], v[72:73], v[108:109]
    v_pk_add_f32 v[74:75], v[74:75], v[110:111]
    s_waitcnt vmcnt(0)
    v_pk_add_f32 v[64:65], v[64:65], v[88:89]
    v_pk_add_f32 v[66:67], v[66:67], v[90:91]
    v_pk_add_f32 v[68:69], v[68:69], v[92:93]
    v_pk_add_f32 v[70:71], v[70:71], v[94:95]
    v_pk_add_f32 v[72:73], v[72:73], v[96:97]
    v_pk_add_f32 v[74:75], v[74:75], v[98:99]
    v_max3_f32 v76, v64, v65, v66
    v_max3_f32 v76, v76, v67, v68
    v_max3_f32 v76, v76, v69, v70
    v_max3_f32 v76, v76, v71, v72
    v_max3_f32 v76, v76, v73, v74
    v_max_f32 v76, v76, v75
    v_mov_b32 v77, v76
    s_nop 1
    v_permlane16_swap_b32 v76, v77
    v_max_f32 v76, v76, v77
    v_mov_b32 v77, v76
    s_nop 1
    v_permlane32_swap_b32 v76, v77
    v_max_f32 v76, v76, v77
    v_mul_f32 v78, s38, v76
    v_pk_fma_f32 v[64:65], v[64:65], v[114:115], v[78:79] op_sel_hi:[1,1,0] neg_lo:[0,0,1] neg_hi:[0,0,1]
    v_pk_fma_f32 v[66:67], v[66:67], v[114:115], v[78:79] op_sel_hi:[1,1,0] neg_lo:[0,0,1] neg_hi:[0,0,1]
    v_pk_fma_f32 v[68:69], v[68:69], v[114:115], v[78:79] op_sel_hi:[1,1,0] neg_lo:[0,0,1] neg_hi:[0,0,1]
    v_pk_fma_f32 v[70:71], v[70:71], v[114:115], v[78:79] op_sel_hi:[1,1,0] neg_lo:[0,0,1] neg_hi:[0,0,1]
    v_pk_fma_f32 v[72:73], v[72:73], v[114:115], v[78:79] op_sel_hi:[1,1,0] neg_lo:[0,0,1] neg_hi:[0,0,1]
    v_pk_fma_f32 v[74:75], v[74:75], v[114:115], v[78:79] op_sel_hi:[1,1,0] neg_lo:[0,0,1] neg_hi:[0,0,1]
    v_exp_f32 v64, v64
    v_exp_f32 v65, v65
    v_exp_f32 v66, v66
    v_exp_f32 v67, v67
    v_exp_f32 v68, v68
    v_exp_f32 v69, v69
    v_exp_f32 v70, v70
    v_exp_f32 v71, v71
    v_exp_f32 v72, v72
    v_exp_f32 v73, v73
    v_exp_f32 v74, v74
    v_exp_f32 v75, v75
    v_pk_add_f32 v[76:77], v[64:65], v[66:67]
    v_pk_add_f32 v[76:77], v[76:77], v[68:69]
    v_pk_add_f32 v[76:77], v[76:77], v[70:71]
    v_pk_add_f32 v[76:77], v[76:77], v[72:73]
    v_pk_add_f32 v[76:77], v[76:77], v[74:75]
    v_add_f32 v76, v76, v77
    v_mov_b32 v77, v76
    s_nop 1
    v_permlane16_swap_b32 v76, v77
    v_add_f32 v76, v76, v77
    v_mov_b32 v77, v76
    s_nop 1
    v_permlane32_swap_b32 v76, v77
    v_add_f32 v76, v76, v77
    v_rcp_f32 v78, v76
    s_nop 0
    v_pk_mul_f32 v[64:65], v[64:65], v[78:79] op_sel_hi:[1,0]
    v_pk_mul_f32 v[66:67], v[66:67], v[78:79] op_sel_hi:[1,0]
    v_pk_mul_f32 v[68:69], v[68:69], v[78:79] op_sel_hi:[1,0]
    v_pk_mul_f32 v[70:71], v[70:71], v[78:79] op_sel_hi:[1,0]
    v_pk_mul_f32 v[72:73], v[72:73], v[78:79] op_sel_hi:[1,0]
    v_pk_mul_f32 v[74:75], v[74:75], v[78:79] op_sel_hi:[1,0]
    v_cvt_pk_bf16_f32 v80, v64, v65
    v_cvt_pk_bf16_f32 v81, v66, v67
    v_cvt_pk_bf16_f32 v82, v68, v69
    v_cvt_pk_bf16_f32 v83, v70, v71
    v_cvt_pk_bf16_f32 v84, v72, v73
    v_cvt_pk_bf16_f32 v85, v74, v75
    buffer_store_dwordx4 v[80:83], v10, s[8:11], s37 offen sc1
    buffer_store_dwordx2 v[84:85], v11, s[8:11], s37 offen sc1
    s_waitcnt vmcnt(0)
    buffer_store_dword v113, v112, s[8:11], s33 offen sc1
VA_N_S:
    s_add_u32 s29, s29, 1
    s_cmp_lt_u32 s29, 64
    s_cbranch_scc1 VA_LOOP_S
    s_waitcnt vmcnt(0)
    s_waitcnt vmcnt(0)
    s_branch END
COMB_S:
    s_sub_u32 s15, s28, 18
    s_cmp_ge_u32 s26, 4
    s_cbranch_scc1 CAUX_S
    v_and_b32 v4, 15, v0
    v_cmp_gt_u32 vcc, 8, v4
    v_mov_b32 v5, 0xeeee
    v_mov_b32 v6, 0x4444
    v_cndmask_b32 v5, v5, v6, vcc
    s_mul_i32 s3, s26, 3072
    v_add_u32 v4, s3, v2
    v_and_b32 v6, 15, v0
    v_lshlrev_b32 v6, 4, v6
    v_bfe_u32 v7, v0, 4, 1
    v_lshl_add_u32 v6, v7, 3, v6
    v_lshrrev_b32 v7, 5, v0
    v_lshl_add_u32 v6, v7, 10, v6
    s_lshl_b32 s3, s26, 8
    s_add_u32 s3, s3, 65536
    v_add_u32 v6, s3, v6
    s_lshl_b32 s3, s26, 12
    v_add_u32 v8, s3, v2
    s_mul_i32 s3, s26, 12288
    v_add_u32 v14, s3, v2
    s_lshr_b32 s4, s26, 1
    s_lshl_b32 s3, s4, 11
    v_add_u32 v11, s3, v2
    s_and_b32 s5, s26, 1
    s_mul_i32 s3, s5, 5120
    v_add_u32 v12, s3, v2
    v_and_b32 v13, 7, v0
    v_lshlrev_b32 v13, 7, v13
    v_lshrrev_b32 v7, 4, v0
    v_lshl_add_u32 v13, v7, 4, v13
    v_bfe_u32 v7, v0, 3, 1
    v_lshl_add_u32 v13, v7, 6, v13
    s_mul_i32 s3, s27, 81920
    s_lshl_b32 s6, s15, 13
    s_add_u32 s3, s3, s6
    s_lshl_b32 s6, s26, 11
    s_add_u32 s3, s3, s6
    v_add_u32 v13, s3, v13
    v_min_u32 v15, 5, v0
    v_lshlrev_b32 v15, 2, v15
    s_mul_i32 s3, s26, 24
    v_add_u32 v15, s3, v15
    v_and_b32 v60, 3, v0
    v_lshlrev_b32 v60, 2, v60
    s_lshl_b32 s3, s5, 4
    s_add_u32 s3, s3, 384
    v_add_u32 v60, s3, v60
    s_add_u32 s3, s15, s26
    s_cmp_eq_u32 s3, 0
    s_mov_b32 s4, 2147483392
    s_cselect_b32 s3, 1024, s4
    v_mov_b32 v61, 2147483392
    s_nop 0
    v_writelane_b32 v61, s3, 0
    s_mov_b32 s43, 13369344
    s_lshl_b32 s3, s15, 15
    s_lshl_b32 s4, s26, 9
    s_add_u32 s3, s3, s4
    s_lshr_b32 s5, s27, 2
    s_lshl_b32 s5, s5, 14
    s_add_u32 s3, s3, s5
    s_and_b32 s4, s27, 3
    s_lshl_b32 s4, s4, 11
    s_add_u32 s3, s3, s4
    v_and_b32 v62, 7, v0
    v_lshrrev_b32 v3, 5, v0
    v_lshlrev_b32 v3, 8, v3
    v_lshl_add_u32 v3, v62, 5, v3
    v_bfe_u32 v7, v0, 4, 1
    v_lshl_add_u32 v3, v7, 4, v3
    v_bfe_u32 v7, v0, 3, 1
    v_lshl_add_u32 v3, v7, 13, v3
    v_add_u32 v3, s3, v3
    v_lshrrev_b32 v7, 4, v0
    v_lshl_add_u32 v1, v7, 3, v62
    v_lshlrev_b32 v1, 4, v1
    v_add_u32 v1, 81920, v1
    s_lshl_b32 s38, s26, 10
    s_mov_b32 s29, 0
    s_mov_b32 s4, 1
FW_62:
    buffer_load_dword v62, v15, s[8:11], s33 offen sc1
    s_waitcnt vmcnt(0)
    v_cmp_gt_u32 vcc, s4, v62
    s_cbranch_vccz FO_63
    s_sub_u32 s30, s30, 1
    s_cbranch_scc0 FW_62
    s_branch END
FO_63:
    s_and_b32 s35, s29, 3
    s_mul_i32 s35, s35, 49152
    s_add_u32 s35, s35, 163840
    s_add_u32 s35, s35, s32
    s_add_u32 s36, s35, 4096
    s_add_u32 s37, s35, 8192
    buffer_load_dwordx4 v[160:163], v14, s[8:11], s35 offen offset:0 sc1
    buffer_load_dwordx4 v[164:167], v14, s[8:11], s35 offen offset:1024 sc1
    buffer_load_dwordx4 v[168:171], v14, s[8:11], s35 offen offset:2048 sc1
    buffer_load_dwordx4 v[172:175], v14, s[8:11], s35 offen offset:3072 sc1
    buffer_load_dwordx4 v[176:179], v14, s[8:11], s36 offen offset:0 sc1
    buffer_load_dwordx4 v[180:183], v14, s[8:11], s36 offen offset:1024 sc1
    buffer_load_dwordx4 v[184:187], v14, s[8:11], s36 offen offset:2048 sc1
    buffer_load_dwordx4 v[188:191], v14, s[8:11], s36 offen offset:3072 sc1
    buffer_load_dwordx4 v[192:195], v14, s[8:11], s37 offen offset:0 sc1
    buffer_load_dwordx4 v[196:199], v14, s[8:11], s37 offen offset:1024 sc1
    buffer_load_dwordx4 v[200:203], v14, s[8:11], s37 offen offset:2048 sc1
    buffer_load_dwordx4 v[204:207], v14, s[8:11], s37 offen offset:3072 sc1
    s_waitcnt vmcnt(0)
    s_add_u32 s3, s29, 0
    s_and_b32 s3, s3, 3
    s_lshl_b32 s3, s3, 14
    v_add_u32 v7, s3, v8
    v_mfma_f32_16x16x32_bf16 v[16:19], v[160:163], v[64:67], 0
    v_mfma_f32_16x16x32_bf16 v[20:23], v[164:167], v[64:67], 0
    v_mfma_f32_16x16x32_bf16 v[24:27], v[160:163], v[72:75], 0
    v_mfma_f32_16x16x32_bf16 v[28:31], v[164:167], v[72:75], 0
    v_mfma_f32_16x16x32_bf16 v[32:35], v[160:163], v[80:83], 0
    v_mfma_f32_16x16x32_bf16 v[36:39], v[164:167], v[80:83], 0
    v_mfma_f32_16x16x32_bf16 v[40:43], v[160:163], v[88:91], 0
    v_mfma_f32_16x16x32_bf16 v[44:47], v[164:167], v[88:91], 0
    v_mfma_f32_16x16x32_bf16 v[16:19], v[168:171], v[68:71], v[16:19]
    v_mfma_f32_16x16x32_bf16 v[20:23], v[172:175], v[68:71], v[20:23]
    v_mfma_f32_16x16x32_bf16 v[24:27], v[168:171], v[76:79], v[24:27]
    v_mfma_f32_16x16x32_bf16 v[28:31], v[172:175], v[76:79], v[28:31]
    v_mfma_f32_16x16x32_bf16 v[32:35], v[168:171], v[84:87], v[32:35]
    v_mfma_f32_16x16x32_bf16 v[36:39], v[172:175], v[84:87], v[36:39]
    v_mfma_f32_16x16x32_bf16 v[40:43], v[168:171], v[92:95], v[40:43]
    v_mfma_f32_16x16x32_bf16 v[44:47], v[172:175], v[92:95], v[44:47]
    v_mfma_f32_16x16x32_bf16 v[16:19], v[176:179], v[96:99], v[16:19]
    v_mfma_f32_16x16x32_bf16 v[20:23], v[180:183], v[96:99], v[20:23]
    v_mfma_f32_16x16x32_bf16 v[24:27], v[176:179], v[104:107], v[24:27]
    v_mfma_f32_16x16x32_bf16 v[28:31], v[180:183], v[104:107], v[28:31]
    v_mfma_f32_16x16x32_bf16 v[32:35], v[176:179], v[112:115], v[32:35]
    v_mfma_f32_16x16x32_bf16 v[36:39], v[180:183], v[112:115], v[36:39]
    v_mfma_f32_16x16x32_bf16 v[40:43], v[176:179], v[120:123], v[40:43]
    v_mfma_f32_16x16x32_bf16 v[44:47], v[180:183], v[120:123], v[44:47]
    v_mfma_f32_16x16x32_bf16 v[16:19], v[184:187], v[100:103], v[16:19]
    v_mfma_f32_16x16x32_bf16 v[20:23], v[188:191], v[100:103], v[20:23]
    v_mfma_f32_16x16x32_bf16 v[24:27], v[184:187], v[108:111], v[24:27]
    v_mfma_f32_16x16x32_bf16 v[28:31], v[188:191], v[108:111], v[28:31]
    v_mfma_f32_16x16x32_bf16 v[32:35], v[184:187], v[116:119], v[32:35]
    v_mfma_f32_16x16x32_bf16 v[36:39], v[188:191], v[116:119], v[36:39]
    v_mfma_f32_16x16x32_bf16 v[40:43], v[184:187], v[124:127], v[40:43]
    v_mfma_f32_16x16x32_bf16 v[44:47], v[188:191], v[124:127], v[44:47]
    v_mfma_f32_16x16x32_bf16 v[16:19], v[192:195], v[128:131], v[16:19]
    v_mfma_f32_16x16x32_bf16 v[20:23], v[196:199], v[128:131], v[20:23]
    v_mfma_f32_16x16x32_bf16 v[24:27], v[192:195], v[136:139], v[24:27]
    v_mfma_f32_16x16x32_bf16 v[28:31], v[196:199], v[136:139], v[28:31]
    v_mfma_f32_16x16x32_bf16 v[32:35], v[192:195], v[144:147], v[32:35]
    v_mfma_f32_16x16x32_bf16 v[36:39], v[196:199], v[144:147], v[36:39]
    v_mfma_f32_16x16x32_bf16 v[40:43], v[192:195], v[152:155], v[40:43]
    v_mfma_f32_16x16x32_bf16 v[44:47], v[196:199], v[152:155], v[44:47]
    v_mfma_f32_16x16x32_bf16 v[16:19], v[200:203], v[132:135], v[16:19]
    v_mfma_f32_16x16x32_bf16 v[20:23], v[204:207], v[132:135], v[20:23]
    v_mfma_f32_16x16x32_bf16 v[24:27], v[200:203], v[140:143], v[24:27]
    v_mfma_f32_16x16x32_bf16 v[28:31], v[204:207], v[140:143], v[28:31]
    v_mfma_f32_16x16x32_bf16 v[32:35], v[200:203], v[148:151], v[32:35]
    v_mfma_f32_16x16x32_bf16 v[36:39], v[204:207], v[148:151], v[36:39]
    v_mfma_f32_16x16x32_bf16 v[40:43], v[200:203], v[156:159], v[40:43]
    v_mfma_f32_16x16x32_bf16 v[44:47], v[204:207], v[156:159], v[44:47]
    s_nop 0
    v_cvt_pk_bf16_f32 v16, v16, v17
    v_cvt_pk_bf16_f32 v17, v18, v19
    v_cvt_pk_bf16_f32 v18, v20, v21
    v_cvt_pk_bf16_f32 v19, v22, v23
    ds_write_b128 v7, v[16:19] offset:0
    v_cvt_pk_bf16_f32 v24, v24, v25
    v_cvt_pk_bf16_f32 v25, v26, v27
    v_cvt_pk_bf16_f32 v26, v28, v29
    v_cvt_pk_bf16_f32 v27, v30, v31
    ds_write_b128 v7, v[24:27] offset:1024
    v_cvt_pk_bf16_f32 v32, v32, v33
    v_cvt_pk_bf16_f32 v33, v34, v35
    v_cvt_pk_bf16_f32 v34, v36, v37
    v_cvt_pk_bf16_f32 v35, v38, v39
    ds_write_b128 v7, v[32:35] offset:2048
    v_cvt_pk_bf16_f32 v40, v40, v41
    v_cvt_pk_bf16_f32 v41, v42, v43
    v_cvt_pk_bf16_f32 v42, v44, v45
    v_cvt_pk_bf16_f32 v43, v46, v47
    ds_write_b128 v7, v[40:43] offset:3072
    s_waitcnt lgkmcnt(0)
    s_barrier
    s_and_b32 s34, s29, 3
    s_mul_i32 s34, s34, 12288
    s_add_u32 s34, s34, 40960
    s_add_u32 s34, s34, s32
    v_mov_b32 v32, 0
    v_mov_b32 v33, 0
    v_mov_b32 v34, 0
    v_mov_b32 v35, 0
    v_mov_b32 v36, 0
    v_mov_b32 v37, 0
    v_mov_b32 v38, 0
    v_mov_b32 v39, 0
    v_mov_b32 v40, 0
    v_mov_b32 v41, 0
    v_mov_b32 v42, 0
    v_mov_b32 v43, 0
    v_mov_b32 v44, 0
    v_mov_b32 v45, 0
    v_mov_b32 v46, 0
    v_mov_b32 v47, 0
    s_and_b32 s3, s29, 3
    s_lshl_b32 s4, s3, 14
    s_add_u32 s4, s4, s38
    v_add_u32 v9, s4, v2
    s_lshl_b32 s3, s3, 12
    v_add_u32 v7, s3, v6
    s_add_u32 s3, s3, s38
    s_add_u32 s3, s3, 65536
    v_add_u32 v10, s3, v2
    ds_read_b128 v[228:231], v9 offset:0
    ds_read_b128 v[232:235], v9 offset:4096
    ds_read_b128 v[236:239], v9 offset:8192
    ds_read_b128 v[240:243], v9 offset:12288
    s_and_b32 s39, s29, 3
    s_mul_i32 s39, s39, 327680
    s_add_u32 s39, s39, 8388608
    s_lshr_b32 s25, s29, 2
    s_and_b32 s25, s25, 1
    s_add_u32 s25, s25, 1
    s_branch CG_P_S
    .p2align 6
CG_LOOP_S:
    s_and_b32 s34, s29, 3
    s_mul_i32 s34, s34, 12288
    s_add_u32 s34, s34, 40960
    s_add_u32 s34, s34, s32
    v_mov_b32 v32, 0
    v_mov_b32 v33, 0
    v_mov_b32 v34, 0
    v_mov_b32 v35, 0
    v_mov_b32 v36, 0
    v_mov_b32 v37, 0
    v_mov_b32 v38, 0
    v_mov_b32 v39, 0
    v_mov_b32 v40, 0
    v_mov_b32 v41, 0
    v_mov_b32 v42, 0
    v_mov_b32 v43, 0
    v_mov_b32 v44, 0
    v_mov_b32 v45, 0
    v_mov_b32 v46, 0
    v_mov_b32 v47, 0
    s_and_b32 s3, s29, 3
    s_lshl_b32 s4, s3, 14
    s_add_u32 s4, s4, s38
    v_add_u32 v9, s4, v2
    s_lshl_b32 s3, s3, 12
    v_add_u32 v7, s3, v6
    s_add_u32 s3, s3, s38
    s_add_u32 s3, s3, 65536
    v_add_u32 v10, s3, v2
    ds_read_b128 v[228:231], v9 offset:0
    ds_read_b128 v[232:235], v9 offset:4096
    ds_read_b128 v[236:239], v9 offset:8192
    ds_read_b128 v[240:243], v9 offset:12288
    s_and_b32 s39, s29, 3
    s_mul_i32 s39, s39, 327680
    s_add_u32 s39, s39, 8388608
    s_lshr_b32 s25, s29, 2
    s_and_b32 s25, s25, 1
    s_add_u32 s25, s25, 1
    s_sleep 10
CG_P_S:
    s_sub_u32 s30, s30, 1
    s_cbranch_scc1 END
    buffer_load_dwordx4 v[48:51], v4, s[8:11], s34 offen offset:0 sc1
    buffer_load_dwordx4 v[52:55], v4, s[8:11], s34 offen offset:1024 sc1
    buffer_load_dwordx4 v[56:59], v4, s[8:11], s34 offen offset:2048 sc1
    s_waitcnt vmcnt(2)
    v_max3_u32 v62, v48, v49, v50
    s_waitcnt vmcnt(1)
    v_max3_u32 v62, v62, v51, v52
    v_max3_u32 v62, v62, v53, v54
    s_waitcnt vmcnt(0)
    v_max3_u32 v62, v62, v55, v56
    v_max3_u32 v62, v62, v57, v58
    v_max_u32 v62, v62, v59
    v_cmp_eq_u32 vcc, -1, v62
    s_cbranch_vccnz CG_P_S
    v_smfmac_f32_16x16x64_bf16 v[32:35], v[48:51], v[64:71], v5
    v_smfmac_f32_16x16x64_bf16 v[36:39], v[48:51], v[72:79], v5
    v_smfmac_f32_16x16x64_bf16 v[40:43], v[48:51], v[80:87], v5
    v_smfmac_f32_16x16x64_bf16 v[44:47], v[48:51], v[88:95], v5
    v_smfmac_f32_16x16x64_bf16 v[32:35], v[52:55], v[96:103], v5
    v_smfmac_f32_16x16x64_bf16 v[36:39], v[52:55], v[104:111], v5
    v_smfmac_f32_16x16x64_bf16 v[40:43], v[52:55], v[112:119], v5
    v_smfmac_f32_16x16x64_bf16 v[44:47], v[52:55], v[120:127], v5
    v_smfmac_f32_16x16x64_bf16 v[32:35], v[56:59], v[128:135], v5
    v_smfmac_f32_16x16x64_bf16 v[36:39], v[56:59], v[136:143], v5
    v_smfmac_f32_16x16x64_bf16 v[40:43], v[56:59], v[144:151], v5
    v_smfmac_f32_16x16x64_bf16 v[44:47], v[56:59], v[152:159], v5
    s_nop 5
    v_permlane32_swap_b32 v32, v36
    v_permlane32_swap_b32 v33, v37
    v_permlane32_swap_b32 v34, v38
    v_permlane32_swap_b32 v35, v39
    v_pk_add_f32 v[32:33], v[32:33], v[36:37]
    v_pk_add_f32 v[34:35], v[34:35], v[38:39]
    v_cvt_pk_bf16_f32 v32, v32, v33
    v_cvt_pk_bf16_f32 v33, v34, v35
    ds_write_b64 v7, v[32:33] offset:0
    v_permlane32_swap_b32 v40, v44
    v_permlane32_swap_b32 v41, v45
    v_permlane32_swap_b32 v42, v46
    v_permlane32_swap_b32 v43, v47
    v_pk_add_f32 v[40:41], v[40:41], v[44:45]
    v_pk_add_f32 v[42:43], v[42:43], v[46:47]
    v_cvt_pk_bf16_f32 v40, v40, v41
    v_cvt_pk_bf16_f32 v41, v42, v43
    ds_write_b64 v7, v[40:41] offset:2048
    s_waitcnt lgkmcnt(0)
    s_barrier
    s_cmp_eq_u32 s29, 63
    s_cbranch_scc1 CG_0_S
    ds_read_b128 v[16:19], v1 offset:0
    ds_read_b128 v[20:23], v1 offset:512
    ds_read_b128 v[24:27], v1 offset:1024
    ds_read_b128 v[28:31], v1 offset:1536
    ds_read_b128 v[32:35], v1 offset:2048
    ds_read_b128 v[36:39], v10
    s_waitcnt lgkmcnt(5)
    v_mfma_f32_16x16x32_bf16 v[40:43], v[228:231], v[16:19], 0
    s_waitcnt lgkmcnt(4)
    v_mfma_f32_16x16x32_bf16 v[40:43], v[232:235], v[20:23], v[40:43]
    s_waitcnt lgkmcnt(3)
    v_mfma_f32_16x16x32_bf16 v[40:43], v[236:239], v[24:27], v[40:43]
    s_waitcnt lgkmcnt(2)
    v_mfma_f32_16x16x32_bf16 v[40:43], v[240:243], v[28:31], v[40:43]
    s_waitcnt lgkmcnt(0)
    v_mfma_f32_16x16x32_bf16 v[40:43], v[36:39], v[32:35], v[40:43]
    s_nop 7
    v_and_or_b32 v40, v40, -4, s25
    v_and_or_b32 v41, v41, -4, s25
    v_and_or_b32 v42, v42, -4, s25
    v_and_or_b32 v43, v43, -4, s25
    buffer_store_dwordx4 v[40:43], v3, s[8:11], s39 offen sc1
CG_0_S:
    s_add_u32 s3, s29, 2
    s_and_b32 s3, s3, 3
    s_lshl_b32 s4, s3, 14
    v_add_u32 v9, s4, v11
    s_lshl_b32 s3, s3, 12
    s_add_u32 s3, s3, 65536
    v_add_u32 v10, s3, v11
    ds_read_b128 v[228:231], v9 offset:0
    ds_read_b128 v[232:235], v9 offset:4096
    ds_read_b128 v[236:239], v9 offset:8192
    ds_read_b128 v[240:243], v9 offset:12288
    ds_read_b128 v[244:247], v10 offset:0
    ds_read_b128 v[248:251], v9 offset:1024
    ds_read_b128 v[252:255], v9 offset:5120
    ds_read_b128 v[48:51], v9 offset:9216
    ds_read_b128 v[52:55], v9 offset:13312
    ds_read_b128 v[56:59], v10 offset:1024
    s_cmp_eq_u32 s29, 63
    s_cbranch_scc1 CG_1_S
    s_cmp_lt_u32 s29, 2
    s_cbranch_scc1 CG_E0_S
CG_Z_S:
    s_add_u32 s35, s29, 2
    s_and_b32 s35, s35, 3
    s_mul_i32 s35, s35, 49152
    s_add_u32 s35, s35, 163840
    s_add_u32 s35, s35, s32
    s_cmp_ge_u32 s29, 62
    s_cselect_b32 s35, 2147417856, s35
    s_add_u32 s36, s35, 4096
    s_add_u32 s37, s35, 8192
    s_add_u32 s3, s29, 1
    s_and_b32 s3, s3, 3
    s_lshl_b32 s3, s3, 14
    v_add_u32 v7, s3, v8
    v_mfma_f32_16x16x32_bf16 v[16:19], v[160:163], v[64:67], 0
    v_mfma_f32_16x16x32_bf16 v[20:23], v[164:167], v[64:67], 0
    v_mfma_f32_16x16x32_bf16 v[24:27], v[160:163], v[72:75], 0
    v_mfma_f32_16x16x32_bf16 v[28:31], v[164:167], v[72:75], 0
    v_mfma_f32_16x16x32_bf16 v[32:35], v[160:163], v[80:83], 0
    v_mfma_f32_16x16x32_bf16 v[36:39], v[164:167], v[80:83], 0
    v_mfma_f32_16x16x32_bf16 v[40:43], v[160:163], v[88:91], 0
    v_mfma_f32_16x16x32_bf16 v[44:47], v[164:167], v[88:91], 0
    v_mfma_f32_16x16x32_bf16 v[16:19], v[168:171], v[68:71], v[16:19]
    v_mfma_f32_16x16x32_bf16 v[20:23], v[172:175], v[68:71], v[20:23]
    v_mfma_f32_16x16x32_bf16 v[24:27], v[168:171], v[76:79], v[24:27]
    v_mfma_f32_16x16x32_bf16 v[28:31], v[172:175], v[76:79], v[28:31]
    v_mfma_f32_16x16x32_bf16 v[32:35], v[168:171], v[84:87], v[32:35]
    v_mfma_f32_16x16x32_bf16 v[36:39], v[172:175], v[84:87], v[36:39]
    v_mfma_f32_16x16x32_bf16 v[40:43], v[168:171], v[92:95], v[40:43]
    v_mfma_f32_16x16x32_bf16 v[44:47], v[172:175], v[92:95], v[44:47]
    buffer_load_dwordx4 v[160:163], v14, s[8:11], s35 offen offset:0 sc1
    buffer_load_dwordx4 v[164:167], v14, s[8:11], s35 offen offset:1024 sc1
    v_mfma_f32_16x16x32_bf16 v[16:19], v[176:179], v[96:99], v[16:19]
    v_mfma_f32_16x16x32_bf16 v[20:23], v[180:183], v[96:99], v[20:23]
    v_mfma_f32_16x16x32_bf16 v[24:27], v[176:179], v[104:107], v[24:27]
    v_mfma_f32_16x16x32_bf16 v[28:31], v[180:183], v[104:107], v[28:31]
    v_mfma_f32_16x16x32_bf16 v[32:35], v[176:179], v[112:115], v[32:35]
    v_mfma_f32_16x16x32_bf16 v[36:39], v[180:183], v[112:115], v[36:39]
    v_mfma_f32_16x16x32_bf16 v[40:43], v[176:179], v[120:123], v[40:43]
    v_mfma_f32_16x16x32_bf16 v[44:47], v[180:183], v[120:123], v[44:47]
    buffer_load_dwordx4 v[168:171], v14, s[8:11], s35 offen offset:2048 sc1
    buffer_load_dwordx4 v[172:175], v14, s[8:11], s35 offen offset:3072 sc1
    v_mfma_f32_16x16x32_bf16 v[16:19], v[184:187], v[100:103], v[16:19]
    v_mfma_f32_16x16x32_bf16 v[20:23], v[188:191], v[100:103], v[20:23]
    v_mfma_f32_16x16x32_bf16 v[24:27], v[184:187], v[108:111], v[24:27]
    v_mfma_f32_16x16x32_bf16 v[28:31], v[188:191], v[108:111], v[28:31]
    v_mfma_f32_16x16x32_bf16 v[32:35], v[184:187], v[116:119], v[32:35]
    v_mfma_f32_16x16x32_bf16 v[36:39], v[188:191], v[116:119], v[36:39]
    v_mfma_f32_16x16x32_bf16 v[40:43], v[184:187], v[124:127], v[40:43]
    v_mfma_f32_16x16x32_bf16 v[44:47], v[188:191], v[124:127], v[44:47]
    buffer_load_dwordx4 v[176:179], v14, s[8:11], s36 offen offset:0 sc1
    buffer_load_dwordx4 v[180:183], v14, s[8:11], s36 offen offset:1024 sc1
    v_mfma_f32_16x16x32_bf16 v[16:19], v[192:195], v[128:131], v[16:19]
    v_mfma_f32_16x16x32_bf16 v[20:23], v[196:199], v[128:131], v[20:23]
    v_mfma_f32_16x16x32_bf16 v[24:27], v[192:195], v[136:139], v[24:27]
    v_mfma_f32_16x16x32_bf16 v[28:31], v[196:199], v[136:139], v[28:31]
    v_mfma_f32_16x16x32_bf16 v[32:35], v[192:195], v[144:147], v[32:35]
    v_mfma_f32_16x16x32_bf16 v[36:39], v[196:199], v[144:147], v[36:39]
    v_mfma_f32_16x16x32_bf16 v[40:43], v[192:195], v[152:155], v[40:43]
    v_mfma_f32_16x16x32_bf16 v[44:47], v[196:199], v[152:155], v[44:47]
    buffer_load_dwordx4 v[184:187], v14, s[8:11], s36 offen offset:2048 sc1
    buffer_load_dwordx4 v[188:191], v14, s[8:11], s36 offen offset:3072 sc1
    v_mfma_f32_16x16x32_bf16 v[16:19], v[200:203], v[132:135], v[16:19]
    v_mfma_f32_16x16x32_bf16 v[20:23], v[204:207], v[132:135], v[20:23]
    v_mfma_f32_16x16x32_bf16 v[24:27], v[200:203], v[140:143], v[24:27]
    v_mfma_f32_16x16x32_bf16 v[28:31], v[204:207], v[140:143], v[28:31]
    v_mfma_f32_16x16x32_bf16 v[32:35], v[200:203], v[148:151], v[32:35]
    v_mfma_f32_16x16x32_bf16 v[36:39], v[204:207], v[148:151], v[36:39]
    v_mfma_f32_16x16x32_bf16 v[40:43], v[200:203], v[156:159], v[40:43]
    v_mfma_f32_16x16x32_bf16 v[44:47], v[204:207], v[156:159], v[44:47]
    buffer_load_dwordx4 v[192:195], v14, s[8:11], s37 offen offset:0 sc1
    buffer_load_dwordx4 v[196:199], v14, s[8:11], s37 offen offset:1024 sc1
    buffer_load_dwordx4 v[200:203], v14, s[8:11], s37 offen offset:2048 sc1
    buffer_load_dwordx4 v[204:207], v14, s[8:11], s37 offen offset:3072 sc1
    v_cvt_pk_bf16_f32 v16, v16, v17
    v_cvt_pk_bf16_f32 v17, v18, v19
    v_cvt_pk_bf16_f32 v18, v20, v21
    v_cvt_pk_bf16_f32 v19, v22, v23
    ds_write_b128 v7, v[16:19] offset:0
    v_cvt_pk_bf16_f32 v24, v24, v25
    v_cvt_pk_bf16_f32 v25, v26, v27
    v_cvt_pk_bf16_f32 v26, v28, v29
    v_cvt_pk_bf16_f32 v27, v30, v31
    ds_write_b128 v7, v[24:27] offset:1024
    v_cvt_pk_bf16_f32 v32, v32, v33
    v_cvt_pk_bf16_f32 v33, v34, v35
    v_cvt_pk_bf16_f32 v34, v36, v37
    v_cvt_pk_bf16_f32 v35, v38, v39
    ds_write_b128 v7, v[32:35] offset:2048
    v_cvt_pk_bf16_f32 v40, v40, v41
    v_cvt_pk_bf16_f32 v41, v42, v43
    v_cvt_pk_bf16_f32 v42, v44, v45
    v_cvt_pk_bf16_f32 v43, v46, v47
    ds_write_b128 v7, v[40:43] offset:3072
CG_1_S:
    s_waitcnt lgkmcnt(0)
    v_mfma_f32_16x16x32_bf16 v[20:23], v[228:231], v[208:211], 0
    v_mfma_f32_16x16x32_bf16 v[28:31], v[248:251], v[208:211], 0
    v_mfma_f32_16x16x32_bf16 v[20:23], v[232:235], v[212:215], v[20:23]
    v_mfma_f32_16x16x32_bf16 v[28:31], v[252:255], v[212:215], v[28:31]
    v_mfma_f32_16x16x32_bf16 v[20:23], v[236:239], v[216:219], v[20:23]
    v_mfma_f32_16x16x32_bf16 v[28:31], v[48:51], v[216:219], v[28:31]
    v_mfma_f32_16x16x32_bf16 v[20:23], v[240:243], v[220:223], v[20:23]
    v_mfma_f32_16x16x32_bf16 v[28:31], v[52:55], v[220:223], v[28:31]
    v_mfma_f32_16x16x32_bf16 v[20:23], v[244:247], v[224:227], v[20:23]
    v_mfma_f32_16x16x32_bf16 v[28:31], v[56:59], v[224:227], v[28:31]
    s_nop 6
    v_and_or_b32 v24, v20, -4, 1
    v_and_or_b32 v28, v28, -4, 1
    v_and_or_b32 v25, v21, -4, 1
    v_and_or_b32 v29, v29, -4, 1
    v_and_or_b32 v26, v22, -4, 1
    v_and_or_b32 v30, v30, -4, 1
    v_and_or_b32 v27, v23, -4, 1
    v_and_or_b32 v31, v31, -4, 1
    v_mov_b32 v20, v24
    v_mov_b32 v21, v25
    v_mov_b32 v22, v26
    v_mov_b32 v23, v27
    v_mov_b32_dpp v20, v28 row_ror:8 row_mask:0xf bank_mask:0xc
    v_mov_b32_dpp v21, v29 row_ror:8 row_mask:0xf bank_mask:0xc
    v_mov_b32_dpp v22, v30 row_ror:8 row_mask:0xf bank_mask:0xc
    v_mov_b32_dpp v23, v31 row_ror:8 row_mask:0xf bank_mask:0xc
    v_mov_b32_dpp v28, v24 row_ror:8 row_mask:0xf bank_mask:0x3
    v_mov_b32_dpp v29, v25 row_ror:8 row_mask:0xf bank_mask:0x3
    v_mov_b32_dpp v30, v26 row_ror:8 row_mask:0xf bank_mask:0x3
    v_mov_b32_dpp v31, v27 row_ror:8 row_mask:0xf bank_mask:0x3
    s_sub_u32 s3, s29, 3
    s_max_i32 s3, s3, 0
    v_mov_b32 v63, s3
    s_cmp_lt_u32 s29, 2
    s_cbranch_scc1 CG_3_S
    buffer_store_dwordx4 v[20:23], v13, s[8:11], s43 offen sc1
    buffer_store_dwordx4 v[28:31], v13, s[8:11], s43 offen offset:1024 sc1
    s_sub_u32 s3, s29, 8
    s_cmp_ge_u32 s3, 4
    s_cbranch_scc1 CG_3_S
    s_add_u32 s3, s43, 35389440
    v_mov_b32 v20, 0
    v_mov_b32 v21, 0
    v_mov_b32 v22, 0
    v_mov_b32 v23, 0
    buffer_store_dwordx4 v[20:23], v13, s[8:11], s3 offen sc1
    buffer_store_dwordx4 v[20:23], v13, s[8:11], s3 offen offset:1024 sc1
CG_3_S:
    s_add_u32 s3, s29, 2
    s_and_b32 s3, s3, 3
    s_mul_i32 s3, s3, 327680
    s_add_u32 s3, s3, 8388608
    v_mov_b32 v44, 0
    v_mov_b32 v45, 0
    v_mov_b32 v46, 0
    v_mov_b32 v47, 0
    buffer_store_dwordx4 v[44:47], v3, s[8:11], s3 offen sc1
    buffer_store_dword v63, v61, s[8:11], s33 offen sc1
    s_add_u32 s35, s29, 3
    s_and_b32 s35, s35, 3
    s_mul_i32 s35, s35, 10240
    s_add_u32 s35, s35, 557056
    s_add_u32 s35, s35, s32
    s_add_u32 s36, s35, 4096
    buffer_load_dwordx4 v[208:211], v12, s[8:11], s35 offen offset:0 sc1
    buffer_load_dwordx4 v[212:215], v12, s[8:11], s35 offen offset:1024 sc1
    buffer_load_dwordx4 v[216:219], v12, s[8:11], s35 offen offset:2048 sc1
    buffer_load_dwordx4 v[220:223], v12, s[8:11], s35 offen offset:3072 sc1
    buffer_load_dwordx4 v[224:227], v12, s[8:11], s36 offen sc1
    s_waitcnt lgkmcnt(0)
    s_barrier
    s_add_u32 s43, s43, 655360
    s_add_u32 s29, s29, 1
    s_cmp_lt_u32 s29, 64
    s_cbranch_scc1 CG_LOOP_S
    s_add_u32 s3, s29, 2
    s_and_b32 s3, s3, 3
    s_lshl_b32 s4, s3, 14
    v_add_u32 v9, s4, v11
    s_lshl_b32 s3, s3, 12
    s_add_u32 s3, s3, 65536
    v_add_u32 v10, s3, v11
    ds_read_b128 v[228:231], v9 offset:0
    ds_read_b128 v[232:235], v9 offset:4096
    ds_read_b128 v[236:239], v9 offset:8192
    ds_read_b128 v[240:243], v9 offset:12288
    ds_read_b128 v[244:247], v10 offset:0
    ds_read_b128 v[248:251], v9 offset:1024
    ds_read_b128 v[252:255], v9 offset:5120
    ds_read_b128 v[48:51], v9 offset:9216
    ds_read_b128 v[52:55], v9 offset:13312
    ds_read_b128 v[56:59], v10 offset:1024
    s_waitcnt vmcnt(0) lgkmcnt(0)
    v_mfma_f32_16x16x32_bf16 v[20:23], v[228:231], v[208:211], 0
    v_mfma_f32_16x16x32_bf16 v[28:31], v[248:251], v[208:211], 0
    v_mfma_f32_16x16x32_bf16 v[20:23], v[232:235], v[212:215], v[20:23]
    v_mfma_f32_16x16x32_bf16 v[28:31], v[252:255], v[212:215], v[28:31]
    v_mfma_f32_16x16x32_bf16 v[20:23], v[236:239], v[216:219], v[20:23]
    v_mfma_f32_16x16x32_bf16 v[28:31], v[48:51], v[216:219], v[28:31]
    v_mfma_f32_16x16x32_bf16 v[20:23], v[240:243], v[220:223], v[20:23]
    v_mfma_f32_16x16x32_bf16 v[28:31], v[52:55], v[220:223], v[28:31]
    v_mfma_f32_16x16x32_bf16 v[20:23], v[244:247], v[224:227], v[20:23]
    v_mfma_f32_16x16x32_bf16 v[28:31], v[56:59], v[224:227], v[28:31]
    s_nop 6
    v_and_or_b32 v24, v20, -4, 1
    v_and_or_b32 v28, v28, -4, 1
    v_and_or_b32 v25, v21, -4, 1
    v_and_or_b32 v29, v29, -4, 1
    v_and_or_b32 v26, v22, -4, 1
    v_and_or_b32 v30, v30, -4, 1
    v_and_or_b32 v27, v23, -4, 1
    v_and_or_b32 v31, v31, -4, 1
    v_mov_b32 v20, v24
    v_mov_b32 v21, v25
    v_mov_b32 v22, v26
    v_mov_b32 v23, v27
    v_mov_b32_dpp v20, v28 row_ror:8 row_mask:0xf bank_mask:0xc
    v_mov_b32_dpp v21, v29 row_ror:8 row_mask:0xf bank_mask:0xc
    v_mov_b32_dpp v22, v30 row_ror:8 row_mask:0xf bank_mask:0xc
    v_mov_b32_dpp v23, v31 row_ror:8 row_mask:0xf bank_mask:0xc
    v_mov_b32_dpp v28, v24 row_ror:8 row_mask:0xf bank_mask:0x3
    v_mov_b32_dpp v29, v25 row_ror:8 row_mask:0xf bank_mask:0x3
    v_mov_b32_dpp v30, v26 row_ror:8 row_mask:0xf bank_mask:0x3
    v_mov_b32_dpp v31, v27 row_ror:8 row_mask:0xf bank_mask:0x3
    buffer_store_dwordx4 v[20:23], v13, s[8:11], s43 offen sc1
    buffer_store_dwordx4 v[28:31], v13, s[8:11], s43 offen offset:1024 sc1
    s_mov_b32 s4, 64
FW_64:
    buffer_load_dword v62, v60, s[8:11], s33 offen sc1
    s_waitcnt vmcnt(0)
    v_cmp_gt_u32 vcc, s4, v62
    s_cbranch_vccz FO_65
    s_sub_u32 s30, s30, 1
    s_cbranch_scc0 FW_64
    s_branch END
FO_65:
    s_add_u32 s35, s29, 3
    s_and_b32 s35, s35, 3
    s_mul_i32 s35, s35, 10240
    s_add_u32 s35, s35, 557056
    s_add_u32 s35, s35, s32
    s_add_u32 s36, s35, 4096
    buffer_load_dwordx4 v[208:211], v12, s[8:11], s35 offen offset:0 sc1
    buffer_load_dwordx4 v[212:215], v12, s[8:11], s35 offen offset:1024 sc1
    buffer_load_dwordx4 v[216:219], v12, s[8:11], s35 offen offset:2048 sc1
    buffer_load_dwordx4 v[220:223], v12, s[8:11], s35 offen offset:3072 sc1
    buffer_load_dwordx4 v[224:227], v12, s[8:11], s36 offen sc1
    s_add_u32 s43, s43, 655360
    s_add_u32 s29, s29, 1
    s_add_u32 s3, s29, 2
    s_and_b32 s3, s3, 3
    s_lshl_b32 s4, s3, 14
    v_add_u32 v9, s4, v11
    s_lshl_b32 s3, s3, 12
    s_add_u32 s3, s3, 65536
    v_add_u32 v10, s3, v11
    ds_read_b128 v[228:231], v9 offset:0
    ds_read_b128 v[232:235], v9 offset:4096
    ds_read_b128 v[236:239], v9 offset:8192
    ds_read_b128 v[240:243], v9 offset:12288
    ds_read_b128 v[244:247], v10 offset:0
    ds_read_b128 v[248:251], v9 offset:1024
    ds_read_b128 v[252:255], v9 offset:5120
    ds_read_b128 v[48:51], v9 offset:9216
    ds_read_b128 v[52:55], v9 offset:13312
    ds_read_b128 v[56:59], v10 offset:1024
    s_waitcnt vmcnt(0) lgkmcnt(0)
    v_mfma_f32_16x16x32_bf16 v[20:23], v[228:231], v[208:211], 0
    v_mfma_f32_16x16x32_bf16 v[28:31], v[248:251], v[208:211], 0
    v_mfma_f32_16x16x32_bf16 v[20:23], v[232:235], v[212:215], v[20:23]
    v_mfma_f32_16x16x32_bf16 v[28:31], v[252:255], v[212:215], v[28:31]
    v_mfma_f32_16x16x32_bf16 v[20:23], v[236:239], v[216:219], v[20:23]
    v_mfma_f32_16x16x32_bf16 v[28:31], v[48:51], v[216:219], v[28:31]
    v_mfma_f32_16x16x32_bf16 v[20:23], v[240:243], v[220:223], v[20:23]
    v_mfma_f32_16x16x32_bf16 v[28:31], v[52:55], v[220:223], v[28:31]
    v_mfma_f32_16x16x32_bf16 v[20:23], v[244:247], v[224:227], v[20:23]
    v_mfma_f32_16x16x32_bf16 v[28:31], v[56:59], v[224:227], v[28:31]
    s_nop 6
    v_and_or_b32 v24, v20, -4, 1
    v_and_or_b32 v28, v28, -4, 1
    v_and_or_b32 v25, v21, -4, 1
    v_and_or_b32 v29, v29, -4, 1
    v_and_or_b32 v26, v22, -4, 1
    v_and_or_b32 v30, v30, -4, 1
    v_and_or_b32 v27, v23, -4, 1
    v_and_or_b32 v31, v31, -4, 1
    v_mov_b32 v20, v24
    v_mov_b32 v21, v25
    v_mov_b32 v22, v26
    v_mov_b32 v23, v27
    v_mov_b32_dpp v20, v28 row_ror:8 row_mask:0xf bank_mask:0xc
    v_mov_b32_dpp v21, v29 row_ror:8 row_mask:0xf bank_mask:0xc
    v_mov_b32_dpp v22, v30 row_ror:8 row_mask:0xf bank_mask:0xc
    v_mov_b32_dpp v23, v31 row_ror:8 row_mask:0xf bank_mask:0xc
    v_mov_b32_dpp v28, v24 row_ror:8 row_mask:0xf bank_mask:0x3
    v_mov_b32_dpp v29, v25 row_ror:8 row_mask:0xf bank_mask:0x3
    v_mov_b32_dpp v30, v26 row_ror:8 row_mask:0xf bank_mask:0x3
    v_mov_b32_dpp v31, v27 row_ror:8 row_mask:0xf bank_mask:0x3
    buffer_store_dwordx4 v[20:23], v13, s[8:11], s43 offen sc1
    buffer_store_dwordx4 v[28:31], v13, s[8:11], s43 offen offset:1024 sc1
    s_waitcnt vmcnt(0)
    s_waitcnt vmcnt(0)
    s_branch END
CG_E0_S:
    s_cmp_eq_u32 s29, 1
    s_cbranch_scc1 CG_Y_S
    s_mov_b32 s4, 2
FW_66:
    buffer_load_dword v62, v15, s[8:11], s33 offen sc1
    s_waitcnt vmcnt(0)
    v_cmp_gt_u32 vcc, s4, v62
    s_cbranch_vccz FO_67
    s_sub_u32 s30, s30, 1
    s_cbranch_scc0 FW_66
    s_branch END
FO_67:
    s_add_u32 s35, s29, 1
    s_and_b32 s35, s35, 3
    s_mul_i32 s35, s35, 49152
    s_add_u32 s35, s35, 163840
    s_add_u32 s35, s35, s32
    s_add_u32 s36, s35, 4096
    s_add_u32 s37, s35, 8192
    buffer_load_dwordx4 v[160:163], v14, s[8:11], s35 offen offset:0 sc1
    buffer_load_dwordx4 v[164:167], v14, s[8:11], s35 offen offset:1024 sc1
    buffer_load_dwordx4 v[168:171], v14, s[8:11], s35 offen offset:2048 sc1
    buffer_load_dwordx4 v[172:175], v14, s[8:11], s35 offen offset:3072 sc1
    buffer_load_dwordx4 v[176:179], v14, s[8:11], s36 offen offset:0 sc1
    buffer_load_dwordx4 v[180:183], v14, s[8:11], s36 offen offset:1024 sc1
    buffer_load_dwordx4 v[184:187], v14, s[8:11], s36 offen offset:2048 sc1
    buffer_load_dwordx4 v[188:191], v14, s[8:11], s36 offen offset:3072 sc1
    buffer_load_dwordx4 v[192:195], v14, s[8:11], s37 offen offset:0 sc1
    buffer_load_dwordx4 v[196:199], v14, s[8:11], s37 offen offset:1024 sc1
    buffer_load_dwordx4 v[200:203], v14, s[8:11], s37 offen offset:2048 sc1
    buffer_load_dwordx4 v[204:207], v14, s[8:11], s37 offen offset:3072 sc1
CG_Y_S:
    s_add_u32 s4, s29, 3
FW_68:
    buffer_load_dword v62, v15, s[8:11], s33 offen sc1
    s_waitcnt vmcnt(0)
    v_cmp_gt_u32 vcc, s4, v62
    s_cbranch_vccz FO_69
    s_sub_u32 s30, s30, 1
    s_cbranch_scc0 FW_68
    s_branch END
FO_69:
    s_branch CG_Z_S
CAUX_S:
    s_setprio 2
    s_sub_u32 s14, s26, 4
    s_mul_i32 s3, s14, 3840
    v_add_u32 v4, s3, v2
    s_add_u32 s3, s3, 1024
    v_lshlrev_b32 v5, 2, v0
    v_add_u32 v5, s3, v5
    v_and_b32 v6, 3, v0
    v_bfe_u32 v7, v0, 2, 3
    v_lshl_add_u32 v12, v6, 3, v7
    v_lshlrev_b32 v12, 4, v12
    v_lshrrev_b32 v8, 5, v0
    v_lshl_add_u32 v12, v8, 3, v12
    s_lshl_b32 s3, s14, 9
    s_add_u32 s3, s3, 81920
    v_add_u32 v12, s3, v12
    v_lshlrev_b32 v13, 4, v7
    v_lshl_add_u32 v13, v8, 3, v13
    v_lshl_add_u32 v13, v6, 1, v13
    s_lshl_b32 s3, s14, 7
    s_add_u32 s3, s3, 83968
    v_add_u32 v13, s3, v13
    s_lshl_b32 s3, s15, 7
    s_add_u32 s3, s3, 2048
    s_cmp_eq_u32 s14, 0
    s_cselect_b32 s3, s3, 2147483392
    v_mov_b32 v10, 2147483392
    s_nop 0
    v_writelane_b32 v10, s3, 0
    s_mov_b32 s24, 0x3dd53b95
    v_mov_b32 v20, s24
    v_mov_b32 v21, s24
    s_mov_b32 s40, 0
    s_cmp_lg_u32 s14, 0
    s_cbranch_scc1 CA_C_S
    v_and_b32 v24, 31, v0
    v_lshlrev_b32 v24, 4, v24
    v_lshrrev_b32 v25, 5, v0
    v_lshl_add_u32 v24, v25, 11, v24
    s_lshl_b32 s3, s15, 15
    v_add_u32 v24, s3, v24
    s_mov_b32 s6, -1
    s_mov_b32 s7, -1
    s_mov_b32 s4, 9043968
    buffer_load_dwordx2 v[26:27], v24, s[8:11], s4 offen sc1
    s_waitcnt vmcnt(0)
    s_mov_b32 s4, 9371648
    s_memtime s[60:61]
    s_waitcnt lgkmcnt(0)
    buffer_load_dwordx2 v[26:27], v24, s[8:11], s4 offen sc1
    s_waitcnt vmcnt(0)
    s_memtime s[62:63]
    s_waitcnt lgkmcnt(0)
    s_sub_u32 s3, s62, s60
    s_min_u32 s6, s6, s3
    s_mov_b32 s4, 9379840
    s_memtime s[60:61]
    s_waitcnt lgkmcnt(0)
    buffer_load_dwordx2 v[26:27], v24, s[8:11], s4 offen sc1
    s_waitcnt vmcnt(0)
    s_memtime s[62:63]
    s_waitcnt lgkmcnt(0)
    s_sub_u32 s3, s62, s60
    s_min_u32 s7, s7, s3
    s_mov_b32 s4, 9375744
    s_memtime s[60:61]
    s_waitcnt lgkmcnt(0)
    buffer_load_dwordx2 v[26:27], v24, s[8:11], s4 offen sc1
    s_waitcnt vmcnt(0)
    s_memtime s[62:63]
    s_waitcnt lgkmcnt(0)
    s_sub_u32 s3, s62, s60
    s_min_u32 s6, s6, s3
    s_mov_b32 s4, 9383936
    s_memtime s[60:61]
    s_waitcnt lgkmcnt(0)
    buffer_load_dwordx2 v[26:27], v24, s[8:11], s4 offen sc1
    s_waitcnt vmcnt(0)
    s_memtime s[62:63]
    s_waitcnt lgkmcnt(0)
    s_sub_u32 s3, s62, s60
    s_min_u32 s7, s7, s3
    s_min_u32 s3, s6, s7
    s_cmp_lt_u32 s3, 520
    s_cbranch_scc1 CA_K_S
    s_mov_b32 s4, 9388032
    s_memtime s[60:61]
    s_waitcnt lgkmcnt(0)
    buffer_load_dwordx2 v[26:27], v24, s[8:11], s4 offen sc1
    s_waitcnt vmcnt(0)
    s_memtime s[62:63]
    s_waitcnt lgkmcnt(0)
    s_sub_u32 s3, s62, s60
    s_min_u32 s6, s6, s3
    s_mov_b32 s4, 9396224
    s_memtime s[60:61]
    s_waitcnt lgkmcnt(0)
    buffer_load_dwordx2 v[26:27], v24, s[8:11], s4 offen sc1
    s_waitcnt vmcnt(0)
    s_memtime s[62:63]
    s_waitcnt lgkmcnt(0)
    s_sub_u32 s3, s62, s60
    s_min_u32 s7, s7, s3
    s_min_u32 s3, s6, s7
    s_cmp_lt_u32 s3, 520
    s_cbranch_scc1 CA_K_S
    s_mov_b32 s4, 9392128
    s_memtime s[60:61]
    s_waitcnt lgkmcnt(0)
    buffer_load_dwordx2 v[26:27], v24, s[8:11], s4 offen sc1
    s_waitcnt vmcnt(0)
    s_memtime s[62:63]
    s_waitcnt lgkmcnt(0)
    s_sub_u32 s3, s62, s60
    s_min_u32 s6, s6, s3
    s_mov_b32 s4, 9400320
    s_memtime s[60:61]
    s_waitcnt lgkmcnt(0)
    buffer_load_dwordx2 v[26:27], v24, s[8:11], s4 offen sc1
    s_waitcnt vmcnt(0)
    s_memtime s[62:63]
    s_waitcnt lgkmcnt(0)
    s_sub_u32 s3, s62, s60
    s_min_u32 s7, s7, s3
    s_min_u32 s3, s6, s7
    s_cmp_lt_u32 s3, 520
    s_cbranch_scc1 CA_K_S
    s_mov_b32 s4, 9372160
    s_memtime s[60:61]
    s_waitcnt lgkmcnt(0)
    buffer_load_dwordx2 v[26:27], v24, s[8:11], s4 offen sc1
    s_waitcnt vmcnt(0)
    s_memtime s[62:63]
    s_waitcnt lgkmcnt(0)
    s_sub_u32 s3, s62, s60
    s_min_u32 s6, s6, s3
    s_mov_b32 s4, 9380352
    s_memtime s[60:61]
    s_waitcnt lgkmcnt(0)
    buffer_load_dwordx2 v[26:27], v24, s[8:11], s4 offen sc1
    s_waitcnt vmcnt(0)
    s_memtime s[62:63]
    s_waitcnt lgkmcnt(0)
    s_sub_u32 s3, s62, s60
    s_min_u32 s7, s7, s3
    s_min_u32 s3, s6, s7
    s_cmp_lt_u32 s3, 520
    s_cbranch_scc1 CA_K_S
    s_mov_b32 s4, 9376256
    s_memtime s[60:61]
    s_waitcnt lgkmcnt(0)
    buffer_load_dwordx2 v[26:27], v24, s[8:11], s4 offen sc1
    s_waitcnt vmcnt(0)
    s_memtime s[62:63]
    s_waitcnt lgkmcnt(0)
    s_sub_u32 s3, s62, s60
    s_min_u32 s6, s6, s3
    s_mov_b32 s4, 9384448
    s_memtime s[60:61]
    s_waitcnt lgkmcnt(0)
    buffer_load_dwordx2 v[26:27], v24, s[8:11], s4 offen sc1
    s_waitcnt vmcnt(0)
    s_memtime s[62:63]
    s_waitcnt lgkmcnt(0)
    s_sub_u32 s3, s62, s60
    s_min_u32 s7, s7, s3
    s_min_u32 s3, s6, s7
    s_cmp_lt_u32 s3, 520
    s_cbranch_scc1 CA_K_S
    s_mov_b32 s4, 9388544
    s_memtime s[60:61]
    s_waitcnt lgkmcnt(0)
    buffer_load_dwordx2 v[26:27], v24, s[8:11], s4 offen sc1
    s_waitcnt vmcnt(0)
    s_memtime s[62:63]
    s_waitcnt lgkmcnt(0)
    s_sub_u32 s3, s62, s60
    s_min_u32 s6, s6, s3
    s_mov_b32 s4, 9396736
    s_memtime s[60:61]
    s_waitcnt lgkmcnt(0)
    buffer_load_dwordx2 v[26:27], v24, s[8:11], s4 offen sc1
    s_waitcnt vmcnt(0)
    s_memtime s[62:63]
    s_waitcnt lgkmcnt(0)
    s_sub_u32 s3, s62, s60
    s_min_u32 s7, s7, s3
    s_min_u32 s3, s6, s7
    s_cmp_lt_u32 s3, 520
    s_cbranch_scc1 CA_K_S
    s_mov_b32 s4, 9392640
    s_memtime s[60:61]
    s_waitcnt lgkmcnt(0)
    buffer_load_dwordx2 v[26:27], v24, s[8:11], s4 offen sc1
    s_waitcnt vmcnt(0)
    s_memtime s[62:63]
    s_waitcnt lgkmcnt(0)
    s_sub_u32 s3, s62, s60
    s_min_u32 s6, s6, s3
    s_mov_b32 s4, 9400832
    s_memtime s[60:61]
    s_waitcnt lgkmcnt(0)
    buffer_load_dwordx2 v[26:27], v24, s[8:11], s4 offen sc1
    s_waitcnt vmcnt(0)
    s_memtime s[62:63]
    s_waitcnt lgkmcnt(0)
    s_sub_u32 s3, s62, s60
    s_min_u32 s7, s7, s3
CA_K_S:
    s_cmp_lt_u32 s7, s6
    s_cselect_b32 s40, 1, 0
CA_C_S:
    s_mov_b32 s29, 0
    s_barrier
    s_and_b32 s34, s29, 3
    s_mul_i32 s34, s34, 15360
    s_add_u32 s34, s34, 90112
    s_add_u32 s34, s34, s32
    s_lshr_b32 s25, s29, 2
    s_and_b32 s25, s25, 1
    s_add_u32 s25, s25, 1
    s_lshl_b32 s3, s29, 1
    s_add_u32 s3, s3, s40
    s_add_u32 s3, s3, 2
    v_mov_b32 v11, s3
    s_branch CA_P2_S
    .p2align 6
CA_LOOP_S:
    s_and_b32 s34, s29, 3
    s_mul_i32 s34, s34, 15360
    s_add_u32 s34, s34, 90112
    s_add_u32 s34, s34, s32
    s_lshr_b32 s25, s29, 2
    s_and_b32 s25, s25, 1
    s_add_u32 s25, s25, 1
    s_lshl_b32 s3, s29, 1
    s_add_u32 s3, s3, s40
    s_add_u32 s3, s3, 2
    v_mov_b32 v11, s3
    s_sleep 16
CA_P2_S:
    s_sub_u32 s30, s30, 1
    s_cbranch_scc1 END
    buffer_load_dwordx4 v[24:27], v4, s[8:11], s34 offen offset:0 sc1
    buffer_load_dwordx4 v[28:31], v4, s[8:11], s34 offen offset:1280 sc1
    buffer_load_dwordx4 v[32:35], v4, s[8:11], s34 offen offset:2560 sc1
    buffer_load_dword v36, v5, s[8:11], s34 offen offset:0 sc1
    buffer_load_dword v37, v5, s[8:11], s34 offen offset:1280 sc1
    buffer_load_dword v38, v5, s[8:11], s34 offen offset:2560 sc1
    s_waitcnt vmcnt(5)
    v_bitop3_b32 v40, s25, v24, v25 bitop3:0x80
    v_bitop3_b32 v40, v40, v26, v27 bitop3:0x80
    s_waitcnt vmcnt(4)
    v_pk_add_f32 v[72:73], v[24:25], v[28:29]
    v_pk_add_f32 v[74:75], v[26:27], v[30:31]
    v_bitop3_b32 v40, v40, v28, v29 bitop3:0x80
    v_bitop3_b32 v40, v40, v30, v31 bitop3:0x80
    s_waitcnt vmcnt(3)
    v_pk_add_f32 v[72:73], v[72:73], v[32:33]
    v_pk_add_f32 v[74:75], v[74:75], v[34:35]
    v_bitop3_b32 v40, v40, v32, v33 bitop3:0x80
    v_bitop3_b32 v40, v40, v34, v35 bitop3:0x80
    v_max3_f32 v77, v72, v73, v74
    s_waitcnt vmcnt(0)
    v_bitop3_b32 v40, v40, v36, v37 bitop3:0x80
    v_add_f32 v76, v36, v37
    v_and_b32 v40, v40, v38
    v_add_f32 v76, v76, v38
    v_cmp_eq_u32 vcc, 0, v40
    v_max3_f32 v77, v77, v75, v76
    s_cbranch_vccnz CA_P2_S
    s_nop 0
    v_max_f32_dpp v77, v77, v77 quad_perm:[1,0,3,2] row_mask:0xf bank_mask:0xf
    s_nop 1
    v_max_f32_dpp v77, v77, v77 quad_perm:[2,3,0,1] row_mask:0xf bank_mask:0xf
    v_mov_b32 v78, v77
    s_nop 1
    v_permlane32_swap_b32 v77, v78
    v_max_f32 v77, v77, v78
    v_mul_f32 v78, s24, v77
    v_pk_fma_f32 v[72:73], v[72:73], v[20:21], v[78:79] op_sel_hi:[1,1,0] neg_lo:[0,0,1] neg_hi:[0,0,1]
    v_pk_fma_f32 v[74:75], v[74:75], v[20:21], v[78:79] op_sel_hi:[1,1,0] neg_lo:[0,0,1] neg_hi:[0,0,1]
    v_fma_f32 v76, v76, v20, -v78
    v_exp_f32 v72, v72
    v_exp_f32 v73, v73
    v_exp_f32 v74, v74
    v_exp_f32 v75, v75
    v_exp_f32 v76, v76
    v_pk_add_f32 v[78:79], v[72:73], v[74:75]
    v_add_f32 v77, v78, v76
    v_add_f32 v77, v77, v79
    s_nop 1
    v_add_f32_dpp v77, v77, v77 quad_perm:[1,0,3,2] row_mask:0xf bank_mask:0xf
    s_nop 1
    v_add_f32_dpp v77, v77, v77 quad_perm:[2,3,0,1] row_mask:0xf bank_mask:0xf
    v_mov_b32 v78, v77
    s_nop 1
    v_permlane32_swap_b32 v77, v78
    v_add_f32 v77, v77, v78
    v_rcp_f32 v78, v77
    s_nop 0
    v_pk_mul_f32 v[72:73], v[72:73], v[78:79] op_sel_hi:[1,0]
    v_pk_mul_f32 v[74:75], v[74:75], v[78:79] op_sel_hi:[1,0]
    v_mul_f32 v76, v76, v78
    v_cvt_pk_bf16_f32 v72, v72, v73
    v_cvt_pk_bf16_f32 v73, v74, v75
    v_cvt_pk_bf16_f32 v76, v76, v76
    ds_write_b64 v12, v[72:73]
    ds_write_b16 v13, v76
    s_waitcnt lgkmcnt(0)
    s_barrier
    buffer_store_dword v11, v10, s[8:11], s33 offen sc1
    s_barrier
    s_add_u32 s29, s29, 1
    s_cmp_lt_u32 s29, 63
    s_cbranch_scc1 CA_LOOP_S
    s_waitcnt lgkmcnt(0)
    s_barrier
    s_barrier
    s_waitcnt vmcnt(0)
    s_waitcnt vmcnt(0)
    s_branch END
FFN:
    s_mov_b32 s12, s76
    s_mov_b32 s13, s77
    s_mov_b32 s14, 1966080
    s_mov_b32 s15, 0x00020000
    s_mov_b32 s16, s78
    s_mov_b32 s17, s79
    s_mov_b32 s18, 1966080
    s_mov_b32 s19, 0x00020000
    v_lshrrev_b32 v4, 2, v0
    v_mul_u32_u24 v4, 3072, v4
    v_and_b32 v5, 3, v0
    v_lshl_add_u32 v4, v5, 4, v4
    v_lshrrev_b32 v5, 5, v0
    v_lshlrev_b32 v5, 9, v5
    v_bfe_u32 v6, v0, 2, 2
    v_lshl_add_u32 v5, v6, 6, v5
    v_bfe_u32 v6, v0, 4, 1
    v_lshl_add_u32 v5, v6, 5, v5
    v_and_b32 v6, 3, v0
    v_lshl_add_u32 v5, v6, 3, v5
    s_mul_i32 s34, s26, 10240
    s_add_u32 s34, s34, 81920
    s_cmp_ge_u32 s27, 6
    s_cselect_b32 s3, 6, 0
    s_sub_u32 s46, s27, s3
    s_lshl_b32 s47, s26, 6
    s_add_u32 s48, s47, 3072
    s_lshl_b32 s35, s46, 9
    s_add_u32 s35, s35, s47
    s_mov_b32 s36, 0
    s_mov_b32 s37, 0
    s_mov_b32 s38, s46
    s_mov_b32 s49, 0
    s_add_u32 s3, s34, s37
    s_mov_b32 m0, s3
    s_nop 0
    buffer_load_dwordx4 v4, s[12:15], s35 offen  lds
    s_add_u32 s3, s3, 1024
    s_mov_b32 m0, s3
    s_nop 0
    buffer_load_dwordx4 v4, s[16:19], s35 offen  lds
    s_add_u32 s37, s37, 2048
    s_cmp_eq_u32 s37, 10240
    s_cselect_b32 s37, 0, s37
    s_add_u32 s35, s35, 49152
    s_add_u32 s36, s36, 1
    s_cmp_eq_u32 s36, 40
    s_cselect_b32 s3, 1965568, 0
    s_cselect_b32 s36, 0, s36
    s_sub_u32 s35, s35, s3
    s_cmp_eq_u32 s35, s48
    s_cselect_b32 s35, s47, s35
    s_add_u32 s3, s34, s37
    s_mov_b32 m0, s3
    s_nop 0
    buffer_load_dwordx4 v4, s[12:15], s35 offen  lds
    s_add_u32 s3, s3, 1024
    s_mov_b32 m0, s3
    s_nop 0
    buffer_load_dwordx4 v4, s[16:19], s35 offen  lds
    s_add_u32 s37, s37, 2048
    s_cmp_eq_u32 s37, 10240
    s_cselect_b32 s37, 0, s37
    s_add_u32 s35, s35, 49152
    s_add_u32 s36, s36, 1
    s_cmp_eq_u32 s36, 40
    s_cselect_b32 s3, 1965568, 0
    s_cselect_b32 s36, 0, s36
    s_sub_u32 s35, s35, s3
    s_cmp_eq_u32 s35, s48
    s_cselect_b32 s35, s47, s35
    s_add_u32 s3, s34, s37
    s_mov_b32 m0, s3
    s_nop 0
    buffer_load_dwordx4 v4, s[12:15], s35 offen  lds
    s_add_u32 s3, s3, 1024
    s_mov_b32 m0, s3
    s_nop 0
    buffer_load_dwordx4 v4, s[16:19], s35 offen  lds
    s_add_u32 s37, s37, 2048
    s_cmp_eq_u32 s37, 10240
    s_cselect_b32 s37, 0, s37
    s_add_u32 s35, s35, 49152
    s_add_u32 s36, s36, 1
    s_cmp_eq_u32 s36, 40
    s_cselect_b32 s3, 1965568, 0
    s_cselect_b32 s36, 0, s36
    s_sub_u32 s35, s35, s3
    s_cmp_eq_u32 s35, s48
    s_cselect_b32 s35, s47, s35
    s_add_u32 s3, s34, s37
    s_mov_b32 m0, s3
    s_nop 0
    buffer_load_dwordx4 v4, s[12:15], s35 offen  lds
    s_add_u32 s3, s3, 1024
    s_mov_b32 m0, s3
    s_nop 0
    buffer_load_dwordx4 v4, s[16:19], s35 offen  lds
    s_add_u32 s37, s37, 2048
    s_cmp_eq_u32 s37, 10240
    s_cselect_b32 s37, 0, s37
    s_add_u32 s35, s35, 49152
    s_add_u32 s36, s36, 1
    s_cmp_eq_u32 s36, 40
    s_cselect_b32 s3, 1965568, 0
    s_cselect_b32 s36, 0, s36
    s_sub_u32 s35, s35, s3
    s_cmp_eq_u32 s35, s48
    s_cselect_b32 s35, s47, s35
    s_mov_b32 s39, 0
F1_PASS:
    v_mov_b32 v64, 0
    v_mov_b32 v65, 0
    v_mov_b32 v66, 0
    v_mov_b32 v67, 0
    v_mov_b32 v68, 0
    v_mov_b32 v69, 0
    v_mov_b32 v70, 0
    v_mov_b32 v71, 0
    v_mov_b32 v72, 0
    v_mov_b32 v73, 0
    v_mov_b32 v74, 0
    v_mov_b32 v75, 0
    v_mov_b32 v76, 0
    v_mov_b32 v77, 0
    v_mov_b32 v78, 0
    v_mov_b32 v79, 0
    v_mov_b32 v80, 0
    v_mov_b32 v81, 0
    v_mov_b32 v82, 0
    v_mov_b32 v83, 0
    v_mov_b32 v84, 0
    v_mov_b32 v85, 0
    v_mov_b32 v86, 0
    v_mov_b32 v87, 0
    v_mov_b32 v88, 0
    v_mov_b32 v89, 0
    v_mov_b32 v90, 0
    v_mov_b32 v91, 0
    v_mov_b32 v92, 0
    v_mov_b32 v93, 0
    v_mov_b32 v94, 0
    v_mov_b32 v95, 0
    v_mov_b32 v96, 0
    v_mov_b32 v97, 0
    v_mov_b32 v98, 0
    v_mov_b32 v99, 0
    v_mov_b32 v100, 0
    v_mov_b32 v101, 0
    v_mov_b32 v102, 0
    v_mov_b32 v103, 0
    v_mov_b32 v104, 0
    v_mov_b32 v105, 0
    v_mov_b32 v106, 0
    v_mov_b32 v107, 0
    v_mov_b32 v108, 0
    v_mov_b32 v109, 0
    v_mov_b32 v110, 0
    v_mov_b32 v111, 0
    v_mov_b32 v112, 0
    v_mov_b32 v113, 0
    v_mov_b32 v114, 0
    v_mov_b32 v115, 0
    v_mov_b32 v116, 0
    v_mov_b32 v117, 0
    v_mov_b32 v118, 0
    v_mov_b32 v119, 0
    v_mov_b32 v120, 0
    v_mov_b32 v121, 0
    v_mov_b32 v122, 0
    v_mov_b32 v123, 0
    v_mov_b32 v124, 0
    v_mov_b32 v125, 0
    v_mov_b32 v126, 0
    v_mov_b32 v127, 0
    v_mov_b32 v6, v2
    s_mov_b32 s40, 0
F1_K:
    s_add_u32 s3, s34, s39
    v_add_u32 v7, s3, v5
    s_waitcnt vmcnt(6)
    ds_read_b64_tr_b16 v[16:17], v7
    ds_read_b64_tr_b16 v[18:19], v7 offset:256
    ds_read_b128 v[24:27], v6
    ds_read_b128 v[28:31], v6 offset:40960
    ds_read_b64_tr_b16 v[20:21], v7 offset:1024
    ds_read_b64_tr_b16 v[22:23], v7 offset:1280
    s_add_u32 s3, s34, s37
    s_mov_b32 m0, s3
    s_nop 0
    buffer_load_dwordx4 v4, s[12:15], s35 offen  lds
    s_add_u32 s3, s3, 1024
    s_mov_b32 m0, s3
    s_nop 0
    buffer_load_dwordx4 v4, s[16:19], s35 offen  lds
    s_add_u32 s37, s37, 2048
    s_cmp_eq_u32 s37, 10240
    s_cselect_b32 s37, 0, s37
    s_add_u32 s35, s35, 49152
    s_add_u32 s36, s36, 1
    s_cmp_eq_u32 s36, 40
    s_cselect_b32 s3, 1965568, 0
    s_cselect_b32 s36, 0, s36
    s_sub_u32 s35, s35, s3
    s_cmp_eq_u32 s35, s48
    s_cselect_b32 s35, s47, s35
    s_add_u32 s39, s39, 2048
    s_cmp_eq_u32 s39, 10240
    s_cselect_b32 s39, 0, s39
    v_add_u32 v6, 1024, v6
    s_waitcnt lgkmcnt(3)
    v_mfma_f32_32x32x16_bf16 v[64:79], v[16:19], v[24:27], v[64:79]
    s_waitcnt lgkmcnt(2)
    v_mfma_f32_32x32x16_bf16 v[80:95], v[16:19], v[28:31], v[80:95]
    s_waitcnt lgkmcnt(0)
    v_mfma_f32_32x32x16_bf16 v[96:111], v[20:23], v[24:27], v[96:111]
    v_mfma_f32_32x32x16_bf16 v[112:127], v[20:23], v[28:31], v[112:127]
    s_add_u32 s40, s40, 1
    s_cmp_lt_u32 s40, 40
    s_cbranch_scc1 F1_K
    s_mov_b32 s3, 0x3fb8aa3b
    s_nop 2
    v_cvt_pk_bf16_f32 v16, v64, v65
    v_lshlrev_b32 v64, 16, v16
    v_and_b32 v65, 0xffff0000, v16
    v_mul_f32 v16, s3, v64
    v_mul_f32 v17, s3, v65
    v_exp_f32 v16, -v16
    v_exp_f32 v17, -v17
    v_add_f32 v16, 1.0, v16
    v_add_f32 v17, 1.0, v17
    v_rcp_f32 v16, v16
    v_rcp_f32 v17, v17
    s_nop 0
    v_pk_mul_f32 v[64:65], v[64:65], v[16:17]
    v_cvt_pk_bf16_f32 v16, v64, v65
    v_lshlrev_b32 v64, 16, v16
    v_and_b32 v65, 0xffff0000, v16
    v_cvt_pk_bf16_f32 v16, v96, v97
    v_lshlrev_b32 v96, 16, v16
    v_and_b32 v97, 0xffff0000, v16
    v_pk_mul_f32 v[64:65], v[64:65], v[96:97]
    v_cvt_pk_bf16_f32 v18, v66, v67
    v_lshlrev_b32 v66, 16, v18
    v_and_b32 v67, 0xffff0000, v18
    v_mul_f32 v18, s3, v66
    v_mul_f32 v19, s3, v67
    v_exp_f32 v18, -v18
    v_exp_f32 v19, -v19
    v_add_f32 v18, 1.0, v18
    v_add_f32 v19, 1.0, v19
    v_rcp_f32 v18, v18
    v_rcp_f32 v19, v19
    s_nop 0
    v_pk_mul_f32 v[66:67], v[66:67], v[18:19]
    v_cvt_pk_bf16_f32 v18, v66, v67
    v_lshlrev_b32 v66, 16, v18
    v_and_b32 v67, 0xffff0000, v18
    v_cvt_pk_bf16_f32 v18, v98, v99
    v_lshlrev_b32 v98, 16, v18
    v_and_b32 v99, 0xffff0000, v18
    v_pk_mul_f32 v[66:67], v[66:67], v[98:99]
    v_cvt_pk_bf16_f32 v20, v68, v69
    v_lshlrev_b32 v68, 16, v20
    v_and_b32 v69, 0xffff0000, v20
    v_mul_f32 v20, s3, v68
    v_mul_f32 v21, s3, v69
    v_exp_f32 v20, -v20
    v_exp_f32 v21, -v21
    v_add_f32 v20, 1.0, v20
    v_add_f32 v21, 1.0, v21
    v_rcp_f32 v20, v20
    v_rcp_f32 v21, v21
    s_nop 0
    v_pk_mul_f32 v[68:69], v[68:69], v[20:21]
    v_cvt_pk_bf16_f32 v20, v68, v69
    v_lshlrev_b32 v68, 16, v20
    v_and_b32 v69, 0xffff0000, v20
    v_cvt_pk_bf16_f32 v20, v100, v101
    v_lshlrev_b32 v100, 16, v20
    v_and_b32 v101, 0xffff0000, v20
    v_pk_mul_f32 v[68:69], v[68:69], v[100:101]
    v_cvt_pk_bf16_f32 v22, v70, v71
    v_lshlrev_b32 v70, 16, v22
    v_and_b32 v71, 0xffff0000, v22
    v_mul_f32 v22, s3, v70
    v_mul_f32 v23, s3, v71
    v_exp_f32 v22, -v22
    v_exp_f32 v23, -v23
    v_add_f32 v22, 1.0, v22
    v_add_f32 v23, 1.0, v23
    v_rcp_f32 v22, v22
    v_rcp_f32 v23, v23
    s_nop 0
    v_pk_mul_f32 v[70:71], v[70:71], v[22:23]
    v_cvt_pk_bf16_f32 v22, v70, v71
    v_lshlrev_b32 v70, 16, v22
    v_and_b32 v71, 0xffff0000, v22
    v_cvt_pk_bf16_f32 v22, v102, v103
    v_lshlrev_b32 v102, 16, v22
    v_and_b32 v103, 0xffff0000, v22
    v_pk_mul_f32 v[70:71], v[70:71], v[102:103]
    v_cvt_pk_bf16_f32 v16, v72, v73
    v_lshlrev_b32 v72, 16, v16
    v_and_b32 v73, 0xffff0000, v16
    v_mul_f32 v16, s3, v72
    v_mul_f32 v17, s3, v73
    v_exp_f32 v16, -v16
    v_exp_f32 v17, -v17
    v_add_f32 v16, 1.0, v16
    v_add_f32 v17, 1.0, v17
    v_rcp_f32 v16, v16
    v_rcp_f32 v17, v17
    s_nop 0
    v_pk_mul_f32 v[72:73], v[72:73], v[16:17]
    v_cvt_pk_bf16_f32 v16, v72, v73
    v_lshlrev_b32 v72, 16, v16
    v_and_b32 v73, 0xffff0000, v16
    v_cvt_pk_bf16_f32 v16, v104, v105
    v_lshlrev_b32 v104, 16, v16
    v_and_b32 v105, 0xffff0000, v16
    v_pk_mul_f32 v[72:73], v[72:73], v[104:105]
    v_cvt_pk_bf16_f32 v18, v74, v75
    v_lshlrev_b32 v74, 16, v18
    v_and_b32 v75, 0xffff0000, v18
    v_mul_f32 v18, s3, v74
    v_mul_f32 v19, s3, v75
    v_exp_f32 v18, -v18
    v_exp_f32 v19, -v19
    v_add_f32 v18, 1.0, v18
    v_add_f32 v19, 1.0, v19
    v_rcp_f32 v18, v18
    v_rcp_f32 v19, v19
    s_nop 0
    v_pk_mul_f32 v[74:75], v[74:75], v[18:19]
    v_cvt_pk_bf16_f32 v18, v74, v75
    v_lshlrev_b32 v74, 16, v18
    v_and_b32 v75, 0xffff0000, v18
    v_cvt_pk_bf16_f32 v18, v106, v107
    v_lshlrev_b32 v106, 16, v18
    v_and_b32 v107, 0xffff0000, v18
    v_pk_mul_f32 v[74:75], v[74:75], v[106:107]
    v_cvt_pk_bf16_f32 v20, v76, v77
    v_lshlrev_b32 v76, 16, v20
    v_and_b32 v77, 0xffff0000, v20
    v_mul_f32 v20, s3, v76
    v_mul_f32 v21, s3, v77
    v_exp_f32 v20, -v20
    v_exp_f32 v21, -v21
    v_add_f32 v20, 1.0, v20
    v_add_f32 v21, 1.0, v21
    v_rcp_f32 v20, v20
    v_rcp_f32 v21, v21
    s_nop 0
    v_pk_mul_f32 v[76:77], v[76:77], v[20:21]
    v_cvt_pk_bf16_f32 v20, v76, v77
    v_lshlrev_b32 v76, 16, v20
    v_and_b32 v77, 0xffff0000, v20
    v_cvt_pk_bf16_f32 v20, v108, v109
    v_lshlrev_b32 v108, 16, v20
    v_and_b32 v109, 0xffff0000, v20
    v_pk_mul_f32 v[76:77], v[76:77], v[108:109]
    v_cvt_pk_bf16_f32 v22, v78, v79
    v_lshlrev_b32 v78, 16, v22
    v_and_b32 v79, 0xffff0000, v22
    v_mul_f32 v22, s3, v78
    v_mul_f32 v23, s3, v79
    v_exp_f32 v22, -v22
    v_exp_f32 v23, -v23
    v_add_f32 v22, 1.0, v22
    v_add_f32 v23, 1.0, v23
    v_rcp_f32 v22, v22
    v_rcp_f32 v23, v23
    s_nop 0
    v_pk_mul_f32 v[78:79], v[78:79], v[22:23]
    v_cvt_pk_bf16_f32 v22, v78, v79
    v_lshlrev_b32 v78, 16, v22
    v_and_b32 v79, 0xffff0000, v22
    v_cvt_pk_bf16_f32 v22, v110, v111
    v_lshlrev_b32 v110, 16, v22
    v_and_b32 v111, 0xffff0000, v22
    v_pk_mul_f32 v[78:79], v[78:79], v[110:111]
    v_cvt_pk_bf16_f32 v16, v80, v81
    v_lshlrev_b32 v80, 16, v16
    v_and_b32 v81, 0xffff0000, v16
    v_mul_f32 v16, s3, v80
    v_mul_f32 v17, s3, v81
    v_exp_f32 v16, -v16
    v_exp_f32 v17, -v17
    v_add_f32 v16, 1.0, v16
    v_add_f32 v17, 1.0, v17
    v_rcp_f32 v16, v16
    v_rcp_f32 v17, v17
    s_nop 0
    v_pk_mul_f32 v[80:81], v[80:81], v[16:17]
    v_cvt_pk_bf16_f32 v16, v80, v81
    v_lshlrev_b32 v80, 16, v16
    v_and_b32 v81, 0xffff0000, v16
    v_cvt_pk_bf16_f32 v16, v112, v113
    v_lshlrev_b32 v112, 16, v16
    v_and_b32 v113, 0xffff0000, v16
    v_pk_mul_f32 v[80:81], v[80:81], v[112:113]
    v_cvt_pk_bf16_f32 v18, v82, v83
    v_lshlrev_b32 v82, 16, v18
    v_and_b32 v83, 0xffff0000, v18
    v_mul_f32 v18, s3, v82
    v_mul_f32 v19, s3, v83
    v_exp_f32 v18, -v18
    v_exp_f32 v19, -v19
    v_add_f32 v18, 1.0, v18
    v_add_f32 v19, 1.0, v19
    v_rcp_f32 v18, v18
    v_rcp_f32 v19, v19
    s_nop 0
    v_pk_mul_f32 v[82:83], v[82:83], v[18:19]
    v_cvt_pk_bf16_f32 v18, v82, v83
    v_lshlrev_b32 v82, 16, v18
    v_and_b32 v83, 0xffff0000, v18
    v_cvt_pk_bf16_f32 v18, v114, v115
    v_lshlrev_b32 v114, 16, v18
    v_and_b32 v115, 0xffff0000, v18
    v_pk_mul_f32 v[82:83], v[82:83], v[114:115]
    v_cvt_pk_bf16_f32 v20, v84, v85
    v_lshlrev_b32 v84, 16, v20
    v_and_b32 v85, 0xffff0000, v20
    v_mul_f32 v20, s3, v84
    v_mul_f32 v21, s3, v85
    v_exp_f32 v20, -v20
    v_exp_f32 v21, -v21
    v_add_f32 v20, 1.0, v20
    v_add_f32 v21, 1.0, v21
    v_rcp_f32 v20, v20
    v_rcp_f32 v21, v21
    s_nop 0
    v_pk_mul_f32 v[84:85], v[84:85], v[20:21]
    v_cvt_pk_bf16_f32 v20, v84, v85
    v_lshlrev_b32 v84, 16, v20
    v_and_b32 v85, 0xffff0000, v20
    v_cvt_pk_bf16_f32 v20, v116, v117
    v_lshlrev_b32 v116, 16, v20
    v_and_b32 v117, 0xffff0000, v20
    v_pk_mul_f32 v[84:85], v[84:85], v[116:117]
    v_cvt_pk_bf16_f32 v22, v86, v87
    v_lshlrev_b32 v86, 16, v22
    v_and_b32 v87, 0xffff0000, v22
    v_mul_f32 v22, s3, v86
    v_mul_f32 v23, s3, v87
    v_exp_f32 v22, -v22
    v_exp_f32 v23, -v23
    v_add_f32 v22, 1.0, v22
    v_add_f32 v23, 1.0, v23
    v_rcp_f32 v22, v22
    v_rcp_f32 v23, v23
    s_nop 0
    v_pk_mul_f32 v[86:87], v[86:87], v[22:23]
    v_cvt_pk_bf16_f32 v22, v86, v87
    v_lshlrev_b32 v86, 16, v22
    v_and_b32 v87, 0xffff0000, v22
    v_cvt_pk_bf16_f32 v22, v118, v119
    v_lshlrev_b32 v118, 16, v22
    v_and_b32 v119, 0xffff0000, v22
    v_pk_mul_f32 v[86:87], v[86:87], v[118:119]
    v_cvt_pk_bf16_f32 v16, v88, v89
    v_lshlrev_b32 v88, 16, v16
    v_and_b32 v89, 0xffff0000, v16
    v_mul_f32 v16, s3, v88
    v_mul_f32 v17, s3, v89
    v_exp_f32 v16, -v16
    v_exp_f32 v17, -v17
    v_add_f32 v16, 1.0, v16
    v_add_f32 v17, 1.0, v17
    v_rcp_f32 v16, v16
    v_rcp_f32 v17, v17
    s_nop 0
    v_pk_mul_f32 v[88:89], v[88:89], v[16:17]
    v_cvt_pk_bf16_f32 v16, v88, v89
    v_lshlrev_b32 v88, 16, v16
    v_and_b32 v89, 0xffff0000, v16
    v_cvt_pk_bf16_f32 v16, v120, v121
    v_lshlrev_b32 v120, 16, v16
    v_and_b32 v121, 0xffff0000, v16
    v_pk_mul_f32 v[88:89], v[88:89], v[120:121]
    v_cvt_pk_bf16_f32 v18, v90, v91
    v_lshlrev_b32 v90, 16, v18
    v_and_b32 v91, 0xffff0000, v18
    v_mul_f32 v18, s3, v90
    v_mul_f32 v19, s3, v91
    v_exp_f32 v18, -v18
    v_exp_f32 v19, -v19
    v_add_f32 v18, 1.0, v18
    v_add_f32 v19, 1.0, v19
    v_rcp_f32 v18, v18
    v_rcp_f32 v19, v19
    s_nop 0
    v_pk_mul_f32 v[90:91], v[90:91], v[18:19]
    v_cvt_pk_bf16_f32 v18, v90, v91
    v_lshlrev_b32 v90, 16, v18
    v_and_b32 v91, 0xffff0000, v18
    v_cvt_pk_bf16_f32 v18, v122, v123
    v_lshlrev_b32 v122, 16, v18
    v_and_b32 v123, 0xffff0000, v18
    v_pk_mul_f32 v[90:91], v[90:91], v[122:123]
    v_cvt_pk_bf16_f32 v20, v92, v93
    v_lshlrev_b32 v92, 16, v20
    v_and_b32 v93, 0xffff0000, v20
    v_mul_f32 v20, s3, v92
    v_mul_f32 v21, s3, v93
    v_exp_f32 v20, -v20
    v_exp_f32 v21, -v21
    v_add_f32 v20, 1.0, v20
    v_add_f32 v21, 1.0, v21
    v_rcp_f32 v20, v20
    v_rcp_f32 v21, v21
    s_nop 0
    v_pk_mul_f32 v[92:93], v[92:93], v[20:21]
    v_cvt_pk_bf16_f32 v20, v92, v93
    v_lshlrev_b32 v92, 16, v20
    v_and_b32 v93, 0xffff0000, v20
    v_cvt_pk_bf16_f32 v20, v124, v125
    v_lshlrev_b32 v124, 16, v20
    v_and_b32 v125, 0xffff0000, v20
    v_pk_mul_f32 v[92:93], v[92:93], v[124:125]
    v_cvt_pk_bf16_f32 v22, v94, v95
    v_lshlrev_b32 v94, 16, v22
    v_and_b32 v95, 0xffff0000, v22
    v_mul_f32 v22, s3, v94
    v_mul_f32 v23, s3, v95
    v_exp_f32 v22, -v22
    v_exp_f32 v23, -v23
    v_add_f32 v22, 1.0, v22
    v_add_f32 v23, 1.0, v23
    v_rcp_f32 v22, v22
    v_rcp_f32 v23, v23
    s_nop 0
    v_pk_mul_f32 v[94:95], v[94:95], v[22:23]
    v_cvt_pk_bf16_f32 v22, v94, v95
    v_lshlrev_b32 v94, 16, v22
    v_and_b32 v95, 0xffff0000, v22
    v_cvt_pk_bf16_f32 v22, v126, v127
    v_lshlrev_b32 v126, 16, v22
    v_and_b32 v127, 0xffff0000, v22
    v_pk_mul_f32 v[94:95], v[94:95], v[126:127]
    s_cmp_lg_u32 s38, 0
    s_cbranch_scc1 F1S_70
    v_cvt_pk_bf16_f32 v160, v64, v65
    v_cvt_pk_bf16_f32 v161, v66, v67
    v_cvt_pk_bf16_f32 v162, v68, v69
    v_cvt_pk_bf16_f32 v163, v70, v71
    v_cvt_pk_bf16_f32 v164, v72, v73
    v_cvt_pk_bf16_f32 v165, v74, v75
    v_cvt_pk_bf16_f32 v166, v76, v77
    v_cvt_pk_bf16_f32 v167, v78, v79
    v_cvt_pk_bf16_f32 v168, v80, v81
    v_cvt_pk_bf16_f32 v169, v82, v83
    v_cvt_pk_bf16_f32 v170, v84, v85
    v_cvt_pk_bf16_f32 v171, v86, v87
    v_cvt_pk_bf16_f32 v172, v88, v89
    v_cvt_pk_bf16_f32 v173, v90, v91
    v_cvt_pk_bf16_f32 v174, v92, v93
    v_cvt_pk_bf16_f32 v175, v94, v95
    s_branch F1_NEXT
F1S_70:
    s_cmp_lg_u32 s38, 1
    s_cbranch_scc1 F1S_71
    v_cvt_pk_bf16_f32 v176, v64, v65
    v_cvt_pk_bf16_f32 v177, v66, v67
    v_cvt_pk_bf16_f32 v178, v68, v69
    v_cvt_pk_bf16_f32 v179, v70, v71
    v_cvt_pk_bf16_f32 v180, v72, v73
    v_cvt_pk_bf16_f32 v181, v74, v75
    v_cvt_pk_bf16_f32 v182, v76, v77
    v_cvt_pk_bf16_f32 v183, v78, v79
    v_cvt_pk_bf16_f32 v184, v80, v81
    v_cvt_pk_bf16_f32 v185, v82, v83
    v_cvt_pk_bf16_f32 v186, v84, v85
    v_cvt_pk_bf16_f32 v187, v86, v87
    v_cvt_pk_bf16_f32 v188, v88, v89
    v_cvt_pk_bf16_f32 v189, v90, v91
    v_cvt_pk_bf16_f32 v190, v92, v93
    v_cvt_pk_bf16_f32 v191, v94, v95
    s_branch F1_NEXT
F1S_71:
    s_cmp_lg_u32 s38, 2
    s_cbranch_scc1 F1S_72
    v_cvt_pk_bf16_f32 v192, v64, v65
    v_cvt_pk_bf16_f32 v193, v66, v67
    v_cvt_pk_bf16_f32 v194, v68, v69
    v_cvt_pk_bf16_f32 v195, v70, v71
    v_cvt_pk_bf16_f32 v196, v72, v73
    v_cvt_pk_bf16_f32 v197, v74, v75
    v_cvt_pk_bf16_f32 v198, v76, v77
    v_cvt_pk_bf16_f32 v199, v78, v79
    v_cvt_pk_bf16_f32 v200, v80, v81
    v_cvt_pk_bf16_f32 v201, v82, v83
    v_cvt_pk_bf16_f32 v202, v84, v85
    v_cvt_pk_bf16_f32 v203, v86, v87
    v_cvt_pk_bf16_f32 v204, v88, v89
    v_cvt_pk_bf16_f32 v205, v90, v91
    v_cvt_pk_bf16_f32 v206, v92, v93
    v_cvt_pk_bf16_f32 v207, v94, v95
    s_branch F1_NEXT
F1S_72:
    s_cmp_lg_u32 s38, 3
    s_cbranch_scc1 F1S_73
    v_cvt_pk_bf16_f32 v208, v64, v65
    v_cvt_pk_bf16_f32 v209, v66, v67
    v_cvt_pk_bf16_f32 v210, v68, v69
    v_cvt_pk_bf16_f32 v211, v70, v71
    v_cvt_pk_bf16_f32 v212, v72, v73
    v_cvt_pk_bf16_f32 v213, v74, v75
    v_cvt_pk_bf16_f32 v214, v76, v77
    v_cvt_pk_bf16_f32 v215, v78, v79
    v_cvt_pk_bf16_f32 v216, v80, v81
    v_cvt_pk_bf16_f32 v217, v82, v83
    v_cvt_pk_bf16_f32 v218, v84, v85
    v_cvt_pk_bf16_f32 v219, v86, v87
    v_cvt_pk_bf16_f32 v220, v88, v89
    v_cvt_pk_bf16_f32 v221, v90, v91
    v_cvt_pk_bf16_f32 v222, v92, v93
    v_cvt_pk_bf16_f32 v223, v94, v95
    s_branch F1_NEXT
F1S_73:
    s_cmp_lg_u32 s38, 4
    s_cbranch_scc1 F1S_74
    v_cvt_pk_bf16_f32 v224, v64, v65
    v_cvt_pk_bf16_f32 v225, v66, v67
    v_cvt_pk_bf16_f32 v226, v68, v69
    v_cvt_pk_bf16_f32 v227, v70, v71
    v_cvt_pk_bf16_f32 v228, v72, v73
    v_cvt_pk_bf16_f32 v229, v74, v75
    v_cvt_pk_bf16_f32 v230, v76, v77
    v_cvt_pk_bf16_f32 v231, v78, v79
    v_cvt_pk_bf16_f32 v232, v80, v81
    v_cvt_pk_bf16_f32 v233, v82, v83
    v_cvt_pk_bf16_f32 v234, v84, v85
    v_cvt_pk_bf16_f32 v235, v86, v87
    v_cvt_pk_bf16_f32 v236, v88, v89
    v_cvt_pk_bf16_f32 v237, v90, v91
    v_cvt_pk_bf16_f32 v238, v92, v93
    v_cvt_pk_bf16_f32 v239, v94, v95
    s_branch F1_NEXT
F1S_74:
    v_cvt_pk_bf16_f32 v240, v64, v65
    v_cvt_pk_bf16_f32 v241, v66, v67
    v_cvt_pk_bf16_f32 v242, v68, v69
    v_cvt_pk_bf16_f32 v243, v70, v71
    v_cvt_pk_bf16_f32 v244, v72, v73
    v_cvt_pk_bf16_f32 v245, v74, v75
    v_cvt_pk_bf16_f32 v246, v76, v77
    v_cvt_pk_bf16_f32 v247, v78, v79
    v_cvt_pk_bf16_f32 v248, v80, v81
    v_cvt_pk_bf16_f32 v249, v82, v83
    v_cvt_pk_bf16_f32 v250, v84, v85
    v_cvt_pk_bf16_f32 v251, v86, v87
    v_cvt_pk_bf16_f32 v252, v88, v89
    v_cvt_pk_bf16_f32 v253, v90, v91
    v_cvt_pk_bf16_f32 v254, v92, v93
    v_cvt_pk_bf16_f32 v255, v94, v95
F1_NEXT:
    s_add_u32 s38, s38, 1
    s_cmp_eq_u32 s38, 6
    s_cselect_b32 s38, 0, s38
    s_add_u32 s49, s49, 1
    s_cmp_lt_u32 s49, 6
    s_cbranch_scc1 F1_PASS
    s_waitcnt vmcnt(0)
    s_barrier
    s_mov_b32 s12, s80
    s_mov_b32 s13, s81
    s_mov_b32 s14, 1966080
    s_mov_b32 s15, 0x00020000
    v_add_u32 v7, 0, v0
    v_mul_u32_u24 v13, 6554, v7
    v_lshrrev_b32 v13, 16, v13
    v_mul_u32_u24 v14, 10, v13
    v_sub_u32 v7, v7, v14
    v_mul_u32_u24 v13, 1280, v13
    v_lshl_add_u32 v8, v7, 4, v13
    v_add_u32 v7, 64, v0
    v_mul_u32_u24 v13, 6554, v7
    v_lshrrev_b32 v13, 16, v13
    v_mul_u32_u24 v14, 10, v13
    v_sub_u32 v7, v7, v14
    v_mul_u32_u24 v13, 1280, v13
    v_lshl_add_u32 v9, v7, 4, v13
    v_add_u32 v7, 128, v0
    v_mul_u32_u24 v13, 6554, v7
    v_lshrrev_b32 v13, 16, v13
    v_mul_u32_u24 v14, 10, v13
    v_sub_u32 v7, v7, v14
    v_mul_u32_u24 v13, 1280, v13
    v_lshl_add_u32 v10, v7, 4, v13
    v_add_u32 v7, 192, v0
    v_mul_u32_u24 v13, 6554, v7
    v_lshrrev_b32 v13, 16, v13
    v_mul_u32_u24 v14, 10, v13
    v_sub_u32 v7, v7, v14
    v_mul_u32_u24 v13, 1280, v13
    v_lshl_add_u32 v11, v7, 4, v13
    v_add_u32 v7, 256, v0
    v_mul_u32_u24 v13, 6554, v7
    v_lshrrev_b32 v13, 16, v13
    v_mul_u32_u24 v14, 10, v13
    v_sub_u32 v7, v7, v14
    v_mul_u32_u24 v13, 1280, v13
    v_lshl_add_u32 v12, v7, 4, v13
    v_lshrrev_b32 v5, 5, v0
    v_lshlrev_b32 v5, 4, v5
    v_bfe_u32 v6, v0, 2, 3
    v_add_u32 v5, v5, v6
    v_mul_u32_u24 v5, 160, v5
    v_and_b32 v6, 3, v0
    v_lshl_add_u32 v5, v6, 3, v5
    v_bfe_u32 v13, v0, 4, 1
    v_lshlrev_b32 v13, 10, v13
    v_lshrrev_b32 v14, 5, v0
    v_lshl_add_u32 v13, v14, 8, v13
    v_and_b32 v14, 15, v0
    v_lshl_add_u32 v13, v14, 4, v13
    s_lshl_b32 s3, s26, 12
    v_add_u32 v13, s3, v13
    s_lshl_b32 s34, s26, 14
    s_add_u32 s34, s34, 32768
    s_mul_i32 s47, s26, 160
    s_add_u32 s48, s47, 1966080
    s_mul_i32 s35, s46, 327680
    s_add_u32 s35, s35, s47
    s_mov_b32 s37, 0
    s_mov_b32 s39, 0
    s_mov_b32 s40, 0
    s_add_u32 s3, s34, s37
    s_mov_b32 m0, s3
    s_nop 0
    buffer_load_dwordx4 v8, s[12:15], s35 offen  lds
    s_add_u32 s3, s3, 1024
    s_mov_b32 m0, s3
    s_nop 0
    buffer_load_dwordx4 v9, s[12:15], s35 offen  lds
    s_add_u32 s3, s3, 1024
    s_mov_b32 m0, s3
    s_nop 0
    buffer_load_dwordx4 v10, s[12:15], s35 offen  lds
    s_add_u32 s3, s3, 1024
    s_mov_b32 m0, s3
    s_nop 0
    buffer_load_dwordx4 v11, s[12:15], s35 offen  lds
    s_add_u32 s3, s3, 1024
    s_mov_b32 m0, s3
    s_nop 0
    buffer_load_dwordx4 v12, s[12:15], s35 offen  lds
    s_add_u32 s37, s37, 5120
    s_cmp_eq_u32 s37, 15360
    s_cselect_b32 s37, 0, s37
    s_add_u32 s35, s35, 40960
    s_cmp_eq_u32 s35, s48
    s_cselect_b32 s35, s47, s35
    s_add_u32 s3, s34, s37
    s_mov_b32 m0, s3
    s_nop 0
    buffer_load_dwordx4 v8, s[12:15], s35 offen  lds
    s_add_u32 s3, s3, 1024
    s_mov_b32 m0, s3
    s_nop 0
    buffer_load_dwordx4 v9, s[12:15], s35 offen  lds
    s_add_u32 s3, s3, 1024
    s_mov_b32 m0, s3
    s_nop 0
    buffer_load_dwordx4 v10, s[12:15], s35 offen  lds
    s_add_u32 s3, s3, 1024
    s_mov_b32 m0, s3
    s_nop 0
    buffer_load_dwordx4 v11, s[12:15], s35 offen  lds
    s_add_u32 s3, s3, 1024
    s_mov_b32 m0, s3
    s_nop 0
    buffer_load_dwordx4 v12, s[12:15], s35 offen  lds
    s_add_u32 s37, s37, 5120
    s_cmp_eq_u32 s37, 15360
    s_cselect_b32 s37, 0, s37
    s_add_u32 s35, s35, 40960
    s_cmp_eq_u32 s35, s48
    s_cselect_b32 s35, s47, s35
    v_mov_b32 v64, 0
    v_mov_b32 v65, 0
    v_mov_b32 v66, 0
    v_mov_b32 v67, 0
    v_mov_b32 v68, 0
    v_mov_b32 v69, 0
    v_mov_b32 v70, 0
    v_mov_b32 v71, 0
    v_mov_b32 v72, 0
    v_mov_b32 v73, 0
    v_mov_b32 v74, 0
    v_mov_b32 v75, 0
    v_mov_b32 v76, 0
    v_mov_b32 v77, 0
    v_mov_b32 v78, 0
    v_mov_b32 v79, 0
    v_mov_b32 v80, 0
    v_mov_b32 v81, 0
    v_mov_b32 v82, 0
    v_mov_b32 v83, 0
    v_mov_b32 v84, 0
    v_mov_b32 v85, 0
    v_mov_b32 v86, 0
    v_mov_b32 v87, 0
    v_mov_b32 v88, 0
    v_mov_b32 v89, 0
    v_mov_b32 v90, 0
    v_mov_b32 v91, 0
    v_mov_b32 v92, 0
    v_mov_b32 v93, 0
    v_mov_b32 v94, 0
    v_mov_b32 v95, 0
    v_mov_b32 v96, 0
    v_mov_b32 v97, 0
    v_mov_b32 v98, 0
    v_mov_b32 v99, 0
    v_mov_b32 v100, 0
    v_mov_b32 v101, 0
    v_mov_b32 v102, 0
    v_mov_b32 v103, 0
    v_mov_b32 v104, 0
    v_mov_b32 v105, 0
    v_mov_b32 v106, 0
    v_mov_b32 v107, 0
    v_mov_b32 v108, 0
    v_mov_b32 v109, 0
    v_mov_b32 v110, 0
    v_mov_b32 v111, 0
    v_mov_b32 v112, 0
    v_mov_b32 v113, 0
    v_mov_b32 v114, 0
    v_mov_b32 v115, 0
    v_mov_b32 v116, 0
    v_mov_b32 v117, 0
    v_mov_b32 v118, 0
    v_mov_b32 v119, 0
    v_mov_b32 v120, 0
    v_mov_b32 v121, 0
    v_mov_b32 v122, 0
    v_mov_b32 v123, 0
    v_mov_b32 v124, 0
    v_mov_b32 v125, 0
    v_mov_b32 v126, 0
    v_mov_b32 v127, 0
    v_mov_b32 v128, 0
    v_mov_b32 v129, 0
    v_mov_b32 v130, 0
    v_mov_b32 v131, 0
    v_mov_b32 v132, 0
    v_mov_b32 v133, 0
    v_mov_b32 v134, 0
    v_mov_b32 v135, 0
    v_mov_b32 v136, 0
    v_mov_b32 v137, 0
    v_mov_b32 v138, 0
    v_mov_b32 v139, 0
    v_mov_b32 v140, 0
    v_mov_b32 v141, 0
    v_mov_b32 v142, 0
    v_mov_b32 v143, 0
F2_K:
    s_and_b32 s3, s40, 7
    s_cmp_lg_u32 s3, 0
    s_cbranch_scc1 F2_M
    s_barrier
    s_mov_b32 s3, s38
    s_add_u32 s38, s38, 1
    s_cmp_eq_u32 s38, 6
    s_cselect_b32 s38, 0, s38
    s_cmp_lg_u32 s3, 0
    s_cbranch_scc1 F2S_76
    ds_write_b128 v13, v[160:163] offset:0
    ds_write_b128 v13, v[164:167] offset:512
    ds_write_b128 v13, v[168:171] offset:2048
    ds_write_b128 v13, v[172:175] offset:2560
    s_branch F2_W
F2S_76:
    s_cmp_lg_u32 s3, 1
    s_cbranch_scc1 F2S_77
    ds_write_b128 v13, v[176:179] offset:0
    ds_write_b128 v13, v[180:183] offset:512
    ds_write_b128 v13, v[184:187] offset:2048
    ds_write_b128 v13, v[188:191] offset:2560
    s_branch F2_W
F2S_77:
    s_cmp_lg_u32 s3, 2
    s_cbranch_scc1 F2S_78
    ds_write_b128 v13, v[192:195] offset:0
    ds_write_b128 v13, v[196:199] offset:512
    ds_write_b128 v13, v[200:203] offset:2048
    ds_write_b128 v13, v[204:207] offset:2560
    s_branch F2_W
F2S_78:
    s_cmp_lg_u32 s3, 3
    s_cbranch_scc1 F2S_79
    ds_write_b128 v13, v[208:211] offset:0
    ds_write_b128 v13, v[212:215] offset:512
    ds_write_b128 v13, v[216:219] offset:2048
    ds_write_b128 v13, v[220:223] offset:2560
    s_branch F2_W
F2S_79:
    s_cmp_lg_u32 s3, 4
    s_cbranch_scc1 F2S_80
    ds_write_b128 v13, v[224:227] offset:0
    ds_write_b128 v13, v[228:231] offset:512
    ds_write_b128 v13, v[232:235] offset:2048
    ds_write_b128 v13, v[236:239] offset:2560
    s_branch F2_W
F2S_80:
    ds_write_b128 v13, v[240:243] offset:0
    ds_write_b128 v13, v[244:247] offset:512
    ds_write_b128 v13, v[248:251] offset:2048
    ds_write_b128 v13, v[252:255] offset:2560
F2_W:
    s_waitcnt lgkmcnt(0)
    s_barrier
    v_mov_b32 v6, v2
F2_M:
    s_add_u32 s3, s34, s39
    v_add_u32 v7, s3, v5
    s_waitcnt vmcnt(5)
    ds_read_b128 v[36:39], v6 offset:0
    ds_read_b128 v[40:43], v6 offset:1024
    ds_read_b128 v[44:47], v6 offset:2048
    ds_read_b128 v[48:51], v6 offset:3072
    ds_read_b64_tr_b16 v[16:17], v7 offset:0
    ds_read_b64_tr_b16 v[18:19], v7 offset:1280
    ds_read_b64_tr_b16 v[20:21], v7 offset:32
    ds_read_b64_tr_b16 v[22:23], v7 offset:1312
    ds_read_b64_tr_b16 v[24:25], v7 offset:64
    ds_read_b64_tr_b16 v[26:27], v7 offset:1344
    ds_read_b64_tr_b16 v[28:29], v7 offset:96
    ds_read_b64_tr_b16 v[30:31], v7 offset:1376
    ds_read_b64_tr_b16 v[32:33], v7 offset:128
    ds_read_b64_tr_b16 v[34:35], v7 offset:1408
    s_add_u32 s3, s34, s37
    s_mov_b32 m0, s3
    s_nop 0
    buffer_load_dwordx4 v8, s[12:15], s35 offen  lds
    s_add_u32 s3, s3, 1024
    s_mov_b32 m0, s3
    s_nop 0
    buffer_load_dwordx4 v9, s[12:15], s35 offen  lds
    s_add_u32 s3, s3, 1024
    s_mov_b32 m0, s3
    s_nop 0
    buffer_load_dwordx4 v10, s[12:15], s35 offen  lds
    s_add_u32 s3, s3, 1024
    s_mov_b32 m0, s3
    s_nop 0
    buffer_load_dwordx4 v11, s[12:15], s35 offen  lds
    s_add_u32 s3, s3, 1024
    s_mov_b32 m0, s3
    s_nop 0
    buffer_load_dwordx4 v12, s[12:15], s35 offen  lds
    s_add_u32 s37, s37, 5120
    s_cmp_eq_u32 s37, 15360
    s_cselect_b32 s37, 0, s37
    s_add_u32 s35, s35, 40960
    s_cmp_eq_u32 s35, s48
    s_cselect_b32 s35, s47, s35
    s_add_u32 s39, s39, 5120
    s_cmp_eq_u32 s39, 15360
    s_cselect_b32 s39, 0, s39
    v_add_u32 v6, 4096, v6
    s_waitcnt lgkmcnt(8)
    v_mfma_f32_16x16x32_bf16 v[64:67], v[16:19], v[36:39], v[64:67]
    v_mfma_f32_16x16x32_bf16 v[68:71], v[16:19], v[40:43], v[68:71]
    v_mfma_f32_16x16x32_bf16 v[72:75], v[16:19], v[44:47], v[72:75]
    v_mfma_f32_16x16x32_bf16 v[76:79], v[16:19], v[48:51], v[76:79]
    s_waitcnt lgkmcnt(6)
    v_mfma_f32_16x16x32_bf16 v[80:83], v[20:23], v[36:39], v[80:83]
    v_mfma_f32_16x16x32_bf16 v[84:87], v[20:23], v[40:43], v[84:87]
    v_mfma_f32_16x16x32_bf16 v[88:91], v[20:23], v[44:47], v[88:91]
    v_mfma_f32_16x16x32_bf16 v[92:95], v[20:23], v[48:51], v[92:95]
    s_waitcnt lgkmcnt(4)
    v_mfma_f32_16x16x32_bf16 v[96:99], v[24:27], v[36:39], v[96:99]
    v_mfma_f32_16x16x32_bf16 v[100:103], v[24:27], v[40:43], v[100:103]
    v_mfma_f32_16x16x32_bf16 v[104:107], v[24:27], v[44:47], v[104:107]
    v_mfma_f32_16x16x32_bf16 v[108:111], v[24:27], v[48:51], v[108:111]
    s_waitcnt lgkmcnt(2)
    v_mfma_f32_16x16x32_bf16 v[112:115], v[28:31], v[36:39], v[112:115]
    v_mfma_f32_16x16x32_bf16 v[116:119], v[28:31], v[40:43], v[116:119]
    v_mfma_f32_16x16x32_bf16 v[120:123], v[28:31], v[44:47], v[120:123]
    v_mfma_f32_16x16x32_bf16 v[124:127], v[28:31], v[48:51], v[124:127]
    s_waitcnt lgkmcnt(0)
    v_mfma_f32_16x16x32_bf16 v[128:131], v[32:35], v[36:39], v[128:131]
    v_mfma_f32_16x16x32_bf16 v[132:135], v[32:35], v[40:43], v[132:135]
    v_mfma_f32_16x16x32_bf16 v[136:139], v[32:35], v[44:47], v[136:139]
    v_mfma_f32_16x16x32_bf16 v[140:143], v[32:35], v[48:51], v[140:143]
    s_add_u32 s40, s40, 1
    s_cmp_lt_u32 s40, 48
    s_cbranch_scc1 F2_K
    s_waitcnt vmcnt(0)
    s_mov_b32 s3, 0x3fb8aa3b
    v_and_b32 v5, 15, v0
    v_mul_u32_u24 v5, 160, v5
    v_lshrrev_b32 v6, 4, v0
    v_lshl_add_u32 v5, v6, 3, v5
    v_add_u32 v5, s34, v5
    v_cvt_pk_bf16_f32 v16, v64, v65
    v_lshlrev_b32 v64, 16, v16
    v_and_b32 v65, 0xffff0000, v16
    v_mul_f32 v16, s3, v64
    v_mul_f32 v17, s3, v65
    v_exp_f32 v16, -v16
    v_exp_f32 v17, -v17
    v_add_f32 v16, 1.0, v16
    v_add_f32 v17, 1.0, v17
    v_rcp_f32 v16, v16
    v_rcp_f32 v17, v17
    s_nop 0
    v_pk_mul_f32 v[64:65], v[64:65], v[16:17]
    v_cvt_pk_bf16_f32 v18, v66, v67
    v_lshlrev_b32 v66, 16, v18
    v_and_b32 v67, 0xffff0000, v18
    v_mul_f32 v18, s3, v66
    v_mul_f32 v19, s3, v67
    v_exp_f32 v18, -v18
    v_exp_f32 v19, -v19
    v_add_f32 v18, 1.0, v18
    v_add_f32 v19, 1.0, v19
    v_rcp_f32 v18, v18
    v_rcp_f32 v19, v19
    s_nop 0
    v_pk_mul_f32 v[66:67], v[66:67], v[18:19]
    v_cvt_pk_bf16_f32 v64, v64, v65
    v_cvt_pk_bf16_f32 v65, v66, v67
    ds_write_b64 v5, v[64:65] offset:0
    v_cvt_pk_bf16_f32 v16, v68, v69
    v_lshlrev_b32 v68, 16, v16
    v_and_b32 v69, 0xffff0000, v16
    v_mul_f32 v16, s3, v68
    v_mul_f32 v17, s3, v69
    v_exp_f32 v16, -v16
    v_exp_f32 v17, -v17
    v_add_f32 v16, 1.0, v16
    v_add_f32 v17, 1.0, v17
    v_rcp_f32 v16, v16
    v_rcp_f32 v17, v17
    s_nop 0
    v_pk_mul_f32 v[68:69], v[68:69], v[16:17]
    v_cvt_pk_bf16_f32 v18, v70, v71
    v_lshlrev_b32 v70, 16, v18
    v_and_b32 v71, 0xffff0000, v18
    v_mul_f32 v18, s3, v70
    v_mul_f32 v19, s3, v71
    v_exp_f32 v18, -v18
    v_exp_f32 v19, -v19
    v_add_f32 v18, 1.0, v18
    v_add_f32 v19, 1.0, v19
    v_rcp_f32 v18, v18
    v_rcp_f32 v19, v19
    s_nop 0
    v_pk_mul_f32 v[70:71], v[70:71], v[18:19]
    v_cvt_pk_bf16_f32 v68, v68, v69
    v_cvt_pk_bf16_f32 v69, v70, v71
    ds_write_b64 v5, v[68:69] offset:2560
    v_cvt_pk_bf16_f32 v16, v72, v73
    v_lshlrev_b32 v72, 16, v16
    v_and_b32 v73, 0xffff0000, v16
    v_mul_f32 v16, s3, v72
    v_mul_f32 v17, s3, v73
    v_exp_f32 v16, -v16
    v_exp_f32 v17, -v17
    v_add_f32 v16, 1.0, v16
    v_add_f32 v17, 1.0, v17
    v_rcp_f32 v16, v16
    v_rcp_f32 v17, v17
    s_nop 0
    v_pk_mul_f32 v[72:73], v[72:73], v[16:17]
    v_cvt_pk_bf16_f32 v18, v74, v75
    v_lshlrev_b32 v74, 16, v18
    v_and_b32 v75, 0xffff0000, v18
    v_mul_f32 v18, s3, v74
    v_mul_f32 v19, s3, v75
    v_exp_f32 v18, -v18
    v_exp_f32 v19, -v19
    v_add_f32 v18, 1.0, v18
    v_add_f32 v19, 1.0, v19
    v_rcp_f32 v18, v18
    v_rcp_f32 v19, v19
    s_nop 0
    v_pk_mul_f32 v[74:75], v[74:75], v[18:19]
    v_cvt_pk_bf16_f32 v72, v72, v73
    v_cvt_pk_bf16_f32 v73, v74, v75
    ds_write_b64 v5, v[72:73] offset:5120
    v_cvt_pk_bf16_f32 v16, v76, v77
    v_lshlrev_b32 v76, 16, v16
    v_and_b32 v77, 0xffff0000, v16
    v_mul_f32 v16, s3, v76
    v_mul_f32 v17, s3, v77
    v_exp_f32 v16, -v16
    v_exp_f32 v17, -v17
    v_add_f32 v16, 1.0, v16
    v_add_f32 v17, 1.0, v17
    v_rcp_f32 v16, v16
    v_rcp_f32 v17, v17
    s_nop 0
    v_pk_mul_f32 v[76:77], v[76:77], v[16:17]
    v_cvt_pk_bf16_f32 v18, v78, v79
    v_lshlrev_b32 v78, 16, v18
    v_and_b32 v79, 0xffff0000, v18
    v_mul_f32 v18, s3, v78
    v_mul_f32 v19, s3, v79
    v_exp_f32 v18, -v18
    v_exp_f32 v19, -v19
    v_add_f32 v18, 1.0, v18
    v_add_f32 v19, 1.0, v19
    v_rcp_f32 v18, v18
    v_rcp_f32 v19, v19
    s_nop 0
    v_pk_mul_f32 v[78:79], v[78:79], v[18:19]
    v_cvt_pk_bf16_f32 v76, v76, v77
    v_cvt_pk_bf16_f32 v77, v78, v79
    ds_write_b64 v5, v[76:77] offset:7680
    v_cvt_pk_bf16_f32 v16, v80, v81
    v_lshlrev_b32 v80, 16, v16
    v_and_b32 v81, 0xffff0000, v16
    v_mul_f32 v16, s3, v80
    v_mul_f32 v17, s3, v81
    v_exp_f32 v16, -v16
    v_exp_f32 v17, -v17
    v_add_f32 v16, 1.0, v16
    v_add_f32 v17, 1.0, v17
    v_rcp_f32 v16, v16
    v_rcp_f32 v17, v17
    s_nop 0
    v_pk_mul_f32 v[80:81], v[80:81], v[16:17]
    v_cvt_pk_bf16_f32 v18, v82, v83
    v_lshlrev_b32 v82, 16, v18
    v_and_b32 v83, 0xffff0000, v18
    v_mul_f32 v18, s3, v82
    v_mul_f32 v19, s3, v83
    v_exp_f32 v18, -v18
    v_exp_f32 v19, -v19
    v_add_f32 v18, 1.0, v18
    v_add_f32 v19, 1.0, v19
    v_rcp_f32 v18, v18
    v_rcp_f32 v19, v19
    s_nop 0
    v_pk_mul_f32 v[82:83], v[82:83], v[18:19]
    v_cvt_pk_bf16_f32 v80, v80, v81
    v_cvt_pk_bf16_f32 v81, v82, v83
    ds_write_b64 v5, v[80:81] offset:32
    v_cvt_pk_bf16_f32 v16, v84, v85
    v_lshlrev_b32 v84, 16, v16
    v_and_b32 v85, 0xffff0000, v16
    v_mul_f32 v16, s3, v84
    v_mul_f32 v17, s3, v85
    v_exp_f32 v16, -v16
    v_exp_f32 v17, -v17
    v_add_f32 v16, 1.0, v16
    v_add_f32 v17, 1.0, v17
    v_rcp_f32 v16, v16
    v_rcp_f32 v17, v17
    s_nop 0
    v_pk_mul_f32 v[84:85], v[84:85], v[16:17]
    v_cvt_pk_bf16_f32 v18, v86, v87
    v_lshlrev_b32 v86, 16, v18
    v_and_b32 v87, 0xffff0000, v18
    v_mul_f32 v18, s3, v86
    v_mul_f32 v19, s3, v87
    v_exp_f32 v18, -v18
    v_exp_f32 v19, -v19
    v_add_f32 v18, 1.0, v18
    v_add_f32 v19, 1.0, v19
    v_rcp_f32 v18, v18
    v_rcp_f32 v19, v19
    s_nop 0
    v_pk_mul_f32 v[86:87], v[86:87], v[18:19]
    v_cvt_pk_bf16_f32 v84, v84, v85
    v_cvt_pk_bf16_f32 v85, v86, v87
    ds_write_b64 v5, v[84:85] offset:2592
    v_cvt_pk_bf16_f32 v16, v88, v89
    v_lshlrev_b32 v88, 16, v16
    v_and_b32 v89, 0xffff0000, v16
    v_mul_f32 v16, s3, v88
    v_mul_f32 v17, s3, v89
    v_exp_f32 v16, -v16
    v_exp_f32 v17, -v17
    v_add_f32 v16, 1.0, v16
    v_add_f32 v17, 1.0, v17
    v_rcp_f32 v16, v16
    v_rcp_f32 v17, v17
    s_nop 0
    v_pk_mul_f32 v[88:89], v[88:89], v[16:17]
    v_cvt_pk_bf16_f32 v18, v90, v91
    v_lshlrev_b32 v90, 16, v18
    v_and_b32 v91, 0xffff0000, v18
    v_mul_f32 v18, s3, v90
    v_mul_f32 v19, s3, v91
    v_exp_f32 v18, -v18
    v_exp_f32 v19, -v19
    v_add_f32 v18, 1.0, v18
    v_add_f32 v19, 1.0, v19
    v_rcp_f32 v18, v18
    v_rcp_f32 v19, v19
    s_nop 0
    v_pk_mul_f32 v[90:91], v[90:91], v[18:19]
    v_cvt_pk_bf16_f32 v88, v88, v89
    v_cvt_pk_bf16_f32 v89, v90, v91
    ds_write_b64 v5, v[88:89] offset:5152
    v_cvt_pk_bf16_f32 v16, v92, v93
    v_lshlrev_b32 v92, 16, v16
    v_and_b32 v93, 0xffff0000, v16
    v_mul_f32 v16, s3, v92
    v_mul_f32 v17, s3, v93
    v_exp_f32 v16, -v16
    v_exp_f32 v17, -v17
    v_add_f32 v16, 1.0, v16
    v_add_f32 v17, 1.0, v17
    v_rcp_f32 v16, v16
    v_rcp_f32 v17, v17
    s_nop 0
    v_pk_mul_f32 v[92:93], v[92:93], v[16:17]
    v_cvt_pk_bf16_f32 v18, v94, v95
    v_lshlrev_b32 v94, 16, v18
    v_and_b32 v95, 0xffff0000, v18
    v_mul_f32 v18, s3, v94
    v_mul_f32 v19, s3, v95
    v_exp_f32 v18, -v18
    v_exp_f32 v19, -v19
    v_add_f32 v18, 1.0, v18
    v_add_f32 v19, 1.0, v19
    v_rcp_f32 v18, v18
    v_rcp_f32 v19, v19
    s_nop 0
    v_pk_mul_f32 v[94:95], v[94:95], v[18:19]
    v_cvt_pk_bf16_f32 v92, v92, v93
    v_cvt_pk_bf16_f32 v93, v94, v95
    ds_write_b64 v5, v[92:93] offset:7712
    v_cvt_pk_bf16_f32 v16, v96, v97
    v_lshlrev_b32 v96, 16, v16
    v_and_b32 v97, 0xffff0000, v16
    v_mul_f32 v16, s3, v96
    v_mul_f32 v17, s3, v97
    v_exp_f32 v16, -v16
    v_exp_f32 v17, -v17
    v_add_f32 v16, 1.0, v16
    v_add_f32 v17, 1.0, v17
    v_rcp_f32 v16, v16
    v_rcp_f32 v17, v17
    s_nop 0
    v_pk_mul_f32 v[96:97], v[96:97], v[16:17]
    v_cvt_pk_bf16_f32 v18, v98, v99
    v_lshlrev_b32 v98, 16, v18
    v_and_b32 v99, 0xffff0000, v18
    v_mul_f32 v18, s3, v98
    v_mul_f32 v19, s3, v99
    v_exp_f32 v18, -v18
    v_exp_f32 v19, -v19
    v_add_f32 v18, 1.0, v18
    v_add_f32 v19, 1.0, v19
    v_rcp_f32 v18, v18
    v_rcp_f32 v19, v19
    s_nop 0
    v_pk_mul_f32 v[98:99], v[98:99], v[18:19]
    v_cvt_pk_bf16_f32 v96, v96, v97
    v_cvt_pk_bf16_f32 v97, v98, v99
    ds_write_b64 v5, v[96:97] offset:64
    v_cvt_pk_bf16_f32 v16, v100, v101
    v_lshlrev_b32 v100, 16, v16
    v_and_b32 v101, 0xffff0000, v16
    v_mul_f32 v16, s3, v100
    v_mul_f32 v17, s3, v101
    v_exp_f32 v16, -v16
    v_exp_f32 v17, -v17
    v_add_f32 v16, 1.0, v16
    v_add_f32 v17, 1.0, v17
    v_rcp_f32 v16, v16
    v_rcp_f32 v17, v17
    s_nop 0
    v_pk_mul_f32 v[100:101], v[100:101], v[16:17]
    v_cvt_pk_bf16_f32 v18, v102, v103
    v_lshlrev_b32 v102, 16, v18
    v_and_b32 v103, 0xffff0000, v18
    v_mul_f32 v18, s3, v102
    v_mul_f32 v19, s3, v103
    v_exp_f32 v18, -v18
    v_exp_f32 v19, -v19
    v_add_f32 v18, 1.0, v18
    v_add_f32 v19, 1.0, v19
    v_rcp_f32 v18, v18
    v_rcp_f32 v19, v19
    s_nop 0
    v_pk_mul_f32 v[102:103], v[102:103], v[18:19]
    v_cvt_pk_bf16_f32 v100, v100, v101
    v_cvt_pk_bf16_f32 v101, v102, v103
    ds_write_b64 v5, v[100:101] offset:2624
    v_cvt_pk_bf16_f32 v16, v104, v105
    v_lshlrev_b32 v104, 16, v16
    v_and_b32 v105, 0xffff0000, v16
    v_mul_f32 v16, s3, v104
    v_mul_f32 v17, s3, v105
    v_exp_f32 v16, -v16
    v_exp_f32 v17, -v17
    v_add_f32 v16, 1.0, v16
    v_add_f32 v17, 1.0, v17
    v_rcp_f32 v16, v16
    v_rcp_f32 v17, v17
    s_nop 0
    v_pk_mul_f32 v[104:105], v[104:105], v[16:17]
    v_cvt_pk_bf16_f32 v18, v106, v107
    v_lshlrev_b32 v106, 16, v18
    v_and_b32 v107, 0xffff0000, v18
    v_mul_f32 v18, s3, v106
    v_mul_f32 v19, s3, v107
    v_exp_f32 v18, -v18
    v_exp_f32 v19, -v19
    v_add_f32 v18, 1.0, v18
    v_add_f32 v19, 1.0, v19
    v_rcp_f32 v18, v18
    v_rcp_f32 v19, v19
    s_nop 0
    v_pk_mul_f32 v[106:107], v[106:107], v[18:19]
    v_cvt_pk_bf16_f32 v104, v104, v105
    v_cvt_pk_bf16_f32 v105, v106, v107
    ds_write_b64 v5, v[104:105] offset:5184
    v_cvt_pk_bf16_f32 v16, v108, v109
    v_lshlrev_b32 v108, 16, v16
    v_and_b32 v109, 0xffff0000, v16
    v_mul_f32 v16, s3, v108
    v_mul_f32 v17, s3, v109
    v_exp_f32 v16, -v16
    v_exp_f32 v17, -v17
    v_add_f32 v16, 1.0, v16
    v_add_f32 v17, 1.0, v17
    v_rcp_f32 v16, v16
    v_rcp_f32 v17, v17
    s_nop 0
    v_pk_mul_f32 v[108:109], v[108:109], v[16:17]
    v_cvt_pk_bf16_f32 v18, v110, v111
    v_lshlrev_b32 v110, 16, v18
    v_and_b32 v111, 0xffff0000, v18
    v_mul_f32 v18, s3, v110
    v_mul_f32 v19, s3, v111
    v_exp_f32 v18, -v18
    v_exp_f32 v19, -v19
    v_add_f32 v18, 1.0, v18
    v_add_f32 v19, 1.0, v19
    v_rcp_f32 v18, v18
    v_rcp_f32 v19, v19
    s_nop 0
    v_pk_mul_f32 v[110:111], v[110:111], v[18:19]
    v_cvt_pk_bf16_f32 v108, v108, v109
    v_cvt_pk_bf16_f32 v109, v110, v111
    ds_write_b64 v5, v[108:109] offset:7744
    v_cvt_pk_bf16_f32 v16, v112, v113
    v_lshlrev_b32 v112, 16, v16
    v_and_b32 v113, 0xffff0000, v16
    v_mul_f32 v16, s3, v112
    v_mul_f32 v17, s3, v113
    v_exp_f32 v16, -v16
    v_exp_f32 v17, -v17
    v_add_f32 v16, 1.0, v16
    v_add_f32 v17, 1.0, v17
    v_rcp_f32 v16, v16
    v_rcp_f32 v17, v17
    s_nop 0
    v_pk_mul_f32 v[112:113], v[112:113], v[16:17]
    v_cvt_pk_bf16_f32 v18, v114, v115
    v_lshlrev_b32 v114, 16, v18
    v_and_b32 v115, 0xffff0000, v18
    v_mul_f32 v18, s3, v114
    v_mul_f32 v19, s3, v115
    v_exp_f32 v18, -v18
    v_exp_f32 v19, -v19
    v_add_f32 v18, 1.0, v18
    v_add_f32 v19, 1.0, v19
    v_rcp_f32 v18, v18
    v_rcp_f32 v19, v19
    s_nop 0
    v_pk_mul_f32 v[114:115], v[114:115], v[18:19]
    v_cvt_pk_bf16_f32 v112, v112, v113
    v_cvt_pk_bf16_f32 v113, v114, v115
    ds_write_b64 v5, v[112:113] offset:96
    v_cvt_pk_bf16_f32 v16, v116, v117
    v_lshlrev_b32 v116, 16, v16
    v_and_b32 v117, 0xffff0000, v16
    v_mul_f32 v16, s3, v116
    v_mul_f32 v17, s3, v117
    v_exp_f32 v16, -v16
    v_exp_f32 v17, -v17
    v_add_f32 v16, 1.0, v16
    v_add_f32 v17, 1.0, v17
    v_rcp_f32 v16, v16
    v_rcp_f32 v17, v17
    s_nop 0
    v_pk_mul_f32 v[116:117], v[116:117], v[16:17]
    v_cvt_pk_bf16_f32 v18, v118, v119
    v_lshlrev_b32 v118, 16, v18
    v_and_b32 v119, 0xffff0000, v18
    v_mul_f32 v18, s3, v118
    v_mul_f32 v19, s3, v119
    v_exp_f32 v18, -v18
    v_exp_f32 v19, -v19
    v_add_f32 v18, 1.0, v18
    v_add_f32 v19, 1.0, v19
    v_rcp_f32 v18, v18
    v_rcp_f32 v19, v19
    s_nop 0
    v_pk_mul_f32 v[118:119], v[118:119], v[18:19]
    v_cvt_pk_bf16_f32 v116, v116, v117
    v_cvt_pk_bf16_f32 v117, v118, v119
    ds_write_b64 v5, v[116:117] offset:2656
    v_cvt_pk_bf16_f32 v16, v120, v121
    v_lshlrev_b32 v120, 16, v16
    v_and_b32 v121, 0xffff0000, v16
    v_mul_f32 v16, s3, v120
    v_mul_f32 v17, s3, v121
    v_exp_f32 v16, -v16
    v_exp_f32 v17, -v17
    v_add_f32 v16, 1.0, v16
    v_add_f32 v17, 1.0, v17
    v_rcp_f32 v16, v16
    v_rcp_f32 v17, v17
    s_nop 0
    v_pk_mul_f32 v[120:121], v[120:121], v[16:17]
    v_cvt_pk_bf16_f32 v18, v122, v123
    v_lshlrev_b32 v122, 16, v18
    v_and_b32 v123, 0xffff0000, v18
    v_mul_f32 v18, s3, v122
    v_mul_f32 v19, s3, v123
    v_exp_f32 v18, -v18
    v_exp_f32 v19, -v19
    v_add_f32 v18, 1.0, v18
    v_add_f32 v19, 1.0, v19
    v_rcp_f32 v18, v18
    v_rcp_f32 v19, v19
    s_nop 0
    v_pk_mul_f32 v[122:123], v[122:123], v[18:19]
    v_cvt_pk_bf16_f32 v120, v120, v121
    v_cvt_pk_bf16_f32 v121, v122, v123
    ds_write_b64 v5, v[120:121] offset:5216
    v_cvt_pk_bf16_f32 v16, v124, v125
    v_lshlrev_b32 v124, 16, v16
    v_and_b32 v125, 0xffff0000, v16
    v_mul_f32 v16, s3, v124
    v_mul_f32 v17, s3, v125
    v_exp_f32 v16, -v16
    v_exp_f32 v17, -v17
    v_add_f32 v16, 1.0, v16
    v_add_f32 v17, 1.0, v17
    v_rcp_f32 v16, v16
    v_rcp_f32 v17, v17
    s_nop 0
    v_pk_mul_f32 v[124:125], v[124:125], v[16:17]
    v_cvt_pk_bf16_f32 v18, v126, v127
    v_lshlrev_b32 v126, 16, v18
    v_and_b32 v127, 0xffff0000, v18
    v_mul_f32 v18, s3, v126
    v_mul_f32 v19, s3, v127
    v_exp_f32 v18, -v18
    v_exp_f32 v19, -v19
    v_add_f32 v18, 1.0, v18
    v_add_f32 v19, 1.0, v19
    v_rcp_f32 v18, v18
    v_rcp_f32 v19, v19
    s_nop 0
    v_pk_mul_f32 v[126:127], v[126:127], v[18:19]
    v_cvt_pk_bf16_f32 v124, v124, v125
    v_cvt_pk_bf16_f32 v125, v126, v127
    ds_write_b64 v5, v[124:125] offset:7776
    v_cvt_pk_bf16_f32 v16, v128, v129
    v_lshlrev_b32 v128, 16, v16
    v_and_b32 v129, 0xffff0000, v16
    v_mul_f32 v16, s3, v128
    v_mul_f32 v17, s3, v129
    v_exp_f32 v16, -v16
    v_exp_f32 v17, -v17
    v_add_f32 v16, 1.0, v16
    v_add_f32 v17, 1.0, v17
    v_rcp_f32 v16, v16
    v_rcp_f32 v17, v17
    s_nop 0
    v_pk_mul_f32 v[128:129], v[128:129], v[16:17]
    v_cvt_pk_bf16_f32 v18, v130, v131
    v_lshlrev_b32 v130, 16, v18
    v_and_b32 v131, 0xffff0000, v18
    v_mul_f32 v18, s3, v130
    v_mul_f32 v19, s3, v131
    v_exp_f32 v18, -v18
    v_exp_f32 v19, -v19
    v_add_f32 v18, 1.0, v18
    v_add_f32 v19, 1.0, v19
    v_rcp_f32 v18, v18
    v_rcp_f32 v19, v19
    s_nop 0
    v_pk_mul_f32 v[130:131], v[130:131], v[18:19]
    v_cvt_pk_bf16_f32 v128, v128, v129
    v_cvt_pk_bf16_f32 v129, v130, v131
    ds_write_b64 v5, v[128:129] offset:128
    v_cvt_pk_bf16_f32 v16, v132, v133
    v_lshlrev_b32 v132, 16, v16
    v_and_b32 v133, 0xffff0000, v16
    v_mul_f32 v16, s3, v132
    v_mul_f32 v17, s3, v133
    v_exp_f32 v16, -v16
    v_exp_f32 v17, -v17
    v_add_f32 v16, 1.0, v16
    v_add_f32 v17, 1.0, v17
    v_rcp_f32 v16, v16
    v_rcp_f32 v17, v17
    s_nop 0
    v_pk_mul_f32 v[132:133], v[132:133], v[16:17]
    v_cvt_pk_bf16_f32 v18, v134, v135
    v_lshlrev_b32 v134, 16, v18
    v_and_b32 v135, 0xffff0000, v18
    v_mul_f32 v18, s3, v134
    v_mul_f32 v19, s3, v135
    v_exp_f32 v18, -v18
    v_exp_f32 v19, -v19
    v_add_f32 v18, 1.0, v18
    v_add_f32 v19, 1.0, v19
    v_rcp_f32 v18, v18
    v_rcp_f32 v19, v19
    s_nop 0
    v_pk_mul_f32 v[134:135], v[134:135], v[18:19]
    v_cvt_pk_bf16_f32 v132, v132, v133
    v_cvt_pk_bf16_f32 v133, v134, v135
    ds_write_b64 v5, v[132:133] offset:2688
    v_cvt_pk_bf16_f32 v16, v136, v137
    v_lshlrev_b32 v136, 16, v16
    v_and_b32 v137, 0xffff0000, v16
    v_mul_f32 v16, s3, v136
    v_mul_f32 v17, s3, v137
    v_exp_f32 v16, -v16
    v_exp_f32 v17, -v17
    v_add_f32 v16, 1.0, v16
    v_add_f32 v17, 1.0, v17
    v_rcp_f32 v16, v16
    v_rcp_f32 v17, v17
    s_nop 0
    v_pk_mul_f32 v[136:137], v[136:137], v[16:17]
    v_cvt_pk_bf16_f32 v18, v138, v139
    v_lshlrev_b32 v138, 16, v18
    v_and_b32 v139, 0xffff0000, v18
    v_mul_f32 v18, s3, v138
    v_mul_f32 v19, s3, v139
    v_exp_f32 v18, -v18
    v_exp_f32 v19, -v19
    v_add_f32 v18, 1.0, v18
    v_add_f32 v19, 1.0, v19
    v_rcp_f32 v18, v18
    v_rcp_f32 v19, v19
    s_nop 0
    v_pk_mul_f32 v[138:139], v[138:139], v[18:19]
    v_cvt_pk_bf16_f32 v136, v136, v137
    v_cvt_pk_bf16_f32 v137, v138, v139
    ds_write_b64 v5, v[136:137] offset:5248
    v_cvt_pk_bf16_f32 v16, v140, v141
    v_lshlrev_b32 v140, 16, v16
    v_and_b32 v141, 0xffff0000, v16
    v_mul_f32 v16, s3, v140
    v_mul_f32 v17, s3, v141
    v_exp_f32 v16, -v16
    v_exp_f32 v17, -v17
    v_add_f32 v16, 1.0, v16
    v_add_f32 v17, 1.0, v17
    v_rcp_f32 v16, v16
    v_rcp_f32 v17, v17
    s_nop 0
    v_pk_mul_f32 v[140:141], v[140:141], v[16:17]
    v_cvt_pk_bf16_f32 v18, v142, v143
    v_lshlrev_b32 v142, 16, v18
    v_and_b32 v143, 0xffff0000, v18
    v_mul_f32 v18, s3, v142
    v_mul_f32 v19, s3, v143
    v_exp_f32 v18, -v18
    v_exp_f32 v19, -v19
    v_add_f32 v18, 1.0, v18
    v_add_f32 v19, 1.0, v19
    v_rcp_f32 v18, v18
    v_rcp_f32 v19, v19
    s_nop 0
    v_pk_mul_f32 v[142:143], v[142:143], v[18:19]
    v_cvt_pk_bf16_f32 v140, v140, v141
    v_cvt_pk_bf16_f32 v141, v142, v143
    ds_write_b64 v5, v[140:141] offset:7808
    s_mov_b32 s12, s82
    s_mov_b32 s13, s83
    s_mov_b32 s14, 2621440
    s_mov_b32 s15, 0x00020000
    v_mul_u32_u24 v4, 52, v0
    v_lshrrev_b32 v4, 10, v4
    v_mul_u32_u24 v5, 20, v4
    v_sub_u32 v5, v0, v5
    s_mul_i32 s4, s26, 20
    v_add_u32 v7, s4, v5
    v_lshrrev_b32 v6, 3, v7
    v_lshlrev_b32 v6, 12, v6
    v_and_b32 v7, 7, v7
    v_lshl_add_u32 v6, v7, 4, v6
    v_mul_u32_u24 v7, 655360, v4
    v_add_u32 v6, v6, v7
    s_lshl_b32 s3, s33, 7
    v_add_u32 v6, s3, v6
    v_mul_u32_u24 v7, 40960, v4
    v_lshl_add_u32 v7, v5, 3, v7
    s_mul_i32 s3, s33, 1280
    s_mul_i32 s4, s26, 160
    s_add_u32 s3, s3, s4
    v_add_u32 v7, s3, v7
    v_mul_u32_u24 v8, 160, v4
    v_lshl_add_u32 v8, v5, 3, v8
    v_add_u32 v8, s34, v8
    s_lshl_b32 s3, s27, 12
    s_add_u32 s3, s3, 13632512
    v_mov_b32 v9, s3
    s_mov_b32 s40, 0
    s_mov_b32 s41, 14680064
    s_mov_b32 s42, 0
    s_waitcnt lgkmcnt(0)
FIN:
    buffer_load_dword v16, v9, s[8:11], 0 offen sc1
    s_waitcnt vmcnt(0)
    v_readfirstlane_b32 s3, v16
    s_cmp_ge_u32 s3, 60
    s_cselect_b32 s3, 64, s3
    s_sub_u32 s43, s3, s40
    s_min_u32 s43, s43, 3
    s_mul_i32 s3, s43, 20
    s_bfm_b64 s[44:45], s3, 0
    s_cmp_lg_u32 s43, 0
    s_cbranch_scc1 FIN_GO
    s_sleep 8
    s_sub_u32 s30, s30, 1
    s_cbranch_scc0 FIN
    s_branch END
FIN_GO:
    s_mov_b64 exec, s[44:45]
    s_add_u32 s3, s41, 0
    buffer_load_dwordx4 v[20:23], v6, s[8:11], s3 offen sc1
    s_add_u32 s3, s41, 81920
    buffer_load_dwordx4 v[24:27], v6, s[8:11], s3 offen sc1
    s_add_u32 s3, s41, 163840
    buffer_load_dwordx4 v[28:31], v6, s[8:11], s3 offen sc1
    s_add_u32 s3, s41, 245760
    buffer_load_dwordx4 v[32:35], v6, s[8:11], s3 offen sc1
    s_add_u32 s3, s41, 327680
    buffer_load_dwordx4 v[36:39], v6, s[8:11], s3 offen sc1
    s_add_u32 s3, s41, 409600
    buffer_load_dwordx4 v[40:43], v6, s[8:11], s3 offen sc1
    s_add_u32 s3, s41, 491520
    buffer_load_dwordx4 v[44:47], v6, s[8:11], s3 offen sc1
    s_add_u32 s3, s41, 573440
    buffer_load_dwordx4 v[48:51], v6, s[8:11], s3 offen sc1
    buffer_load_dwordx2 v[52:53], v7, s[20:23], s42 offen
    ds_read_b64 v[54:55], v8
    s_waitcnt vmcnt(8)
    v_bitop3_b32 v17, 1, v20, v21 bitop3:0x80
    v_bitop3_b32 v17, v17, v22, v23 bitop3:0x80
    s_waitcnt vmcnt(7)
    v_pk_add_f32 v[20:21], v[20:21], v[24:25]
    v_pk_add_f32 v[22:23], v[22:23], v[26:27]
    v_bitop3_b32 v17, v17, v24, v25 bitop3:0x80
    v_bitop3_b32 v17, v17, v26, v27 bitop3:0x80
    s_waitcnt vmcnt(6)
    v_pk_add_f32 v[20:21], v[20:21], v[28:29]
    v_pk_add_f32 v[22:23], v[22:23], v[30:31]
    v_bitop3_b32 v17, v17, v28, v29 bitop3:0x80
    v_bitop3_b32 v17, v17, v30, v31 bitop3:0x80
    s_waitcnt vmcnt(5)
    v_pk_add_f32 v[20:21], v[20:21], v[32:33]
    v_pk_add_f32 v[22:23], v[22:23], v[34:35]
    v_bitop3_b32 v17, v17, v32, v33 bitop3:0x80
    v_bitop3_b32 v17, v17, v34, v35 bitop3:0x80
    s_waitcnt vmcnt(4)
    v_pk_add_f32 v[20:21], v[20:21], v[36:37]
    v_pk_add_f32 v[22:23], v[22:23], v[38:39]
    v_bitop3_b32 v17, v17, v36, v37 bitop3:0x80
    v_bitop3_b32 v17, v17, v38, v39 bitop3:0x80
    s_waitcnt vmcnt(3)
    v_pk_add_f32 v[20:21], v[20:21], v[40:41]
    v_pk_add_f32 v[22:23], v[22:23], v[42:43]
    v_bitop3_b32 v17, v17, v40, v41 bitop3:0x80
    v_bitop3_b32 v17, v17, v42, v43 bitop3:0x80
    s_waitcnt vmcnt(2)
    v_pk_add_f32 v[20:21], v[20:21], v[44:45]
    v_pk_add_f32 v[22:23], v[22:23], v[46:47]
    v_bitop3_b32 v17, v17, v44, v45 bitop3:0x80
    v_bitop3_b32 v17, v17, v46, v47 bitop3:0x80
    s_waitcnt vmcnt(1)
    v_pk_add_f32 v[20:21], v[20:21], v[48:49]
    v_pk_add_f32 v[22:23], v[22:23], v[50:51]
    v_bitop3_b32 v17, v17, v48, v49 bitop3:0x80
    v_bitop3_b32 v17, v17, v50, v51 bitop3:0x80
    v_cmp_eq_u32 vcc, 0, v17
    s_cbranch_vccz FIN_OK
    s_waitcnt vmcnt(0) lgkmcnt(0)
    s_sub_u32 s30, s30, 1
    s_cbranch_scc0 FIN_GO
    s_branch END
FIN_OK:
    v_cvt_pk_bf16_f32 v20, v20, v21
    v_cvt_pk_bf16_f32 v22, v22, v23
    v_and_b32 v21, 0xffff0000, v20
    v_lshlrev_b32 v20, 16, v20
    v_and_b32 v23, 0xffff0000, v22
    v_lshlrev_b32 v22, 16, v22
    s_waitcnt lgkmcnt(0)
    v_lshlrev_b32 v24, 16, v54
    v_and_b32 v25, 0xffff0000, v54
    v_lshlrev_b32 v26, 16, v55
    v_and_b32 v27, 0xffff0000, v55
    v_pk_mul_f32 v[20:21], v[20:21], v[24:25]
    v_pk_mul_f32 v[22:23], v[22:23], v[26:27]
    v_cvt_pk_bf16_f32 v20, v20, v21
    v_cvt_pk_bf16_f32 v22, v22, v23
    v_and_b32 v21, 0xffff0000, v20
    v_lshlrev_b32 v20, 16, v20
    v_and_b32 v23, 0xffff0000, v22
    v_lshlrev_b32 v22, 16, v22
    s_waitcnt vmcnt(0)
    v_lshlrev_b32 v24, 16, v52
    v_and_b32 v25, 0xffff0000, v52
    v_lshlrev_b32 v26, 16, v53
    v_and_b32 v27, 0xffff0000, v53
    v_pk_add_f32 v[20:21], v[20:21], v[24:25]
    v_pk_add_f32 v[22:23], v[22:23], v[26:27]
    v_cvt_pk_bf16_f32 v20, v20, v21
    v_cvt_pk_bf16_f32 v21, v22, v23
    buffer_store_dwordx2 v[20:21], v7, s[12:15], s42 offen
    s_mov_b64 exec, -1
    s_add_u32 s40, s40, s43
    s_mul_i32 s3, s43, 655360
    s_add_u32 s41, s41, s3
    s_mul_i32 s3, s43, 40960
    s_add_u32 s42, s42, s3
    s_mul_i32 s3, s43, 160
    v_add_u32 v8, s3, v8
    s_cmp_lt_u32 s40, 64
    s_cbranch_scc1 FIN
    s_waitcnt vmcnt(0)
    s_waitcnt vmcnt(0)
END:
s_endpgm
.section .rodata,"a"
.p2align 6
.amdhsa_kernel recurrent_scan__memory_aug_recurrent_mem_tr__swiglu_ffn__prompt_kernel
  .amdhsa_next_free_vgpr 256
  .amdhsa_next_free_sgpr 102
  .amdhsa_accum_offset 256
  .amdhsa_group_segment_fixed_size 0
  .amdhsa_kernarg_size 112
  .amdhsa_user_sgpr_count 2
  .amdhsa_user_sgpr_kernarg_segment_ptr 1
  .amdhsa_system_sgpr_workgroup_id_x 1
.end_amdhsa_kernel
```
